```python
import torch

def _softmax(x, axis=-1):
    return torch.softmax(x, dim=axis)
def _gelu(x):
    return torch.nn.functional.gelu(x, approximate="tanh")
def _silu(x):
    return torch.nn.functional.silu(x)
def _sigmoid(x):
    return torch.sigmoid(x)
def _layernorm(x, axis=-1, eps=1e-5):
    m = x.mean(dim=axis, keepdim=True)
    v = x.var(dim=axis, keepdim=True, unbiased=False)
    return (x - m) / torch.sqrt(v + eps)
def _scatter_add(tgt, idx, src, axis=0):
    return tgt.clone().index_add_(axis, idx, src)
def _segment_sum(src, seg, n):
    out = torch.zeros((n,) + src.shape[1:], dtype=src.dtype)
    return out.index_add_(0, seg, src)
def _pad(x, pw):
    flat = tuple(v for pair in reversed(pw) for v in pair)
    return torch.nn.functional.pad(x, flat)

kernel_name = 'interleave_layers__sliding_block__mha_block__prompt'

def setup_inputs():

    _w = (lambda a: (lambda t: t.to(torch.bfloat16) if t.is_floating_point() else t)(torch.as_tensor(a)))
    def _A_setup():
        B, S, D = 1, 2048, 640
        return {
            "x": _w((lambda *s: torch.randn(*s, dtype=torch.bfloat16) * 0.05)(B, S, D)),
            "wqkv": _w((lambda *s: torch.randn(*s, dtype=torch.bfloat16) * 0.05)(D, 3 * D)),
            "wo": _w((lambda *s: torch.randn(*s, dtype=torch.bfloat16) * 0.05)(D, D)),
        }
    _A_in = _A_setup()

    def _B_setup():
        B, S, D, H = 1, 2048, 640, 32
        return {
            "x": _w((lambda *s: torch.randn(*s, dtype=torch.bfloat16) * 0.05)(B, S, D)),
            "wqkv": _w((lambda *s: torch.randn(*s, dtype=torch.bfloat16) * 0.05)(D, 3 * D)),
            "wo": _w((lambda *s: torch.randn(*s, dtype=torch.bfloat16) * 0.05)(D, D)),
        }
    _B_in = _B_setup()

    return {
        "A_x": _A_in["x"],
        "A_wqkv": _A_in["wqkv"],
        "A_wo": _A_in["wo"],
        "B_x": _B_in["x"],
        "B_wqkv": _B_in["wqkv"],
        "B_wo": _B_in["wo"],
    }

def reference(A_x, A_wqkv, A_wo, B_x, B_wqkv, B_wo):
    def _A_ref(x, wqkv, wo):
        B, S, D = x.shape
        H = 32; Dh = D // H; W = 256
        qkv = (lambda x, *d: x.permute(*d))((x @ wqkv).reshape(B, S, 3, H, Dh), 2, 0, 3, 1, 4)
        q, k, v = qkv[0], qkv[1], qkv[2]
        scores = torch.einsum("bhqd,bhkd->bhqk", q, k) * (Dh ** -0.5)
        idx = torch.arange(S)
        mask = (idx[:, None] - idx[None, :] >= 0) & (idx[:, None] - idx[None, :] < W)
        scores = torch.where(mask[None, None], scores, -1e9)
        p = _softmax(scores, axis=-1)
        o = torch.einsum("bhqk,bhkd->bhqd", p, v)
        return (lambda x, *d: x.permute(*d))(o, 0, 2, 1, 3).reshape(B, S, D) @ wo

    def _B_ref(x, wqkv, wo):
        B, S, D = x.shape
        H = 32
        Dh = D // H
        qkv = (lambda x, *d: x.permute(*d))((x @ wqkv).reshape(B, S, 3, H, Dh), 2, 0, 3, 1, 4)
        q, k, v = qkv[0], qkv[1], qkv[2]
        scores = torch.einsum("bhqd,bhkd->bhqk", q, k) * (Dh ** -0.5)
        p = _softmax(scores, axis=-1)
        o = torch.einsum("bhqk,bhkd->bhqd", p, v)
        return (lambda x, *d: x.permute(*d))(o, 0, 2, 1, 3).reshape(B, S, D) @ wo

    x = A_x
    x = x + _A_ref(_layernorm(x, axis=-1), A_wqkv, A_wo)
    x = x + _B_ref(_layernorm(x, axis=-1), B_wqkv, B_wo)
    x = x + _A_ref(_layernorm(x, axis=-1), A_wqkv, A_wo)
    x = x + _B_ref(_layernorm(x, axis=-1), B_wqkv, B_wo)
    return x
```

```asm
; @launch grid=(256,1,1) block=(512,1,1) lds=163840
.amdgcn_target "amdgcn-amd-amdhsa--gfx950"
.text
.globl interleave_layers__sliding_block__mha_block__prompt_kernel
.p2align 8
.type interleave_layers__sliding_block__mha_block__prompt_kernel,@function
interleave_layers__sliding_block__mha_block__prompt_kernel:
    s_load_dwordx2 s[4:5], s[0:1], 64
    s_load_dwordx2 s[6:7], s[0:1], 48
    s_load_dwordx2 s[24:25], s[0:1], 8
    s_load_dwordx2 s[26:27], s[0:1], 32
    s_load_dwordx2 s[100:101], s[0:1], 56
    s_load_dwordx2 s[40:41], s[0:1], 0
    s_load_dwordx2 s[96:97], s[0:1], 16
    s_load_dwordx2 s[98:99], s[0:1], 40
    s_cmp_ge_u32 s2, 256
    s_cbranch_scc1 L_exit
    s_getreg_b32 s3, hwreg(HW_REG_XCC_ID, 0, 4)
    s_and_b32 s13, s2, 7
    s_lshr_b32 s14, s2, 3
    v_lshrrev_b32 v1, 6, v0
    v_and_b32 v2, 63, v0
    v_and_b32 v254, 31, v0
    v_readfirstlane_b32 s12, v1
    v_bfe_u32 v253, v0, 5, 1
    v_lshlrev_b32 v255, 4, v2
    v_lshlrev_b32 v252, 2, v254
    v_cmp_eq_u32 s[28:29], 0, v253
    v_lshrrev_b32 v3, 4, v2
    v_bfe_u32 v4, v2, 2, 2
    v_xor_b32 v4, v3, v4
    v_mul_u32_u24 v244, 3840, v3
    v_lshl_add_u32 v244, v4, 6, v244
    v_and_b32 v3, 48, v255
    v_add_u32 v244, v244, v3
    s_mov_b32 s15, 0
    s_mov_b32 s16, 0
    s_mov_b32 s17, 0
    s_lshl_b32 s18, s13, 7
    s_add_u32 s18, s18, 0x1e50000
    s_lshl_b32 s19, s14, 2
    s_add_u32 s19, s19, s18
    s_mov_b32 s38, 0x400
    s_mov_b32 s30, 0x07060302
    s_mov_b32 s31, 0xffff0000
    s_mov_b32 s22, 2457600
    s_mov_b32 s23, 0x00020000
    s_mov_b32 s34, 5251072
    s_mov_b32 s35, 0x00020000
    s_and_b32 s36, s12, 3
    s_lshl_b32 s63, s36, 10
    s_mul_i32 s61, s36, 15360
    s_lshr_b32 s36, s14, 1
    s_lshl_b32 s36, s36, 8
    s_add_u32 s61, s61, s36
    s_waitcnt lgkmcnt(0)
    s_mov_b32 s8, s4
    s_and_b32 s9, s5, 0xffff
    s_mov_b32 s10, 0x10000000
    s_mov_b32 s11, 0x00020000
    s_bitcmp1_b32 s16, 0
    s_cselect_b32 s20, s26, s24
    s_cselect_b32 s21, s27, s25
    s_and_b32 s21, s21, 0xffff
    s_lshl_b32 s62, s13, 5
    s_add_u32 s62, s62, s14
    s_mov_b32 s51, 0x00020000
    s_and_b32 s37, s62, 3
    s_lshl_b32 s37, s37, 1
    v_add_u32 v3, s37, v253
    v_mul_u32_u24 v4, 1280, v254
    v_mul_u32_u24 v5, 160, v3
    v_add_u32 v4, v4, v5
    v_mul_u32_u24 v5, 5120, v3
    v_lshl_add_u32 v111, v254, 4, v5
    v_lshlrev_b32 v6, 3, v3
    v_lshl_add_u32 v110, v254, 6, v6
    v_and_b32 v6, 15, v2
    v_lshlrev_b32 v109, 5, v6
    s_mov_b32 s60, 0
    s_cmp_eq_u32 s12, 2
    s_cbranch_scc1 L_l_end
    s_cmp_eq_u32 s12, 3
    s_cbranch_scc1 L_l_c
    s_cmp_lg_u32 s12, 0
    s_cbranch_scc1 L_l_cs
    s_mov_b32 s48, s40
    s_and_b32 s49, s41, 0xffff
    s_mov_b32 s50, 2621440
    s_lshr_b32 s36, s62, 2
    s_mul_i32 s46, s36, 40960
    buffer_load_dwordx2 v[112:113], v4, s[48:51], s46 offen offset:0
    buffer_load_dwordx2 v[116:117], v4, s[48:51], s46 offen offset:8
    buffer_load_dwordx2 v[114:115], v4, s[48:51], s46 offen offset:16
    buffer_load_dwordx2 v[118:119], v4, s[48:51], s46 offen offset:24
    buffer_load_dwordx2 v[120:121], v4, s[48:51], s46 offen offset:32
    buffer_load_dwordx2 v[124:125], v4, s[48:51], s46 offen offset:40
    buffer_load_dwordx2 v[122:123], v4, s[48:51], s46 offen offset:48
    buffer_load_dwordx2 v[126:127], v4, s[48:51], s46 offen offset:56
    buffer_load_dwordx2 v[128:129], v4, s[48:51], s46 offen offset:64
    buffer_load_dwordx2 v[132:133], v4, s[48:51], s46 offen offset:72
    buffer_load_dwordx2 v[130:131], v4, s[48:51], s46 offen offset:80
    buffer_load_dwordx2 v[134:135], v4, s[48:51], s46 offen offset:88
    buffer_load_dwordx2 v[136:137], v4, s[48:51], s46 offen offset:96
    buffer_load_dwordx2 v[140:141], v4, s[48:51], s46 offen offset:104
    buffer_load_dwordx2 v[138:139], v4, s[48:51], s46 offen offset:112
    buffer_load_dwordx2 v[142:143], v4, s[48:51], s46 offen offset:120
    buffer_load_dwordx2 v[144:145], v4, s[48:51], s46 offen offset:128
    buffer_load_dwordx2 v[148:149], v4, s[48:51], s46 offen offset:136
    buffer_load_dwordx2 v[146:147], v4, s[48:51], s46 offen offset:144
    buffer_load_dwordx2 v[150:151], v4, s[48:51], s46 offen offset:152
    s_branch L_l_end
L_l_cs:
    s_cmp_ge_u32 s62, 240
    s_cbranch_scc1 L_l_end
    s_cmp_ge_u32 s62, 120
    s_cselect_b32 s48, s26, s24
    s_cselect_b32 s49, s27, s25
    s_cselect_b32 s36, 120, 0
    s_mov_b32 s60, 0x1e10000
    s_cselect_b32 s60, 0x1e20000, s60
    s_and_b32 s49, s49, 0xffff
    s_mov_b32 s50, 2457600
    s_sub_u32 s36, s62, s36
    s_lshr_b32 s37, s36, 3
    s_and_b32 s36, s36, 7
    s_mul_i32 s46, s36, 307200
    s_lshl_b32 s56, s37, 8
    s_add_u32 s46, s46, s56
    s_lshl_b32 s56, s37, 9
    s_add_u32 s60, s60, s56
    s_lshl_b32 s56, s36, 13
    s_add_u32 s60, s60, s56
    v_lshrrev_b32 v3, 4, v2
    v_mul_u32_u24 v3, 3840, v3
    v_lshl_add_u32 v3, v6, 4, v3
    s_mul_i32 s56, s63, 75
    s_add_u32 s46, s46, s56
    s_cmp_eq_u32 s12, 1
    s_cbranch_scc1 L_l_end
    s_add_u32 s56, s46, 0
    buffer_load_dwordx4 v[112:115], v3, s[48:51], s56 offen
    s_add_u32 s56, s46, 15360
    buffer_load_dwordx4 v[116:119], v3, s[48:51], s56 offen
    s_add_u32 s56, s46, 30720
    buffer_load_dwordx4 v[120:123], v3, s[48:51], s56 offen
    s_add_u32 s56, s46, 46080
    buffer_load_dwordx4 v[124:127], v3, s[48:51], s56 offen
    s_add_u32 s56, s46, 61440
    buffer_load_dwordx4 v[128:131], v3, s[48:51], s56 offen
    s_branch L_l_end
L_l_c:
    v_lshlrev_b32 v3, 19, v2
    buffer_load_dword v238, v3, s[8:11], 0 offen offset:64 sc1
    s_lshr_b32 s36, s14, 3
    s_mul_i32 s36, s36, 5505024
    s_and_b32 s37, s14, 7
    s_lshl_b32 s39, s13, 3
    s_add_u32 s37, s37, s39
    s_mul_i32 s37, s37, 82048
    s_add_u32 s36, s36, s37
    s_add_u32 s36, s36, 0x794000
    v_mov_b32 v4, 0
    v_mov_b32 v5, 0
    v_mov_b32 v6, 0
    v_mov_b32 v7, 0
    v_mov_b32 v12, 0x3f803f80
    v_mov_b32 v13, 0x3f803f80
    v_mov_b32 v14, 0x3f803f80
    v_mov_b32 v15, 0x3f803f80
    s_mov_b64 exec, 1
    buffer_store_dwordx4 v[12:15], v4, s[8:11], s36 offen sc1
    s_mov_b64 exec, -1
    s_cmp_lg_u32 s62, 255
    s_cbranch_scc1 L_l_end
    s_mov_b32 s36, 0x1e50000
    buffer_store_dwordx4 v[4:7], v255, s[8:11], s36 offen sc1
    buffer_store_dwordx4 v[4:7], v255, s[8:11], s36 offen offset:1024 sc1
    buffer_store_dwordx4 v[4:7], v255, s[8:11], s36 offen offset:2048 sc1
    buffer_store_dwordx4 v[4:7], v255, s[8:11], s36 offen offset:3072 sc1
    s_mov_b32 s52, s100
    s_and_b32 s53, s101, 0xffff
    s_mov_b32 s54, 256
    s_mov_b32 s55, 0x00020000
    s_waitcnt vmcnt(0)
    v_mov_b32 v5, 1
    s_mov_b64 exec, 1
    buffer_store_dword v5, v4, s[52:55], 0 offen sc1
    s_mov_b64 exec, -1
L_l_end:
    s_lshr_b32 s36, s14, 1
    s_and_b32 s37, s14, 1
    s_mul_i32 s39, s36, 2560
    s_mul_i32 s40, s37, 1536
    s_add_u32 s40, s40, s39
    v_add_u32 v249, s40, v255
    s_add_u32 s41, s39, 1024
    v_lshlrev_b32 v3, 4, v254
    v_add_u32 v4, s41, v3
    s_lshl_b32 s42, s37, 3
    v_add_u32 v245, s42, v4
    s_lshl_b32 s43, s37, 2
    s_mul_i32 s44, s14, 320
    s_add_u32 s44, s44, 40960
    s_mov_b32 s45, 10240
    v_mul_u32_u24 v5, 3277, v254
    v_lshrrev_b32 v5, 16, v5
    v_mul_u32_u24 v6, 20, v5
    v_sub_u32 v6, v254, v6
    v_add_u32 v6, s43, v6
    v_subrev_u32 v7, 20, v6
    v_cmp_gt_u32 s[46:47], 20, v6
    v_mad_u32_u24 v5, v5, s45, 0
    s_nop 0
    v_cndmask_b32 v6, v7, v6, s[46:47]
    v_lshl_add_u32 v5, v6, 4, v5
    v_add_u32 v8, s44, v5
    v_cndmask_b32 v250, v8, v4, s[28:29]
    v_subrev_u32 v250, 1024, v250
    v_add_u32 v9, 32, v2
    v_mul_u32_u24 v5, 3277, v9
    v_lshrrev_b32 v5, 16, v5
    v_mul_u32_u24 v6, 20, v5
    v_sub_u32 v6, v9, v6
    v_add_u32 v6, s43, v6
    v_subrev_u32 v7, 20, v6
    v_cmp_gt_u32 s[46:47], 20, v6
    v_mad_u32_u24 v5, v5, s45, 0
    s_nop 0
    v_cndmask_b32 v6, v7, v6, s[46:47]
    v_lshl_add_u32 v5, v6, 4, v5
    v_add_u32 v8, s44, v5
    v_mov_b32 v10, 81920
    v_cmp_gt_u32 s[46:47], 48, v2
    s_nop 1
    v_cndmask_b32 v251, v10, v8, s[46:47]
    v_subrev_u32 v251, 2048, v251
    v_add_u32 v5, s42, v3
    v_add_u32 v5, 1024, v5
    v_mov_b32 v6, 2816
    v_cndmask_b32 v246, v6, v5, s[28:29]
    v_cmp_gt_u32 s[46:47], 20, v254
    v_cmp_gt_u32 s[48:49], 28, v254
    v_mov_b32 v7, 12
    v_mov_b32 v8, 4
    v_cndmask_b32 v7, v7, v8, s[48:49]
    v_mul_u32_u24 v5, 20, v253
    v_add_u32 v5, 96, v5
    v_add_u32 v6, v5, v7
    v_and_b32 v6, 15, v6
    v_add_u32 v6, 176, v6
    v_add_u32 v5, v5, v254
    v_cndmask_b32 v5, v6, v5, s[46:47]
    v_lshlrev_b32 v247, 4, v5
    v_mul_u32_u24 v5, 20, v253
    v_add_u32 v5, 136, v5
    v_add_u32 v6, v5, v7
    v_and_b32 v6, 15, v6
    v_add_u32 v6, 176, v6
    v_add_u32 v5, v5, v254
    v_cndmask_b32 v5, v6, v5, s[46:47]
    v_lshlrev_b32 v248, 4, v5
    s_lshr_b32 s36, s14, 1
    s_lshl_b32 s36, s36, 8
    v_lshrrev_b32 v5, 1, v2
    v_mul_u32_u24 v5, 3840, v5
    v_and_b32 v6, 1, v2
    v_lshl_add_u32 v5, v6, 7, v5
    v_add_u32 v239, s36, v5
    s_mov_b32 s52, s100
    s_and_b32 s53, s101, 0xffff
    s_mov_b32 s54, 256
    s_mov_b32 s55, 0x00020000
    v_mov_b32 v11, 0
    s_cmp_ge_u32 s12, 4
    s_cbranch_scc1 L_xc_3
    s_cmp_lg_u32 s12, 0
    s_cbranch_scc1 L_xs_1
    s_lshr_b32 s36, s62, 2
    s_mul_i32 s46, s36, 40960
    s_add_u32 s46, s46, 0x0
    s_add_u32 s47, s46, 4096
    s_lshl_b32 s36, s36, 11
    s_add_u32 s36, s36, 0x1e30000
    s_mov_b32 s37, 0x3f803f80
    v_mov_b32 v8, 0
    v_mov_b32 v9, 0
    v_mov_b32 v12, 0
    v_mov_b32 v13, 0
    s_waitcnt vmcnt(0)
    buffer_store_dwordx4 v[112:115], v111, s[8:11], s46 offen offset:0 sc1
    buffer_store_dwordx4 v[116:119], v111, s[8:11], s46 offen offset:512 sc1
    buffer_store_dwordx4 v[120:123], v111, s[8:11], s46 offen offset:1024 sc1
    buffer_store_dwordx4 v[124:127], v111, s[8:11], s46 offen offset:1536 sc1
    buffer_store_dwordx4 v[128:131], v111, s[8:11], s46 offen offset:2048 sc1
    buffer_store_dwordx4 v[132:135], v111, s[8:11], s46 offen offset:2560 sc1
    buffer_store_dwordx4 v[136:139], v111, s[8:11], s46 offen offset:3072 sc1
    buffer_store_dwordx4 v[140:143], v111, s[8:11], s46 offen offset:3584 sc1
    buffer_store_dwordx4 v[144:147], v111, s[8:11], s47 offen offset:0 sc1
    buffer_store_dwordx4 v[148:151], v111, s[8:11], s47 offen offset:512 sc1
    v_dot2_f32_bf16 v8, v112, s37, v8
    v_dot2_f32_bf16 v9, v112, v112, v9
    v_dot2_f32_bf16 v12, v113, s37, v12
    v_dot2_f32_bf16 v13, v113, v113, v13
    v_dot2_f32_bf16 v8, v114, s37, v8
    v_dot2_f32_bf16 v9, v114, v114, v9
    v_dot2_f32_bf16 v12, v115, s37, v12
    v_dot2_f32_bf16 v13, v115, v115, v13
    v_dot2_f32_bf16 v8, v116, s37, v8
    v_dot2_f32_bf16 v9, v116, v116, v9
    v_dot2_f32_bf16 v12, v117, s37, v12
    v_dot2_f32_bf16 v13, v117, v117, v13
    v_dot2_f32_bf16 v8, v118, s37, v8
    v_dot2_f32_bf16 v9, v118, v118, v9
    v_dot2_f32_bf16 v12, v119, s37, v12
    v_dot2_f32_bf16 v13, v119, v119, v13
    v_dot2_f32_bf16 v8, v120, s37, v8
    v_dot2_f32_bf16 v9, v120, v120, v9
    v_dot2_f32_bf16 v12, v121, s37, v12
    v_dot2_f32_bf16 v13, v121, v121, v13
    v_dot2_f32_bf16 v8, v122, s37, v8
    v_dot2_f32_bf16 v9, v122, v122, v9
    v_dot2_f32_bf16 v12, v123, s37, v12
    v_dot2_f32_bf16 v13, v123, v123, v13
    v_dot2_f32_bf16 v8, v124, s37, v8
    v_dot2_f32_bf16 v9, v124, v124, v9
    v_dot2_f32_bf16 v12, v125, s37, v12
    v_dot2_f32_bf16 v13, v125, v125, v13
    v_dot2_f32_bf16 v8, v126, s37, v8
    v_dot2_f32_bf16 v9, v126, v126, v9
    v_dot2_f32_bf16 v12, v127, s37, v12
    v_dot2_f32_bf16 v13, v127, v127, v13
    v_dot2_f32_bf16 v8, v128, s37, v8
    v_dot2_f32_bf16 v9, v128, v128, v9
    v_dot2_f32_bf16 v12, v129, s37, v12
    v_dot2_f32_bf16 v13, v129, v129, v13
    v_dot2_f32_bf16 v8, v130, s37, v8
    v_dot2_f32_bf16 v9, v130, v130, v9
    v_dot2_f32_bf16 v12, v131, s37, v12
    v_dot2_f32_bf16 v13, v131, v131, v13
    v_dot2_f32_bf16 v8, v132, s37, v8
    v_dot2_f32_bf16 v9, v132, v132, v9
    v_dot2_f32_bf16 v12, v133, s37, v12
    v_dot2_f32_bf16 v13, v133, v133, v13
    v_dot2_f32_bf16 v8, v134, s37, v8
    v_dot2_f32_bf16 v9, v134, v134, v9
    v_dot2_f32_bf16 v12, v135, s37, v12
    v_dot2_f32_bf16 v13, v135, v135, v13
    v_dot2_f32_bf16 v8, v136, s37, v8
    v_dot2_f32_bf16 v9, v136, v136, v9
    v_dot2_f32_bf16 v12, v137, s37, v12
    v_dot2_f32_bf16 v13, v137, v137, v13
    v_dot2_f32_bf16 v8, v138, s37, v8
    v_dot2_f32_bf16 v9, v138, v138, v9
    v_dot2_f32_bf16 v12, v139, s37, v12
    v_dot2_f32_bf16 v13, v139, v139, v13
    v_dot2_f32_bf16 v8, v140, s37, v8
    v_dot2_f32_bf16 v9, v140, v140, v9
    v_dot2_f32_bf16 v12, v141, s37, v12
    v_dot2_f32_bf16 v13, v141, v141, v13
    v_dot2_f32_bf16 v8, v142, s37, v8
    v_dot2_f32_bf16 v9, v142, v142, v9
    v_dot2_f32_bf16 v12, v143, s37, v12
    v_dot2_f32_bf16 v13, v143, v143, v13
    v_dot2_f32_bf16 v8, v144, s37, v8
    v_dot2_f32_bf16 v9, v144, v144, v9
    v_dot2_f32_bf16 v12, v145, s37, v12
    v_dot2_f32_bf16 v13, v145, v145, v13
    v_dot2_f32_bf16 v8, v146, s37, v8
    v_dot2_f32_bf16 v9, v146, v146, v9
    v_dot2_f32_bf16 v12, v147, s37, v12
    v_dot2_f32_bf16 v13, v147, v147, v13
    v_dot2_f32_bf16 v8, v148, s37, v8
    v_dot2_f32_bf16 v9, v148, v148, v9
    v_dot2_f32_bf16 v12, v149, s37, v12
    v_dot2_f32_bf16 v13, v149, v149, v13
    v_dot2_f32_bf16 v8, v150, s37, v8
    v_dot2_f32_bf16 v9, v150, v150, v9
    v_dot2_f32_bf16 v12, v151, s37, v12
    v_dot2_f32_bf16 v13, v151, v151, v13
    s_nop 3
    v_add_f32 v8, v8, v12
    v_add_f32 v9, v9, v13
    buffer_store_dwordx2 v[8:9], v110, s[8:11], s36 offen sc1
    s_branch L_xs_1
L_xc_3:
    v_mov_b32 v8, 0
    v_mov_b32 v9, 0
    v_mov_b32 v10, 0
    v_mov_b32 v11, 0
    v_mov_b32 v12, 0
    v_mov_b32 v13, 0
    v_mov_b32 v14, 0
    v_mov_b32 v15, 0
    s_waitcnt vmcnt(4)
    v_lshlrev_b32 v16, 16, v112
    v_and_b32 v17, s31, v112
    v_add_f32 v8, v8, v16
    v_add_f32 v9, v9, v17
    v_lshlrev_b32 v16, 16, v113
    v_and_b32 v17, s31, v113
    v_add_f32 v10, v10, v16
    v_add_f32 v11, v11, v17
    v_lshlrev_b32 v16, 16, v114
    v_and_b32 v17, s31, v114
    v_add_f32 v12, v12, v16
    v_add_f32 v13, v13, v17
    v_lshlrev_b32 v16, 16, v115
    v_and_b32 v17, s31, v115
    v_add_f32 v14, v14, v16
    v_add_f32 v15, v15, v17
    s_waitcnt vmcnt(3)
    v_lshlrev_b32 v16, 16, v116
    v_and_b32 v17, s31, v116
    v_add_f32 v8, v8, v16
    v_add_f32 v9, v9, v17
    v_lshlrev_b32 v16, 16, v117
    v_and_b32 v17, s31, v117
    v_add_f32 v10, v10, v16
    v_add_f32 v11, v11, v17
    v_lshlrev_b32 v16, 16, v118
    v_and_b32 v17, s31, v118
    v_add_f32 v12, v12, v16
    v_add_f32 v13, v13, v17
    v_lshlrev_b32 v16, 16, v119
    v_and_b32 v17, s31, v119
    v_add_f32 v14, v14, v16
    v_add_f32 v15, v15, v17
    s_waitcnt vmcnt(2)
    v_lshlrev_b32 v16, 16, v120
    v_and_b32 v17, s31, v120
    v_add_f32 v8, v8, v16
    v_add_f32 v9, v9, v17
    v_lshlrev_b32 v16, 16, v121
    v_and_b32 v17, s31, v121
    v_add_f32 v10, v10, v16
    v_add_f32 v11, v11, v17
    v_lshlrev_b32 v16, 16, v122
    v_and_b32 v17, s31, v122
    v_add_f32 v12, v12, v16
    v_add_f32 v13, v13, v17
    v_lshlrev_b32 v16, 16, v123
    v_and_b32 v17, s31, v123
    v_add_f32 v14, v14, v16
    v_add_f32 v15, v15, v17
    s_waitcnt vmcnt(1)
    v_lshlrev_b32 v16, 16, v124
    v_and_b32 v17, s31, v124
    v_add_f32 v8, v8, v16
    v_add_f32 v9, v9, v17
    v_lshlrev_b32 v16, 16, v125
    v_and_b32 v17, s31, v125
    v_add_f32 v10, v10, v16
    v_add_f32 v11, v11, v17
    v_lshlrev_b32 v16, 16, v126
    v_and_b32 v17, s31, v126
    v_add_f32 v12, v12, v16
    v_add_f32 v13, v13, v17
    v_lshlrev_b32 v16, 16, v127
    v_and_b32 v17, s31, v127
    v_add_f32 v14, v14, v16
    v_add_f32 v15, v15, v17
    s_waitcnt vmcnt(0)
    v_lshlrev_b32 v16, 16, v128
    v_and_b32 v17, s31, v128
    v_add_f32 v8, v8, v16
    v_add_f32 v9, v9, v17
    v_lshlrev_b32 v16, 16, v129
    v_and_b32 v17, s31, v129
    v_add_f32 v10, v10, v16
    v_add_f32 v11, v11, v17
    v_lshlrev_b32 v16, 16, v130
    v_and_b32 v17, s31, v130
    v_add_f32 v12, v12, v16
    v_add_f32 v13, v13, v17
    v_lshlrev_b32 v16, 16, v131
    v_and_b32 v17, s31, v131
    v_add_f32 v14, v14, v16
    v_add_f32 v15, v15, v17
    s_lshl_b32 s36, s63, 1
    v_lshl_add_u32 v16, v255, 1, s36
    ds_write_b128 v16, v[8:11]
    ds_write_b128 v16, v[12:15] offset:16
    s_waitcnt lgkmcnt(0)
L_xs_1:
    s_barrier
    s_cmp_lg_u32 s12, 1
    s_cbranch_scc1 L_x2_4
    v_lshrrev_b32 v16, 1, v255
    ds_read_b64 v[20:21], v16 offset:0
    ds_read_b64 v[22:23], v16 offset:512
    ds_read_b64 v[24:25], v16 offset:1024
    ds_read_b64 v[26:27], v16 offset:1536
    ds_read_b64 v[28:29], v16 offset:2048
    ds_read_b64 v[30:31], v16 offset:2560
    ds_read_b64 v[32:33], v16 offset:3072
    ds_read_b64 v[34:35], v16 offset:3584
    ds_read_b64 v[36:37], v16 offset:4096
    ds_read_b64 v[38:39], v16 offset:4608
    ds_read_b64 v[40:41], v16 offset:5120
    ds_read_b64 v[42:43], v16 offset:5632
    ds_read_b64 v[44:45], v16 offset:6144
    ds_read_b64 v[46:47], v16 offset:6656
    ds_read_b64 v[48:49], v16 offset:7168
    ds_read_b64 v[50:51], v16 offset:7680
    s_waitcnt lgkmcnt(0)
    v_pk_add_f32 v[20:21], v[20:21], v[22:23]
    v_pk_add_f32 v[20:21], v[20:21], v[24:25]
    v_pk_add_f32 v[20:21], v[20:21], v[26:27]
    v_pk_add_f32 v[20:21], v[20:21], v[28:29]
    v_pk_add_f32 v[20:21], v[20:21], v[30:31]
    v_pk_add_f32 v[20:21], v[20:21], v[32:33]
    v_pk_add_f32 v[20:21], v[20:21], v[34:35]
    v_pk_add_f32 v[20:21], v[20:21], v[36:37]
    v_pk_add_f32 v[20:21], v[20:21], v[38:39]
    v_pk_add_f32 v[20:21], v[20:21], v[40:41]
    v_pk_add_f32 v[20:21], v[20:21], v[42:43]
    v_pk_add_f32 v[20:21], v[20:21], v[44:45]
    v_pk_add_f32 v[20:21], v[20:21], v[46:47]
    v_pk_add_f32 v[20:21], v[20:21], v[48:49]
    v_pk_add_f32 v[20:21], v[20:21], v[50:51]
    s_cmp_ge_u32 s62, 240
    s_cbranch_scc1 L_x2_4
    buffer_store_dwordx2 v[20:21], v16, s[8:11], s60 offen sc1
L_x2_4:
    s_cmp_lg_u32 s12, 3
    s_cbranch_scc1 L_xg_5
    s_mov_b32 s37, 400000
L_gate_p_6:
    buffer_load_dword v10, v11, s[52:55], 0 offen sc1
    s_waitcnt vmcnt(0)
    v_cmp_eq_u32 vcc, 0, v10
    s_cbranch_vccz L_gate_d_7
    s_sub_u32 s37, s37, 1
    s_cmp_lg_u32 s37, 0
    s_cbranch_scc1 L_gate_p_6
L_gate_d_7:
L_xg_5:
    s_barrier
    s_cmp_lt_u32 s12, 4
    s_cbranch_scc1 L_xw_2
    s_cmp_ge_u32 s14, 30
    s_cbranch_scc1 L_notlb
    s_add_u32 m0, s63, 0
    s_add_u32 s36, s61, 0
    buffer_load_dwordx4 v244, s[20:23], s36 offen lds
    s_add_u32 m0, s63, 4096
    s_add_u32 s36, s61, 61440
    buffer_load_dwordx4 v244, s[20:23], s36 offen lds
    s_add_u32 m0, s63, 8192
    s_add_u32 s36, s61, 122880
    buffer_load_dwordx4 v244, s[20:23], s36 offen lds
    s_add_u32 m0, s63, 12288
    s_add_u32 s36, s61, 184320
    buffer_load_dwordx4 v244, s[20:23], s36 offen lds
    s_add_u32 m0, s63, 16384
    s_add_u32 s36, s61, 245760
    buffer_load_dwordx4 v244, s[20:23], s36 offen lds
    s_add_u32 m0, s63, 20480
    s_add_u32 s36, s61, 307200
    buffer_load_dwordx4 v244, s[20:23], s36 offen lds
    s_add_u32 m0, s63, 24576
    s_add_u32 s36, s61, 368640
    buffer_load_dwordx4 v244, s[20:23], s36 offen lds
    s_add_u32 m0, s63, 28672
    s_add_u32 s36, s61, 430080
    buffer_load_dwordx4 v244, s[20:23], s36 offen lds
    s_add_u32 m0, s63, 32768
    s_add_u32 s36, s61, 491520
    buffer_load_dwordx4 v244, s[20:23], s36 offen lds
    s_add_u32 m0, s63, 36864
    s_add_u32 s36, s61, 552960
    buffer_load_dwordx4 v244, s[20:23], s36 offen lds
    s_add_u32 m0, s63, 40960
    s_add_u32 s36, s61, 614400
    buffer_load_dwordx4 v244, s[20:23], s36 offen lds
    s_add_u32 m0, s63, 45056
    s_add_u32 s36, s61, 675840
    buffer_load_dwordx4 v244, s[20:23], s36 offen lds
    s_add_u32 m0, s63, 49152
    s_add_u32 s36, s61, 737280
    buffer_load_dwordx4 v244, s[20:23], s36 offen lds
    s_add_u32 m0, s63, 53248
    s_add_u32 s36, s61, 798720
    buffer_load_dwordx4 v244, s[20:23], s36 offen lds
    s_add_u32 m0, s63, 57344
    s_add_u32 s36, s61, 860160
    buffer_load_dwordx4 v244, s[20:23], s36 offen lds
    s_add_u32 m0, s63, 61440
    s_add_u32 s36, s61, 921600
    buffer_load_dwordx4 v244, s[20:23], s36 offen lds
    s_add_u32 m0, s63, 65536
    s_add_u32 s36, s61, 983040
    buffer_load_dwordx4 v244, s[20:23], s36 offen lds
    s_add_u32 m0, s63, 69632
    s_add_u32 s36, s61, 1044480
    buffer_load_dwordx4 v244, s[20:23], s36 offen lds
    s_add_u32 m0, s63, 73728
    s_add_u32 s36, s61, 1105920
    buffer_load_dwordx4 v244, s[20:23], s36 offen lds
    s_add_u32 m0, s63, 77824
    s_add_u32 s36, s61, 1167360
    buffer_load_dwordx4 v244, s[20:23], s36 offen lds
    s_add_u32 m0, s63, 81920
    s_add_u32 s36, s61, 1228800
    buffer_load_dwordx4 v244, s[20:23], s36 offen lds
    s_add_u32 m0, s63, 86016
    s_add_u32 s36, s61, 1290240
    buffer_load_dwordx4 v244, s[20:23], s36 offen lds
    s_add_u32 m0, s63, 90112
    s_add_u32 s36, s61, 1351680
    buffer_load_dwordx4 v244, s[20:23], s36 offen lds
    s_add_u32 m0, s63, 94208
    s_add_u32 s36, s61, 1413120
    buffer_load_dwordx4 v244, s[20:23], s36 offen lds
    s_add_u32 m0, s63, 98304
    s_add_u32 s36, s61, 1474560
    buffer_load_dwordx4 v244, s[20:23], s36 offen lds
    s_add_u32 m0, s63, 102400
    s_add_u32 s36, s61, 1536000
    buffer_load_dwordx4 v244, s[20:23], s36 offen lds
    s_add_u32 m0, s63, 106496
    s_add_u32 s36, s61, 1597440
    buffer_load_dwordx4 v244, s[20:23], s36 offen lds
    s_add_u32 m0, s63, 110592
    s_add_u32 s36, s61, 1658880
    buffer_load_dwordx4 v244, s[20:23], s36 offen lds
    s_add_u32 m0, s63, 114688
    s_add_u32 s36, s61, 1720320
    buffer_load_dwordx4 v244, s[20:23], s36 offen lds
    s_add_u32 m0, s63, 118784
    s_add_u32 s36, s61, 1781760
    buffer_load_dwordx4 v244, s[20:23], s36 offen lds
    s_add_u32 m0, s63, 122880
    s_add_u32 s36, s61, 1843200
    buffer_load_dwordx4 v244, s[20:23], s36 offen lds
    s_add_u32 m0, s63, 126976
    s_add_u32 s36, s61, 1904640
    buffer_load_dwordx4 v244, s[20:23], s36 offen lds
    s_add_u32 m0, s63, 131072
    s_add_u32 s36, s61, 1966080
    buffer_load_dwordx4 v244, s[20:23], s36 offen lds
    s_add_u32 m0, s63, 135168
    s_add_u32 s36, s61, 2027520
    buffer_load_dwordx4 v244, s[20:23], s36 offen lds
    s_add_u32 m0, s63, 139264
    s_add_u32 s36, s61, 2088960
    buffer_load_dwordx4 v244, s[20:23], s36 offen lds
    s_add_u32 m0, s63, 143360
    s_add_u32 s36, s61, 2150400
    buffer_load_dwordx4 v244, s[20:23], s36 offen lds
    s_add_u32 m0, s63, 147456
    s_add_u32 s36, s61, 2211840
    buffer_load_dwordx4 v244, s[20:23], s36 offen lds
    s_add_u32 m0, s63, 151552
    s_add_u32 s36, s61, 2273280
    buffer_load_dwordx4 v244, s[20:23], s36 offen lds
    s_add_u32 m0, s63, 155648
    s_add_u32 s36, s61, 2334720
    buffer_load_dwordx4 v244, s[20:23], s36 offen lds
    s_add_u32 m0, s63, 159744
    s_add_u32 s36, s61, 2396160
    buffer_load_dwordx4 v244, s[20:23], s36 offen lds
    s_branch L_notlb
L_xw_2:
    s_cmp_eq_u32 s12, 2
    s_cbranch_scc1 L_notlb
    s_cmp_eq_u32 s12, 3
    s_cbranch_scc1 L_notlb
    s_cmp_eq_u32 s12, 0
    s_cselect_b32 s39, 0, s62
    s_cmp_ge_u32 s39, 240
    s_cbranch_scc1 L_notlb
    s_waitcnt vmcnt(0)
    s_add_u32 s36, s3, 1
    s_lshl_b32 s37, s12, 10
    s_add_u32 s37, s37, 0x800
    v_mov_b32 v10, s36
    v_mov_b32 v11, s19
    s_mov_b64 exec, 1
    buffer_store_dword v10, v11, s[8:11], s37 offen sc1
    s_mov_b64 exec, -1
    s_branch L_notlb
L_notlb:
    s_cmp_lt_u32 s14, 30
    s_cbranch_scc1 L_nwo_10
    s_lshl_b32 s42, s13, 1
    s_add_u32 s42, s42, s14
    s_sub_u32 s42, s42, 30
    s_sub_u32 s36, 7, s12
    s_lshl_b32 s36, s36, 4
    s_add_u32 s42, s42, s36
    s_mov_b32 s51, 0x00020000
L_wo_loop:
    s_cmp_ge_u32 s42, 160
    s_cbranch_scc1 L_wo_end
    s_cmp_ge_u32 s42, 80
    s_cselect_b32 s48, s98, s96
    s_cselect_b32 s49, s99, s97
    s_cselect_b32 s36, 80, 0
    s_mov_b32 s43, 0x1c80000
    s_cselect_b32 s43, 0x1d48000, s43
    s_and_b32 s49, s49, 0xffff
    s_mov_b32 s50, 819200
    s_sub_u32 s36, s42, s36
    s_mul_i32 s46, s36, 10240
    s_mul_i32 s37, s36, 205
    s_lshr_b32 s37, s37, 10
    s_mul_i32 s56, s37, 5
    s_sub_u32 s56, s36, s56
    s_lshr_b32 s57, s37, 2
    s_add_u32 s57, s57, 16
    s_and_b32 s58, s37, 3
    s_cmp_gt_u32 s56, 2
    s_cselect_b32 s59, 1, 0
    s_sub_u32 s59, s56, s59
    s_cmp_eq_u32 s56, 2
    s_cselect_b32 s37, s57, s37
    s_cselect_b32 s59, s58, s59
    s_mul_i32 s37, s37, 5120
    s_add_u32 s43, s43, s37
    s_lshl_b32 s59, s59, 8
    s_add_u32 s43, s43, s59
    v_lshrrev_b32 v4, 2, v255
    s_add_u32 s56, s46, 0
    buffer_load_dword v112, v4, s[48:51], s56 offen offset:0
    buffer_load_dword v120, v4, s[48:51], s56 offen offset:256
    buffer_load_dword v128, v4, s[48:51], s56 offen offset:512
    buffer_load_dword v136, v4, s[48:51], s56 offen offset:768
    buffer_load_dword v144, v4, s[48:51], s56 offen offset:1024
    s_add_u32 s56, s46, 1280
    buffer_load_dword v113, v4, s[48:51], s56 offen offset:0
    buffer_load_dword v121, v4, s[48:51], s56 offen offset:256
    buffer_load_dword v129, v4, s[48:51], s56 offen offset:512
    buffer_load_dword v137, v4, s[48:51], s56 offen offset:768
    buffer_load_dword v145, v4, s[48:51], s56 offen offset:1024
    s_add_u32 s56, s46, 2560
    buffer_load_dword v114, v4, s[48:51], s56 offen offset:0
    buffer_load_dword v122, v4, s[48:51], s56 offen offset:256
    buffer_load_dword v130, v4, s[48:51], s56 offen offset:512
    buffer_load_dword v138, v4, s[48:51], s56 offen offset:768
    buffer_load_dword v146, v4, s[48:51], s56 offen offset:1024
    s_add_u32 s56, s46, 3840
    buffer_load_dword v115, v4, s[48:51], s56 offen offset:0
    buffer_load_dword v123, v4, s[48:51], s56 offen offset:256
    buffer_load_dword v131, v4, s[48:51], s56 offen offset:512
    buffer_load_dword v139, v4, s[48:51], s56 offen offset:768
    buffer_load_dword v147, v4, s[48:51], s56 offen offset:1024
    s_add_u32 s56, s46, 5120
    buffer_load_dword v116, v4, s[48:51], s56 offen offset:0
    buffer_load_dword v124, v4, s[48:51], s56 offen offset:256
    buffer_load_dword v132, v4, s[48:51], s56 offen offset:512
    buffer_load_dword v140, v4, s[48:51], s56 offen offset:768
    buffer_load_dword v148, v4, s[48:51], s56 offen offset:1024
    s_add_u32 s56, s46, 6400
    buffer_load_dword v117, v4, s[48:51], s56 offen offset:0
    buffer_load_dword v125, v4, s[48:51], s56 offen offset:256
    buffer_load_dword v133, v4, s[48:51], s56 offen offset:512
    buffer_load_dword v141, v4, s[48:51], s56 offen offset:768
    buffer_load_dword v149, v4, s[48:51], s56 offen offset:1024
    s_add_u32 s56, s46, 7680
    buffer_load_dword v118, v4, s[48:51], s56 offen offset:0
    buffer_load_dword v126, v4, s[48:51], s56 offen offset:256
    buffer_load_dword v134, v4, s[48:51], s56 offen offset:512
    buffer_load_dword v142, v4, s[48:51], s56 offen offset:768
    buffer_load_dword v150, v4, s[48:51], s56 offen offset:1024
    s_add_u32 s56, s46, 8960
    buffer_load_dword v119, v4, s[48:51], s56 offen offset:0
    buffer_load_dword v127, v4, s[48:51], s56 offen offset:256
    buffer_load_dword v135, v4, s[48:51], s56 offen offset:512
    buffer_load_dword v143, v4, s[48:51], s56 offen offset:768
    buffer_load_dword v151, v4, s[48:51], s56 offen offset:1024
    s_mov_b32 s56, 0x05040100
    v_lshrrev_b32 v3, 3, v254
    v_and_b32 v4, 0x70, v255
    v_lshlrev_b32 v4, 1, v4
    v_lshl_add_u32 v4, v253, 4, v4
    v_add_u32 v5, 0, v3
    v_mul_u32_u24 v6, 205, v5
    v_lshrrev_b32 v6, 10, v6
    v_mul_u32_u24 v7, 5, v6
    v_sub_u32 v7, v5, v7
    v_mul_u32_u24 v6, 102400, v6
    v_lshl_add_u32 v6, v7, 10, v6
    v_add_u32 v52, v6, v4
    v_add_u32 v5, 4, v3
    v_mul_u32_u24 v6, 205, v5
    v_lshrrev_b32 v6, 10, v6
    v_mul_u32_u24 v7, 5, v6
    v_sub_u32 v7, v5, v7
    v_mul_u32_u24 v6, 102400, v6
    v_lshl_add_u32 v6, v7, 10, v6
    v_add_u32 v53, v6, v4
    v_add_u32 v5, 8, v3
    v_mul_u32_u24 v6, 205, v5
    v_lshrrev_b32 v6, 10, v6
    v_mul_u32_u24 v7, 5, v6
    v_sub_u32 v7, v5, v7
    v_mul_u32_u24 v6, 102400, v6
    v_lshl_add_u32 v6, v7, 10, v6
    v_add_u32 v54, v6, v4
    v_add_u32 v5, 12, v3
    v_mul_u32_u24 v6, 205, v5
    v_lshrrev_b32 v6, 10, v6
    v_mul_u32_u24 v7, 5, v6
    v_sub_u32 v7, v5, v7
    v_mul_u32_u24 v6, 102400, v6
    v_lshl_add_u32 v6, v7, 10, v6
    v_add_u32 v55, v6, v4
    v_add_u32 v5, 16, v3
    v_mul_u32_u24 v6, 205, v5
    v_lshrrev_b32 v6, 10, v6
    v_mul_u32_u24 v7, 5, v6
    v_sub_u32 v7, v5, v7
    v_mul_u32_u24 v6, 102400, v6
    v_lshl_add_u32 v6, v7, 10, v6
    v_add_u32 v56, v6, v4
    v_add_u32 v5, 20, v3
    v_mul_u32_u24 v6, 205, v5
    v_lshrrev_b32 v6, 10, v6
    v_mul_u32_u24 v7, 5, v6
    v_sub_u32 v7, v5, v7
    v_mul_u32_u24 v6, 102400, v6
    v_lshl_add_u32 v6, v7, 10, v6
    v_add_u32 v57, v6, v4
    v_add_u32 v5, 24, v3
    v_mul_u32_u24 v6, 205, v5
    v_lshrrev_b32 v6, 10, v6
    v_mul_u32_u24 v7, 5, v6
    v_sub_u32 v7, v5, v7
    v_mul_u32_u24 v6, 102400, v6
    v_lshl_add_u32 v6, v7, 10, v6
    v_add_u32 v58, v6, v4
    v_add_u32 v5, 28, v3
    v_mul_u32_u24 v6, 205, v5
    v_lshrrev_b32 v6, 10, v6
    v_mul_u32_u24 v7, 5, v6
    v_sub_u32 v7, v5, v7
    v_mul_u32_u24 v6, 102400, v6
    v_lshl_add_u32 v6, v7, 10, v6
    v_add_u32 v59, v6, v4
    v_add_u32 v5, 32, v3
    v_mul_u32_u24 v6, 205, v5
    v_lshrrev_b32 v6, 10, v6
    v_mul_u32_u24 v7, 5, v6
    v_sub_u32 v7, v5, v7
    v_mul_u32_u24 v6, 102400, v6
    v_lshl_add_u32 v6, v7, 10, v6
    v_add_u32 v60, v6, v4
    v_add_u32 v5, 36, v3
    v_mul_u32_u24 v6, 205, v5
    v_lshrrev_b32 v6, 10, v6
    v_mul_u32_u24 v7, 5, v6
    v_sub_u32 v7, v5, v7
    v_mul_u32_u24 v6, 102400, v6
    v_lshl_add_u32 v6, v7, 10, v6
    v_add_u32 v61, v6, v4
    s_waitcnt vmcnt(0)
    v_perm_b32 v12, v113, v112, s56
    v_perm_b32 v16, v113, v112, s30
    v_perm_b32 v13, v115, v114, s56
    v_perm_b32 v17, v115, v114, s30
    v_perm_b32 v14, v117, v116, s56
    v_perm_b32 v18, v117, v116, s30
    v_perm_b32 v15, v119, v118, s56
    v_perm_b32 v19, v119, v118, s30
    v_perm_b32 v20, v121, v120, s56
    v_perm_b32 v24, v121, v120, s30
    v_perm_b32 v21, v123, v122, s56
    v_perm_b32 v25, v123, v122, s30
    v_perm_b32 v22, v125, v124, s56
    v_perm_b32 v26, v125, v124, s30
    v_perm_b32 v23, v127, v126, s56
    v_perm_b32 v27, v127, v126, s30
    v_perm_b32 v28, v129, v128, s56
    v_perm_b32 v32, v129, v128, s30
    v_perm_b32 v29, v131, v130, s56
    v_perm_b32 v33, v131, v130, s30
    v_perm_b32 v30, v133, v132, s56
    v_perm_b32 v34, v133, v132, s30
    v_perm_b32 v31, v135, v134, s56
    v_perm_b32 v35, v135, v134, s30
    v_perm_b32 v36, v137, v136, s56
    v_perm_b32 v40, v137, v136, s30
    v_perm_b32 v37, v139, v138, s56
    v_perm_b32 v41, v139, v138, s30
    v_perm_b32 v38, v141, v140, s56
    v_perm_b32 v42, v141, v140, s30
    v_perm_b32 v39, v143, v142, s56
    v_perm_b32 v43, v143, v142, s30
    v_perm_b32 v44, v145, v144, s56
    v_perm_b32 v48, v145, v144, s30
    v_perm_b32 v45, v147, v146, s56
    v_perm_b32 v49, v147, v146, s30
    v_perm_b32 v46, v149, v148, s56
    v_perm_b32 v50, v149, v148, s30
    v_perm_b32 v47, v151, v150, s56
    v_perm_b32 v51, v151, v150, s30
    s_nop 1
    v_permlane32_swap_b32 v12, v16
    v_permlane32_swap_b32 v13, v17
    v_permlane32_swap_b32 v14, v18
    v_permlane32_swap_b32 v15, v19
    v_permlane32_swap_b32 v20, v24
    v_permlane32_swap_b32 v21, v25
    v_permlane32_swap_b32 v22, v26
    v_permlane32_swap_b32 v23, v27
    v_permlane32_swap_b32 v28, v32
    v_permlane32_swap_b32 v29, v33
    v_permlane32_swap_b32 v30, v34
    v_permlane32_swap_b32 v31, v35
    v_permlane32_swap_b32 v36, v40
    v_permlane32_swap_b32 v37, v41
    v_permlane32_swap_b32 v38, v42
    v_permlane32_swap_b32 v39, v43
    v_permlane32_swap_b32 v44, v48
    v_permlane32_swap_b32 v45, v49
    v_permlane32_swap_b32 v46, v50
    v_permlane32_swap_b32 v47, v51
    buffer_store_dwordx4 v[12:15], v52, s[8:11], s43 offen sc1
    buffer_store_dwordx4 v[16:19], v53, s[8:11], s43 offen sc1
    buffer_store_dwordx4 v[20:23], v54, s[8:11], s43 offen sc1
    buffer_store_dwordx4 v[24:27], v55, s[8:11], s43 offen sc1
    buffer_store_dwordx4 v[28:31], v56, s[8:11], s43 offen sc1
    buffer_store_dwordx4 v[32:35], v57, s[8:11], s43 offen sc1
    buffer_store_dwordx4 v[36:39], v58, s[8:11], s43 offen sc1
    buffer_store_dwordx4 v[40:43], v59, s[8:11], s43 offen sc1
    buffer_store_dwordx4 v[44:47], v60, s[8:11], s43 offen sc1
    buffer_store_dwordx4 v[48:51], v61, s[8:11], s43 offen sc1
    s_add_u32 s42, s42, 128
    s_branch L_wo_loop
L_wo_end:
    s_waitcnt vmcnt(0)
L_nwo_10:
    s_cmp_ge_u32 s12, 4
    s_cbranch_scc1 L_sb_9
    s_waitcnt vmcnt(0)
    s_cmp_lg_u32 s12, 0
    s_cbranch_scc1 L_sb_9
    s_add_u32 s36, s18, 0x800
    s_mov_b32 s37, 400000
L_m0_p_11:
    buffer_load_dword v240, v252, s[8:11], s36 offen sc1
    s_waitcnt vmcnt(0)
    v_cmp_eq_u32 vcc, 0, v240
    s_cbranch_vccz L_m0_d_12
    s_sub_u32 s37, s37, 1
    s_cmp_lg_u32 s37, 0
    s_cbranch_scc1 L_m0_p_11
L_m0_d_12:
    s_add_u32 s36, s3, 1
    v_cmp_ne_u32 vcc, s36, v240
    s_cmp_lg_u64 vcc, 0
    s_cselect_b32 s15, 1, 0
L_sb_9:
    s_barrier
    s_cmp_lt_u32 s14, 30
    s_cbranch_scc1 L_qkv
    s_cmp_lg_u32 s12, 1
    s_cbranch_scc1 L_g0_14
    s_mov_b64 exec, 1
    v_mov_b32 v240, 1
    v_mov_b32 v241, s19
    buffer_store_dword v240, v241, s[8:11], s38 offen sc1
    s_mov_b64 exec, -1
L_g0_14:
L_qkv:
    s_and_b32 s41, s16, 1
    s_cmp_eq_u32 s16, 3
    s_cselect_b32 s60, 2, s41
    s_mul_i32 s60, s60, 5505024
    s_add_u32 s60, s60, 0xcc0000
    s_add_u32 s32, s4, s60
    s_addc_u32 s33, s5, 0
    s_and_b32 s33, s33, 0xffff
    s_cmp_ge_u32 s14, 30
    s_cbranch_scc1 L_qkv_idle
    s_cmp_ge_u32 s12, 4
    s_cbranch_scc1 L_qkv_help
    s_and_b32 s39, s14, 1
    s_lshl_b32 s40, s13, 1
    s_add_u32 s39, s39, s40
    s_lshr_b32 s40, s14, 1
    s_lshl_b32 s42, s39, 2
    s_add_u32 s42, s42, s12
    s_lshl_b32 s43, s40, 9
    s_add_u32 s43, s43, 0x1e10000
    s_cmp_lg_u32 s41, 0
    s_cselect_b64 s[54:55], -1, 0
    s_lshl_b32 s44, s42, 11
    s_add_u32 s44, s44, 0x1e30000
    s_mul_i32 s45, s42, 40960
    s_add_u32 s45, s45, 0x0
    s_sub_u32 s51, s60, 0x780000
    v_bfe_u32 v225, v255, 6, 2
    v_bfe_u32 v226, v255, 4, 2
    v_bfe_u32 v227, v255, 8, 1
    v_lshl_add_u32 v228, v253, 2, v225
    v_lshlrev_b32 v228, 8, v228
    v_lshl_add_u32 v228, v227, 5, v228
    v_lshl_add_u32 v228, v226, 3, v228
    v_xor_b32 v226, 0, v225
    v_lshl_add_u32 v192, v226, 6, v228
    v_xor_b32 v226, 1, v225
    v_lshl_add_u32 v193, v226, 6, v228
    v_xor_b32 v226, 2, v225
    v_lshl_add_u32 v194, v226, 6, v228
    v_xor_b32 v226, 3, v225
    v_lshl_add_u32 v195, v226, 6, v228
    v_lshlrev_b32 v230, 6, v254
    v_lshl_add_u32 v230, v253, 5, v230
    v_lshl_add_u32 v231, v253, 15, v252
    s_cmp_ge_u32 s40, 10
    s_cbranch_scc1 L_qkv_v
    s_mul_i32 s47, s42, 40960
    s_add_u32 s47, s47, 0x280000
    s_mul_i32 s48, s42, 82048
    s_add_u32 s48, s48, 0x776000
    s_cmp_ge_u32 s40, 5
    s_cselect_b32 s47, s48, s47
    s_cselect_b32 s52, 1.0, 0x3ea52b5c
    s_lshl_b32 s48, s40, 13
    s_add_u32 s47, s47, s48
    s_add_u32 s48, s47, 4096
    s_add_u32 s49, s47, s51
    s_add_u32 s50, s48, s51
    s_cmp_eq_u32 s16, 0
    s_cbranch_scc1 L_qkv_nopoll_15
    buffer_load_dword v240, v252, s[8:11], s18 offen sc1
    s_barrier
    ds_read_b64_tr_b16 v[64:65], v192 offset:0
    ds_read_b64_tr_b16 v[66:67], v192 offset:2048
    ds_read_b64_tr_b16 v[68:69], v193 offset:0
    ds_read_b64_tr_b16 v[70:71], v193 offset:2048
    ds_read_b64_tr_b16 v[72:73], v194 offset:0
    ds_read_b64_tr_b16 v[74:75], v194 offset:2048
    ds_read_b64_tr_b16 v[76:77], v195 offset:0
    ds_read_b64_tr_b16 v[78:79], v195 offset:2048
    ds_read_b64_tr_b16 v[80:81], v192 offset:4096
    ds_read_b64_tr_b16 v[82:83], v192 offset:6144
    ds_read_b64_tr_b16 v[84:85], v193 offset:4096
    ds_read_b64_tr_b16 v[86:87], v193 offset:6144
    ds_read_b64_tr_b16 v[88:89], v194 offset:4096
    ds_read_b64_tr_b16 v[90:91], v194 offset:6144
    ds_read_b64_tr_b16 v[92:93], v195 offset:4096
    ds_read_b64_tr_b16 v[94:95], v195 offset:6144
    s_waitcnt vmcnt(0)
    v_cmp_gt_u32 vcc, s17, v240
    s_cbranch_vccz L_qkv_d_18
    s_mov_b32 s37, 400000
L_qkv_p_17:
    buffer_load_dword v240, v252, s[8:11], s18 offen sc1
    s_waitcnt vmcnt(0)
    v_cmp_gt_u32 vcc, s17, v240
    s_cbranch_vccz L_qkv_d_18
    s_sub_u32 s37, s37, 1
    s_cmp_lg_u32 s37, 0
    s_cbranch_scc1 L_qkv_p_17
L_qkv_d_18:
    s_add_u32 s46, s45, 0
    buffer_load_dwordx4 v[96:99], v255, s[8:11], s46 offen offset:0 sc1
    buffer_load_dwordx4 v[100:103], v255, s[8:11], s46 offen offset:1024 sc1
    buffer_load_dwordx4 v[104:107], v255, s[8:11], s46 offen offset:2048 sc1
    buffer_load_dwordx4 v[108:111], v255, s[8:11], s46 offen offset:3072 sc1
    s_add_u32 s46, s45, 4096
    buffer_load_dwordx4 v[112:115], v255, s[8:11], s46 offen offset:0 sc1
    buffer_load_dwordx4 v[116:119], v255, s[8:11], s46 offen offset:1024 sc1
    s_branch L_qkv_first_16
L_qkv_nopoll_15:
    s_add_u32 s46, s45, 0
    buffer_load_dwordx4 v[96:99], v255, s[8:11], s46 offen offset:0 sc1
    buffer_load_dwordx4 v[100:103], v255, s[8:11], s46 offen offset:1024 sc1
    buffer_load_dwordx4 v[104:107], v255, s[8:11], s46 offen offset:2048 sc1
    buffer_load_dwordx4 v[108:111], v255, s[8:11], s46 offen offset:3072 sc1
    s_add_u32 s46, s45, 4096
    buffer_load_dwordx4 v[112:115], v255, s[8:11], s46 offen offset:0 sc1
    buffer_load_dwordx4 v[116:119], v255, s[8:11], s46 offen offset:1024 sc1
    s_barrier
    ds_read_b64_tr_b16 v[64:65], v192 offset:0
    ds_read_b64_tr_b16 v[66:67], v192 offset:2048
    ds_read_b64_tr_b16 v[68:69], v193 offset:0
    ds_read_b64_tr_b16 v[70:71], v193 offset:2048
    ds_read_b64_tr_b16 v[72:73], v194 offset:0
    ds_read_b64_tr_b16 v[74:75], v194 offset:2048
    ds_read_b64_tr_b16 v[76:77], v195 offset:0
    ds_read_b64_tr_b16 v[78:79], v195 offset:2048
    ds_read_b64_tr_b16 v[80:81], v192 offset:4096
    ds_read_b64_tr_b16 v[82:83], v192 offset:6144
    ds_read_b64_tr_b16 v[84:85], v193 offset:4096
    ds_read_b64_tr_b16 v[86:87], v193 offset:6144
    ds_read_b64_tr_b16 v[88:89], v194 offset:4096
    ds_read_b64_tr_b16 v[90:91], v194 offset:6144
    ds_read_b64_tr_b16 v[92:93], v195 offset:4096
    ds_read_b64_tr_b16 v[94:95], v195 offset:6144
L_qkv_first_16:
    s_waitcnt vmcnt(5)
    s_waitcnt lgkmcnt(14)
    v_mfma_f32_32x32x16_bf16 v[0:15], v[64:67], v[96:99], 0
    ds_read_b64_tr_b16 v[64:65], v192 offset:8192
    ds_read_b64_tr_b16 v[66:67], v192 offset:10240
    s_waitcnt lgkmcnt(14)
    v_mfma_f32_32x32x16_bf16 v[16:31], v[68:71], v[96:99], 0
    ds_read_b64_tr_b16 v[68:69], v193 offset:8192
    ds_read_b64_tr_b16 v[70:71], v193 offset:10240
    buffer_load_dwordx4 v[120:123], v255, s[8:11], s46 offen offset:2048 sc1
    s_waitcnt lgkmcnt(14)
    v_mfma_f32_32x32x16_bf16 v[32:47], v[72:75], v[96:99], 0
    ds_read_b64_tr_b16 v[72:73], v194 offset:8192
    ds_read_b64_tr_b16 v[74:75], v194 offset:10240
    s_waitcnt lgkmcnt(14)
    v_mfma_f32_32x32x16_bf16 v[48:63], v[76:79], v[96:99], 0
    ds_read_b64_tr_b16 v[76:77], v195 offset:8192
    ds_read_b64_tr_b16 v[78:79], v195 offset:10240
    buffer_load_dwordx4 v[124:127], v255, s[8:11], s46 offen offset:3072 sc1
    s_waitcnt vmcnt(6)
    s_waitcnt lgkmcnt(14)
    v_mfma_f32_32x32x16_bf16 v[0:15], v[80:83], v[100:103], v[0:15]
    ds_read_b64_tr_b16 v[80:81], v192 offset:12288
    ds_read_b64_tr_b16 v[82:83], v192 offset:14336
    s_waitcnt lgkmcnt(14)
    v_mfma_f32_32x32x16_bf16 v[16:31], v[84:87], v[100:103], v[16:31]
    ds_read_b64_tr_b16 v[84:85], v193 offset:12288
    ds_read_b64_tr_b16 v[86:87], v193 offset:14336
    s_add_u32 s46, s45, 8192
    buffer_load_dwordx4 v[128:131], v255, s[8:11], s46 offen offset:0 sc1
    s_waitcnt lgkmcnt(14)
    v_mfma_f32_32x32x16_bf16 v[32:47], v[88:91], v[100:103], v[32:47]
    ds_read_b64_tr_b16 v[88:89], v194 offset:12288
    ds_read_b64_tr_b16 v[90:91], v194 offset:14336
    s_waitcnt lgkmcnt(14)
    v_mfma_f32_32x32x16_bf16 v[48:63], v[92:95], v[100:103], v[48:63]
    ds_read_b64_tr_b16 v[92:93], v195 offset:12288
    ds_read_b64_tr_b16 v[94:95], v195 offset:14336
    buffer_load_dwordx4 v[132:135], v255, s[8:11], s46 offen offset:1024 sc1
    s_waitcnt vmcnt(7)
    s_waitcnt lgkmcnt(14)
    v_mfma_f32_32x32x16_bf16 v[0:15], v[64:67], v[104:107], v[0:15]
    ds_read_b64_tr_b16 v[64:65], v192 offset:16384
    ds_read_b64_tr_b16 v[66:67], v192 offset:18432
    s_waitcnt lgkmcnt(14)
    v_mfma_f32_32x32x16_bf16 v[16:31], v[68:71], v[104:107], v[16:31]
    ds_read_b64_tr_b16 v[68:69], v193 offset:16384
    ds_read_b64_tr_b16 v[70:71], v193 offset:18432
    buffer_load_dwordx4 v[136:139], v255, s[8:11], s46 offen offset:2048 sc1
    s_waitcnt lgkmcnt(14)
    v_mfma_f32_32x32x16_bf16 v[32:47], v[72:75], v[104:107], v[32:47]
    ds_read_b64_tr_b16 v[72:73], v194 offset:16384
    ds_read_b64_tr_b16 v[74:75], v194 offset:18432
    s_waitcnt lgkmcnt(14)
    v_mfma_f32_32x32x16_bf16 v[48:63], v[76:79], v[104:107], v[48:63]
    ds_read_b64_tr_b16 v[76:77], v195 offset:16384
    ds_read_b64_tr_b16 v[78:79], v195 offset:18432
    buffer_load_dwordx4 v[140:143], v255, s[8:11], s46 offen offset:3072 sc1
    s_waitcnt vmcnt(8)
    s_waitcnt lgkmcnt(14)
    v_mfma_f32_32x32x16_bf16 v[0:15], v[80:83], v[108:111], v[0:15]
    ds_read_b64_tr_b16 v[80:81], v192 offset:20480
    ds_read_b64_tr_b16 v[82:83], v192 offset:22528
    s_waitcnt lgkmcnt(14)
    v_mfma_f32_32x32x16_bf16 v[16:31], v[84:87], v[108:111], v[16:31]
    ds_read_b64_tr_b16 v[84:85], v193 offset:20480
    ds_read_b64_tr_b16 v[86:87], v193 offset:22528
    s_add_u32 s46, s45, 12288
    buffer_load_dwordx4 v[144:147], v255, s[8:11], s46 offen offset:0 sc1
    s_waitcnt lgkmcnt(14)
    v_mfma_f32_32x32x16_bf16 v[32:47], v[88:91], v[108:111], v[32:47]
    ds_read_b64_tr_b16 v[88:89], v194 offset:20480
    ds_read_b64_tr_b16 v[90:91], v194 offset:22528
    s_waitcnt lgkmcnt(14)
    v_mfma_f32_32x32x16_bf16 v[48:63], v[92:95], v[108:111], v[48:63]
    ds_read_b64_tr_b16 v[92:93], v195 offset:20480
    ds_read_b64_tr_b16 v[94:95], v195 offset:22528
    buffer_load_dwordx4 v[148:151], v255, s[8:11], s46 offen offset:1024 sc1
    s_waitcnt vmcnt(9)
    s_waitcnt lgkmcnt(14)
    v_mfma_f32_32x32x16_bf16 v[0:15], v[64:67], v[112:115], v[0:15]
    ds_read_b64_tr_b16 v[64:65], v192 offset:24576
    ds_read_b64_tr_b16 v[66:67], v192 offset:26624
    buffer_load_dwordx4 v[208:211], v230, s[8:11], s44 offen offset:0 sc1
    s_waitcnt lgkmcnt(14)
    v_mfma_f32_32x32x16_bf16 v[16:31], v[68:71], v[112:115], v[16:31]
    ds_read_b64_tr_b16 v[68:69], v193 offset:24576
    ds_read_b64_tr_b16 v[70:71], v193 offset:26624
    buffer_load_dwordx4 v[152:155], v255, s[8:11], s46 offen offset:2048 sc1
    s_waitcnt lgkmcnt(14)
    v_mfma_f32_32x32x16_bf16 v[32:47], v[72:75], v[112:115], v[32:47]
    ds_read_b64_tr_b16 v[72:73], v194 offset:24576
    ds_read_b64_tr_b16 v[74:75], v194 offset:26624
    s_waitcnt lgkmcnt(14)
    v_mfma_f32_32x32x16_bf16 v[48:63], v[76:79], v[112:115], v[48:63]
    ds_read_b64_tr_b16 v[76:77], v195 offset:24576
    ds_read_b64_tr_b16 v[78:79], v195 offset:26624
    buffer_load_dwordx4 v[156:159], v255, s[8:11], s46 offen offset:3072 sc1
    s_waitcnt vmcnt(11)
    s_waitcnt lgkmcnt(14)
    v_mfma_f32_32x32x16_bf16 v[0:15], v[80:83], v[116:119], v[0:15]
    ds_read_b64_tr_b16 v[80:81], v192 offset:28672
    ds_read_b64_tr_b16 v[82:83], v192 offset:30720
    buffer_load_dwordx4 v[212:215], v230, s[8:11], s44 offen offset:16 sc1
    s_waitcnt lgkmcnt(14)
    v_mfma_f32_32x32x16_bf16 v[16:31], v[84:87], v[116:119], v[16:31]
    ds_read_b64_tr_b16 v[84:85], v193 offset:28672
    ds_read_b64_tr_b16 v[86:87], v193 offset:30720
    s_add_u32 s46, s45, 16384
    buffer_load_dwordx4 v[160:163], v255, s[8:11], s46 offen offset:0 sc1
    s_waitcnt lgkmcnt(14)
    v_mfma_f32_32x32x16_bf16 v[32:47], v[88:91], v[116:119], v[32:47]
    ds_read_b64_tr_b16 v[88:89], v194 offset:28672
    ds_read_b64_tr_b16 v[90:91], v194 offset:30720
    s_waitcnt lgkmcnt(14)
    v_mfma_f32_32x32x16_bf16 v[48:63], v[92:95], v[116:119], v[48:63]
    ds_read_b64_tr_b16 v[92:93], v195 offset:28672
    ds_read_b64_tr_b16 v[94:95], v195 offset:30720
    buffer_load_dwordx4 v[164:167], v255, s[8:11], s46 offen offset:1024 sc1
    s_waitcnt vmcnt(13)
    s_waitcnt lgkmcnt(14)
    v_mfma_f32_32x32x16_bf16 v[0:15], v[64:67], v[120:123], v[0:15]
    ds_read_b64_tr_b16 v[64:65], v192 offset:32768
    ds_read_b64_tr_b16 v[66:67], v192 offset:34816
    s_waitcnt lgkmcnt(14)
    v_mfma_f32_32x32x16_bf16 v[16:31], v[68:71], v[120:123], v[16:31]
    ds_read_b64_tr_b16 v[68:69], v193 offset:32768
    ds_read_b64_tr_b16 v[70:71], v193 offset:34816
    buffer_load_dwordx4 v[168:171], v255, s[8:11], s46 offen offset:2048 sc1
    s_waitcnt lgkmcnt(14)
    v_mfma_f32_32x32x16_bf16 v[32:47], v[72:75], v[120:123], v[32:47]
    ds_read_b64_tr_b16 v[72:73], v194 offset:32768
    ds_read_b64_tr_b16 v[74:75], v194 offset:34816
    s_waitcnt lgkmcnt(14)
    v_mfma_f32_32x32x16_bf16 v[48:63], v[76:79], v[120:123], v[48:63]
    ds_read_b64_tr_b16 v[76:77], v195 offset:32768
    ds_read_b64_tr_b16 v[78:79], v195 offset:34816
    buffer_load_dwordx4 v[172:175], v255, s[8:11], s46 offen offset:3072 sc1
    s_barrier
    s_waitcnt vmcnt(14)
    s_waitcnt lgkmcnt(14)
    v_mfma_f32_32x32x16_bf16 v[0:15], v[80:83], v[124:127], v[0:15]
    ds_read_b64_tr_b16 v[80:81], v192 offset:36864
    ds_read_b64_tr_b16 v[82:83], v192 offset:38912
    s_waitcnt lgkmcnt(14)
    v_mfma_f32_32x32x16_bf16 v[16:31], v[84:87], v[124:127], v[16:31]
    ds_read_b64_tr_b16 v[84:85], v193 offset:36864
    ds_read_b64_tr_b16 v[86:87], v193 offset:38912
    s_add_u32 s46, s45, 20480
    buffer_load_dwordx4 v[96:99], v255, s[8:11], s46 offen offset:0 sc1
    s_waitcnt lgkmcnt(14)
    v_mfma_f32_32x32x16_bf16 v[32:47], v[88:91], v[124:127], v[32:47]
    ds_read_b64_tr_b16 v[88:89], v194 offset:36864
    ds_read_b64_tr_b16 v[90:91], v194 offset:38912
    s_waitcnt lgkmcnt(14)
    v_mfma_f32_32x32x16_bf16 v[48:63], v[92:95], v[124:127], v[48:63]
    ds_read_b64_tr_b16 v[92:93], v195 offset:36864
    ds_read_b64_tr_b16 v[94:95], v195 offset:38912
    buffer_load_dwordx4 v[100:103], v255, s[8:11], s46 offen offset:1024 sc1
    s_waitcnt vmcnt(15)
    s_waitcnt lgkmcnt(14)
    v_mfma_f32_32x32x16_bf16 v[0:15], v[64:67], v[128:131], v[0:15]
    ds_read_b64_tr_b16 v[64:65], v192 offset:40960
    ds_read_b64_tr_b16 v[66:67], v192 offset:43008
    s_waitcnt lgkmcnt(14)
    v_mfma_f32_32x32x16_bf16 v[16:31], v[68:71], v[128:131], v[16:31]
    ds_read_b64_tr_b16 v[68:69], v193 offset:40960
    ds_read_b64_tr_b16 v[70:71], v193 offset:43008
    buffer_load_dwordx4 v[104:107], v255, s[8:11], s46 offen offset:2048 sc1
    s_waitcnt lgkmcnt(14)
    v_mfma_f32_32x32x16_bf16 v[32:47], v[72:75], v[128:131], v[32:47]
    ds_read_b64_tr_b16 v[72:73], v194 offset:40960
    ds_read_b64_tr_b16 v[74:75], v194 offset:43008
    s_waitcnt lgkmcnt(14)
    v_mfma_f32_32x32x16_bf16 v[48:63], v[76:79], v[128:131], v[48:63]
    ds_read_b64_tr_b16 v[76:77], v195 offset:40960
    ds_read_b64_tr_b16 v[78:79], v195 offset:43008
    buffer_load_dwordx4 v[108:111], v255, s[8:11], s46 offen offset:3072 sc1
    s_waitcnt vmcnt(16)
    s_waitcnt lgkmcnt(14)
    v_mfma_f32_32x32x16_bf16 v[0:15], v[80:83], v[132:135], v[0:15]
    ds_read_b64_tr_b16 v[80:81], v192 offset:45056
    ds_read_b64_tr_b16 v[82:83], v192 offset:47104
    s_waitcnt lgkmcnt(14)
    v_mfma_f32_32x32x16_bf16 v[16:31], v[84:87], v[132:135], v[16:31]
    ds_read_b64_tr_b16 v[84:85], v193 offset:45056
    ds_read_b64_tr_b16 v[86:87], v193 offset:47104
    s_add_u32 s46, s45, 24576
    buffer_load_dwordx4 v[112:115], v255, s[8:11], s46 offen offset:0 sc1
    s_waitcnt lgkmcnt(14)
    v_mfma_f32_32x32x16_bf16 v[32:47], v[88:91], v[132:135], v[32:47]
    ds_read_b64_tr_b16 v[88:89], v194 offset:45056
    ds_read_b64_tr_b16 v[90:91], v194 offset:47104
    s_waitcnt lgkmcnt(14)
    v_mfma_f32_32x32x16_bf16 v[48:63], v[92:95], v[132:135], v[48:63]
    ds_read_b64_tr_b16 v[92:93], v195 offset:45056
    ds_read_b64_tr_b16 v[94:95], v195 offset:47104
    buffer_load_dwordx4 v[116:119], v255, s[8:11], s46 offen offset:1024 sc1
    s_waitcnt vmcnt(17)
    s_waitcnt lgkmcnt(14)
    v_mfma_f32_32x32x16_bf16 v[0:15], v[64:67], v[136:139], v[0:15]
    ds_read_b64_tr_b16 v[64:65], v192 offset:49152
    ds_read_b64_tr_b16 v[66:67], v192 offset:51200
    s_waitcnt lgkmcnt(14)
    v_mfma_f32_32x32x16_bf16 v[16:31], v[68:71], v[136:139], v[16:31]
    ds_read_b64_tr_b16 v[68:69], v193 offset:49152
    ds_read_b64_tr_b16 v[70:71], v193 offset:51200
    buffer_load_dwordx4 v[120:123], v255, s[8:11], s46 offen offset:2048 sc1
    s_waitcnt lgkmcnt(14)
    v_mfma_f32_32x32x16_bf16 v[32:47], v[72:75], v[136:139], v[32:47]
    ds_read_b64_tr_b16 v[72:73], v194 offset:49152
    ds_read_b64_tr_b16 v[74:75], v194 offset:51200
    s_waitcnt lgkmcnt(14)
    v_mfma_f32_32x32x16_bf16 v[48:63], v[76:79], v[136:139], v[48:63]
    ds_read_b64_tr_b16 v[76:77], v195 offset:49152
    ds_read_b64_tr_b16 v[78:79], v195 offset:51200
    buffer_load_dwordx4 v[124:127], v255, s[8:11], s46 offen offset:3072 sc1
    s_waitcnt vmcnt(18)
    s_waitcnt lgkmcnt(14)
    v_mfma_f32_32x32x16_bf16 v[0:15], v[80:83], v[140:143], v[0:15]
    ds_read_b64_tr_b16 v[80:81], v192 offset:53248
    ds_read_b64_tr_b16 v[82:83], v192 offset:55296
    s_waitcnt vmcnt(12)
    v_add_f32 v208, v208, v210
    s_waitcnt lgkmcnt(14)
    v_mfma_f32_32x32x16_bf16 v[16:31], v[84:87], v[140:143], v[16:31]
    ds_read_b64_tr_b16 v[84:85], v193 offset:53248
    ds_read_b64_tr_b16 v[86:87], v193 offset:55296
    s_add_u32 s46, s45, 28672
    buffer_load_dwordx4 v[128:131], v255, s[8:11], s46 offen offset:0 sc1
    v_add_f32 v209, v209, v211
    v_add_f32 v208, v208, v212
    s_waitcnt lgkmcnt(14)
    v_mfma_f32_32x32x16_bf16 v[32:47], v[88:91], v[140:143], v[32:47]
    ds_read_b64_tr_b16 v[88:89], v194 offset:53248
    ds_read_b64_tr_b16 v[90:91], v194 offset:55296
    v_add_f32 v209, v209, v213
    v_add_f32 v208, v208, v214
    s_waitcnt lgkmcnt(14)
    v_mfma_f32_32x32x16_bf16 v[48:63], v[92:95], v[140:143], v[48:63]
    ds_read_b64_tr_b16 v[92:93], v195 offset:53248
    ds_read_b64_tr_b16 v[94:95], v195 offset:55296
    buffer_load_dwordx4 v[132:135], v255, s[8:11], s46 offen offset:1024 sc1
    s_waitcnt lgkmcnt(14)
    v_mfma_f32_32x32x16_bf16 v[0:15], v[64:67], v[144:147], v[0:15]
    ds_read_b64_tr_b16 v[64:65], v192 offset:57344
    ds_read_b64_tr_b16 v[66:67], v192 offset:59392
    v_add_f32 v209, v209, v215
    v_mov_b32 v210, v208
    s_waitcnt lgkmcnt(14)
    v_mfma_f32_32x32x16_bf16 v[16:31], v[68:71], v[144:147], v[16:31]
    ds_read_b64_tr_b16 v[68:69], v193 offset:57344
    ds_read_b64_tr_b16 v[70:71], v193 offset:59392
    buffer_load_dwordx4 v[136:139], v255, s[8:11], s46 offen offset:2048 sc1
    v_mov_b32 v211, v209
    s_nop 1
    s_waitcnt lgkmcnt(14)
    v_mfma_f32_32x32x16_bf16 v[32:47], v[72:75], v[144:147], v[32:47]
    ds_read_b64_tr_b16 v[72:73], v194 offset:57344
    ds_read_b64_tr_b16 v[74:75], v194 offset:59392
    v_permlane32_swap_b32 v208, v210
    v_permlane32_swap_b32 v209, v211
    s_waitcnt lgkmcnt(14)
    v_mfma_f32_32x32x16_bf16 v[48:63], v[76:79], v[144:147], v[48:63]
    ds_read_b64_tr_b16 v[76:77], v195 offset:57344
    ds_read_b64_tr_b16 v[78:79], v195 offset:59392
    buffer_load_dwordx4 v[140:143], v255, s[8:11], s46 offen offset:3072 sc1
    s_waitcnt lgkmcnt(14)
    v_mfma_f32_32x32x16_bf16 v[0:15], v[80:83], v[148:151], v[0:15]
    ds_read_b64_tr_b16 v[80:81], v192 offset:61440
    ds_read_b64_tr_b16 v[82:83], v192 offset:63488
    s_nop 0
    v_add_f32 v208, v208, v210
    s_waitcnt lgkmcnt(14)
    v_mfma_f32_32x32x16_bf16 v[16:31], v[84:87], v[148:151], v[16:31]
    ds_read_b64_tr_b16 v[84:85], v193 offset:61440
    ds_read_b64_tr_b16 v[86:87], v193 offset:63488
    s_add_u32 s46, s45, 32768
    buffer_load_dwordx4 v[144:147], v255, s[8:11], s46 offen offset:0 sc1
    v_add_f32 v209, v209, v211
    v_mul_f32 v224, 0x3acccccd, v208
    s_waitcnt lgkmcnt(14)
    v_mfma_f32_32x32x16_bf16 v[32:47], v[88:91], v[148:151], v[32:47]
    ds_read_b64_tr_b16 v[88:89], v194 offset:61440
    ds_read_b64_tr_b16 v[90:91], v194 offset:63488
    v_mul_f32 v225, 0x3acccccd, v209
    v_fma_f32 v225, -v224, v224, v225
    s_waitcnt lgkmcnt(14)
    v_mfma_f32_32x32x16_bf16 v[48:63], v[92:95], v[148:151], v[48:63]
    ds_read_b64_tr_b16 v[92:93], v195 offset:61440
    ds_read_b64_tr_b16 v[94:95], v195 offset:63488
    s_waitcnt lgkmcnt(14)
    v_mfma_f32_32x32x16_bf16 v[0:15], v[64:67], v[152:155], v[0:15]
    v_add_u32 v192, 0x10000, v192
    ds_read_b64_tr_b16 v[64:65], v192 offset:0
    ds_read_b64_tr_b16 v[66:67], v192 offset:2048
    v_max_f32 v225, 0, v225
    v_cvt_pk_bf16_f32 v225, v225, v225
    s_waitcnt lgkmcnt(14)
    v_mfma_f32_32x32x16_bf16 v[16:31], v[68:71], v[152:155], v[16:31]
    v_add_u32 v193, 0x10000, v193
    ds_read_b64_tr_b16 v[68:69], v193 offset:0
    ds_read_b64_tr_b16 v[70:71], v193 offset:2048
    buffer_load_dwordx4 v[148:151], v255, s[8:11], s46 offen offset:1024 sc1
    v_and_b32 v225, s31, v225
    v_add_f32 v225, 0x3727c5ac, v225
    s_waitcnt lgkmcnt(14)
    v_mfma_f32_32x32x16_bf16 v[32:47], v[72:75], v[152:155], v[32:47]
    v_add_u32 v194, 0x10000, v194
    ds_read_b64_tr_b16 v[72:73], v194 offset:0
    ds_read_b64_tr_b16 v[74:75], v194 offset:2048
    v_cvt_pk_bf16_f32 v225, v225, v225
    v_and_b32 v225, s31, v225
    s_waitcnt lgkmcnt(14)
    v_mfma_f32_32x32x16_bf16 v[48:63], v[76:79], v[152:155], v[48:63]
    v_add_u32 v195, 0x10000, v195
    ds_read_b64_tr_b16 v[76:77], v195 offset:0
    ds_read_b64_tr_b16 v[78:79], v195 offset:2048
    s_waitcnt lgkmcnt(14)
    v_mfma_f32_32x32x16_bf16 v[0:15], v[80:83], v[156:159], v[0:15]
    ds_read_b64_tr_b16 v[80:81], v192 offset:4096
    ds_read_b64_tr_b16 v[82:83], v192 offset:6144
    v_sqrt_f32 v225, v225
    v_sub_f32 v224, 0, v224
    s_waitcnt lgkmcnt(14)
    v_mfma_f32_32x32x16_bf16 v[16:31], v[84:87], v[156:159], v[16:31]
    ds_read_b64_tr_b16 v[84:85], v193 offset:4096
    ds_read_b64_tr_b16 v[86:87], v193 offset:6144
    buffer_load_dwordx4 v[152:155], v255, s[8:11], s46 offen offset:2048 sc1
    v_cvt_pk_bf16_f32 v225, v225, v225
    v_and_b32 v225, s31, v225
    s_waitcnt lgkmcnt(14)
    v_mfma_f32_32x32x16_bf16 v[32:47], v[88:91], v[156:159], v[32:47]
    ds_read_b64_tr_b16 v[88:89], v194 offset:4096
    ds_read_b64_tr_b16 v[90:91], v194 offset:6144
    v_rcp_f32 v198, v225
    v_cvt_pk_bf16_f32 v196, v224, v224
    s_waitcnt lgkmcnt(14)
    v_mfma_f32_32x32x16_bf16 v[48:63], v[92:95], v[156:159], v[48:63]
    ds_read_b64_tr_b16 v[92:93], v195 offset:4096
    ds_read_b64_tr_b16 v[94:95], v195 offset:6144
    s_waitcnt vmcnt(18)
    s_waitcnt lgkmcnt(14)
    v_mfma_f32_32x32x16_bf16 v[0:15], v[64:67], v[160:163], v[0:15]
    ds_read_b64_tr_b16 v[64:65], v192 offset:8192
    ds_read_b64_tr_b16 v[66:67], v192 offset:10240
    v_mov_b32 v226, 0
    v_and_b32 v197, 0xffff, v196
    s_waitcnt lgkmcnt(14)
    v_mfma_f32_32x32x16_bf16 v[16:31], v[68:71], v[160:163], v[16:31]
    ds_read_b64_tr_b16 v[68:69], v193 offset:8192
    ds_read_b64_tr_b16 v[70:71], v193 offset:10240
    buffer_load_dwordx4 v[156:159], v255, s[8:11], s46 offen offset:3072 sc1
    v_cndmask_b32 v196, v226, v196, s[28:29]
    v_cndmask_b32 v197, v226, v197, s[28:29]
    s_waitcnt lgkmcnt(14)
    v_mfma_f32_32x32x16_bf16 v[32:47], v[72:75], v[160:163], v[32:47]
    ds_read_b64_tr_b16 v[72:73], v194 offset:8192
    ds_read_b64_tr_b16 v[74:75], v194 offset:10240
    v_mul_f32 v198, s52, v198
    s_nop 0
    s_waitcnt lgkmcnt(14)
    v_mfma_f32_32x32x16_bf16 v[48:63], v[76:79], v[160:163], v[48:63]
    ds_read_b64_tr_b16 v[76:77], v195 offset:8192
    ds_read_b64_tr_b16 v[78:79], v195 offset:10240
    s_waitcnt vmcnt(18)
    s_waitcnt lgkmcnt(14)
    v_mfma_f32_32x32x16_bf16 v[0:15], v[80:83], v[164:167], v[0:15]
    ds_read_b64_tr_b16 v[80:81], v192 offset:12288
    ds_read_b64_tr_b16 v[82:83], v192 offset:14336
    v_mov_b32 v199, v198
    v_cndmask_b32 v200, v176, v184, s[54:55]
    s_waitcnt lgkmcnt(14)
    v_mfma_f32_32x32x16_bf16 v[16:31], v[84:87], v[164:167], v[16:31]
    ds_read_b64_tr_b16 v[84:85], v193 offset:12288
    ds_read_b64_tr_b16 v[86:87], v193 offset:14336
    s_add_u32 s46, s45, 36864
    buffer_load_dwordx4 v[160:163], v255, s[8:11], s46 offen offset:0 sc1
    v_cndmask_b32 v201, v177, v185, s[54:55]
    v_cndmask_b32 v202, v178, v186, s[54:55]
    s_waitcnt lgkmcnt(14)
    v_mfma_f32_32x32x16_bf16 v[32:47], v[88:91], v[164:167], v[32:47]
    ds_read_b64_tr_b16 v[88:89], v194 offset:12288
    ds_read_b64_tr_b16 v[90:91], v194 offset:14336
    v_cndmask_b32 v203, v179, v187, s[54:55]
    v_cndmask_b32 v204, v180, v188, s[54:55]
    s_waitcnt lgkmcnt(14)
    v_mfma_f32_32x32x16_bf16 v[48:63], v[92:95], v[164:167], v[48:63]
    ds_read_b64_tr_b16 v[92:93], v195 offset:12288
    ds_read_b64_tr_b16 v[94:95], v195 offset:14336
    s_waitcnt vmcnt(18)
    s_waitcnt lgkmcnt(14)
    v_mfma_f32_32x32x16_bf16 v[0:15], v[64:67], v[168:171], v[0:15]
    ds_read_b64_tr_b16 v[64:65], v192 offset:16384
    ds_read_b64_tr_b16 v[66:67], v192 offset:18432
    v_cndmask_b32 v205, v181, v189, s[54:55]
    v_cndmask_b32 v206, v182, v190, s[54:55]
    s_waitcnt lgkmcnt(14)
    v_mfma_f32_32x32x16_bf16 v[16:31], v[68:71], v[168:171], v[16:31]
    ds_read_b64_tr_b16 v[68:69], v193 offset:16384
    ds_read_b64_tr_b16 v[70:71], v193 offset:18432
    buffer_load_dwordx4 v[164:167], v255, s[8:11], s46 offen offset:1024 sc1
    v_cndmask_b32 v207, v183, v191, s[54:55]
    s_waitcnt lgkmcnt(14)
    v_mfma_f32_32x32x16_bf16 v[32:47], v[72:75], v[168:171], v[32:47]
    ds_read_b64_tr_b16 v[72:73], v194 offset:16384
    ds_read_b64_tr_b16 v[74:75], v194 offset:18432
    s_waitcnt lgkmcnt(14)
    v_mfma_f32_32x32x16_bf16 v[48:63], v[76:79], v[168:171], v[48:63]
    ds_read_b64_tr_b16 v[76:77], v195 offset:16384
    ds_read_b64_tr_b16 v[78:79], v195 offset:18432
    s_waitcnt vmcnt(18)
    s_waitcnt lgkmcnt(14)
    v_mfma_f32_32x32x16_bf16 v[0:15], v[80:83], v[172:175], v[0:15]
    ds_read_b64_tr_b16 v[80:81], v192 offset:20480
    ds_read_b64_tr_b16 v[82:83], v192 offset:22528
    s_waitcnt lgkmcnt(14)
    v_mfma_f32_32x32x16_bf16 v[16:31], v[84:87], v[172:175], v[16:31]
    ds_read_b64_tr_b16 v[84:85], v193 offset:20480
    ds_read_b64_tr_b16 v[86:87], v193 offset:22528
    buffer_load_dwordx4 v[168:171], v255, s[8:11], s46 offen offset:2048 sc1
    s_waitcnt lgkmcnt(14)
    v_mfma_f32_32x32x16_bf16 v[32:47], v[88:91], v[172:175], v[32:47]
    ds_read_b64_tr_b16 v[88:89], v194 offset:20480
    ds_read_b64_tr_b16 v[90:91], v194 offset:22528
    s_waitcnt lgkmcnt(14)
    v_mfma_f32_32x32x16_bf16 v[48:63], v[92:95], v[172:175], v[48:63]
    ds_read_b64_tr_b16 v[92:93], v195 offset:20480
    ds_read_b64_tr_b16 v[94:95], v195 offset:22528
    s_waitcnt vmcnt(18)
    s_waitcnt lgkmcnt(14)
    v_mfma_f32_32x32x16_bf16 v[0:15], v[64:67], v[96:99], v[0:15]
    ds_read_b64_tr_b16 v[64:65], v192 offset:24576
    ds_read_b64_tr_b16 v[66:67], v192 offset:26624
    s_waitcnt lgkmcnt(14)
    v_mfma_f32_32x32x16_bf16 v[16:31], v[68:71], v[96:99], v[16:31]
    ds_read_b64_tr_b16 v[68:69], v193 offset:24576
    ds_read_b64_tr_b16 v[70:71], v193 offset:26624
    buffer_load_dwordx4 v[172:175], v255, s[8:11], s46 offen offset:3072 sc1
    s_waitcnt lgkmcnt(14)
    v_mfma_f32_32x32x16_bf16 v[32:47], v[72:75], v[96:99], v[32:47]
    ds_read_b64_tr_b16 v[72:73], v194 offset:24576
    ds_read_b64_tr_b16 v[74:75], v194 offset:26624
    s_waitcnt lgkmcnt(14)
    v_mfma_f32_32x32x16_bf16 v[48:63], v[76:79], v[96:99], v[48:63]
    ds_read_b64_tr_b16 v[76:77], v195 offset:24576
    ds_read_b64_tr_b16 v[78:79], v195 offset:26624
    s_bitcmp0_b32 s16, 0
    s_cbranch_scc1 L_go_20
    s_barrier
L_go_20:
    s_waitcnt vmcnt(18)
    s_waitcnt lgkmcnt(14)
    v_mfma_f32_32x32x16_bf16 v[0:15], v[80:83], v[100:103], v[0:15]
    ds_read_b64_tr_b16 v[80:81], v192 offset:28672
    ds_read_b64_tr_b16 v[82:83], v192 offset:30720
    s_waitcnt lgkmcnt(14)
    v_mfma_f32_32x32x16_bf16 v[16:31], v[84:87], v[100:103], v[16:31]
    ds_read_b64_tr_b16 v[84:85], v193 offset:28672
    ds_read_b64_tr_b16 v[86:87], v193 offset:30720
    s_waitcnt lgkmcnt(14)
    v_mfma_f32_32x32x16_bf16 v[32:47], v[88:91], v[100:103], v[32:47]
    ds_read_b64_tr_b16 v[88:89], v194 offset:28672
    ds_read_b64_tr_b16 v[90:91], v194 offset:30720
    s_waitcnt lgkmcnt(14)
    v_mfma_f32_32x32x16_bf16 v[48:63], v[92:95], v[100:103], v[48:63]
    ds_read_b64_tr_b16 v[92:93], v195 offset:28672
    ds_read_b64_tr_b16 v[94:95], v195 offset:30720
    s_waitcnt vmcnt(17)
    s_waitcnt lgkmcnt(14)
    v_mfma_f32_32x32x16_bf16 v[0:15], v[64:67], v[104:107], v[0:15]
    ds_read_b64_tr_b16 v[64:65], v192 offset:32768
    ds_read_b64_tr_b16 v[66:67], v192 offset:34816
    s_waitcnt lgkmcnt(14)
    v_mfma_f32_32x32x16_bf16 v[16:31], v[68:71], v[104:107], v[16:31]
    ds_read_b64_tr_b16 v[68:69], v193 offset:32768
    ds_read_b64_tr_b16 v[70:71], v193 offset:34816
    s_waitcnt lgkmcnt(14)
    v_mfma_f32_32x32x16_bf16 v[32:47], v[72:75], v[104:107], v[32:47]
    ds_read_b64_tr_b16 v[72:73], v194 offset:32768
    ds_read_b64_tr_b16 v[74:75], v194 offset:34816
    s_waitcnt lgkmcnt(14)
    v_mfma_f32_32x32x16_bf16 v[48:63], v[76:79], v[104:107], v[48:63]
    ds_read_b64_tr_b16 v[76:77], v195 offset:32768
    ds_read_b64_tr_b16 v[78:79], v195 offset:34816
    s_waitcnt vmcnt(16)
    s_waitcnt lgkmcnt(14)
    v_mfma_f32_32x32x16_bf16 v[0:15], v[80:83], v[108:111], v[0:15]
    ds_read_b64_tr_b16 v[80:81], v192 offset:36864
    ds_read_b64_tr_b16 v[82:83], v192 offset:38912
    s_waitcnt lgkmcnt(14)
    v_mfma_f32_32x32x16_bf16 v[16:31], v[84:87], v[108:111], v[16:31]
    ds_read_b64_tr_b16 v[84:85], v193 offset:36864
    ds_read_b64_tr_b16 v[86:87], v193 offset:38912
    s_waitcnt lgkmcnt(14)
    v_mfma_f32_32x32x16_bf16 v[32:47], v[88:91], v[108:111], v[32:47]
    ds_read_b64_tr_b16 v[88:89], v194 offset:36864
    ds_read_b64_tr_b16 v[90:91], v194 offset:38912
    s_waitcnt lgkmcnt(14)
    v_mfma_f32_32x32x16_bf16 v[48:63], v[92:95], v[108:111], v[48:63]
    ds_read_b64_tr_b16 v[92:93], v195 offset:36864
    ds_read_b64_tr_b16 v[94:95], v195 offset:38912
    s_waitcnt vmcnt(15)
    s_waitcnt lgkmcnt(14)
    v_mfma_f32_32x32x16_bf16 v[0:15], v[64:67], v[112:115], v[0:15]
    ds_read_b64_tr_b16 v[64:65], v192 offset:40960
    ds_read_b64_tr_b16 v[66:67], v192 offset:43008
    s_waitcnt lgkmcnt(14)
    v_mfma_f32_32x32x16_bf16 v[16:31], v[68:71], v[112:115], v[16:31]
    ds_read_b64_tr_b16 v[68:69], v193 offset:40960
    ds_read_b64_tr_b16 v[70:71], v193 offset:43008
    s_waitcnt lgkmcnt(14)
    v_mfma_f32_32x32x16_bf16 v[32:47], v[72:75], v[112:115], v[32:47]
    ds_read_b64_tr_b16 v[72:73], v194 offset:40960
    ds_read_b64_tr_b16 v[74:75], v194 offset:43008
    s_waitcnt lgkmcnt(14)
    v_mfma_f32_32x32x16_bf16 v[48:63], v[76:79], v[112:115], v[48:63]
    ds_read_b64_tr_b16 v[76:77], v195 offset:40960
    ds_read_b64_tr_b16 v[78:79], v195 offset:43008
    s_waitcnt vmcnt(14)
    s_waitcnt lgkmcnt(14)
    v_mfma_f32_32x32x16_bf16 v[0:15], v[80:83], v[116:119], v[0:15]
    ds_read_b64_tr_b16 v[80:81], v192 offset:45056
    ds_read_b64_tr_b16 v[82:83], v192 offset:47104
    s_waitcnt lgkmcnt(14)
    v_mfma_f32_32x32x16_bf16 v[16:31], v[84:87], v[116:119], v[16:31]
    ds_read_b64_tr_b16 v[84:85], v193 offset:45056
    ds_read_b64_tr_b16 v[86:87], v193 offset:47104
    s_waitcnt lgkmcnt(14)
    v_mfma_f32_32x32x16_bf16 v[32:47], v[88:91], v[116:119], v[32:47]
    ds_read_b64_tr_b16 v[88:89], v194 offset:45056
    ds_read_b64_tr_b16 v[90:91], v194 offset:47104
    s_waitcnt lgkmcnt(14)
    v_mfma_f32_32x32x16_bf16 v[48:63], v[92:95], v[116:119], v[48:63]
    ds_read_b64_tr_b16 v[92:93], v195 offset:45056
    ds_read_b64_tr_b16 v[94:95], v195 offset:47104
    s_waitcnt vmcnt(13)
    s_waitcnt lgkmcnt(14)
    v_mfma_f32_32x32x16_bf16 v[0:15], v[64:67], v[120:123], v[0:15]
    ds_read_b64_tr_b16 v[64:65], v192 offset:49152
    ds_read_b64_tr_b16 v[66:67], v192 offset:51200
    s_waitcnt lgkmcnt(14)
    v_mfma_f32_32x32x16_bf16 v[16:31], v[68:71], v[120:123], v[16:31]
    ds_read_b64_tr_b16 v[68:69], v192 offset:53248
    ds_read_b64_tr_b16 v[70:71], v192 offset:55296
    s_waitcnt lgkmcnt(14)
    v_mfma_f32_32x32x16_bf16 v[32:47], v[72:75], v[120:123], v[32:47]
    ds_read_b64_tr_b16 v[72:73], v192 offset:57344
    ds_read_b64_tr_b16 v[74:75], v192 offset:59392
    s_waitcnt lgkmcnt(14)
    v_mfma_f32_32x32x16_bf16 v[48:63], v[76:79], v[120:123], v[48:63]
    ds_read_b64_tr_b16 v[76:77], v192 offset:61440
    ds_read_b64_tr_b16 v[78:79], v192 offset:63488
    s_waitcnt vmcnt(12)
    s_waitcnt lgkmcnt(14)
    v_mfma_f32_32x32x16_bf16 v[0:15], v[80:83], v[124:127], v[0:15]
    v_add_u32 v192, 0x10000, v192
    ds_read_b64_tr_b16 v[80:81], v192 offset:0
    ds_read_b64_tr_b16 v[82:83], v192 offset:2048
    s_waitcnt lgkmcnt(14)
    v_mfma_f32_32x32x16_bf16 v[16:31], v[84:87], v[124:127], v[16:31]
    ds_read_b64_tr_b16 v[84:85], v192 offset:4096
    ds_read_b64_tr_b16 v[86:87], v192 offset:6144
    s_waitcnt lgkmcnt(14)
    v_mfma_f32_32x32x16_bf16 v[32:47], v[88:91], v[124:127], v[32:47]
    ds_read_b64_tr_b16 v[88:89], v192 offset:8192
    ds_read_b64_tr_b16 v[90:91], v192 offset:10240
    s_waitcnt lgkmcnt(14)
    v_mfma_f32_32x32x16_bf16 v[48:63], v[92:95], v[124:127], v[48:63]
    ds_read_b64_tr_b16 v[92:93], v192 offset:12288
    ds_read_b64_tr_b16 v[94:95], v192 offset:14336
    s_cmp_lg_u32 s16, 0
    s_cbranch_scc1 L_qkv_st_21
    v_lshrrev_b32 v224, 1, v255
    s_lshl_b32 s59, s12, 9
    v_add_u32 v225, s59, v224
    s_barrier
    ds_read_b64 v[176:177], v224 offset:0
    ds_read_b64 v[178:179], v224 offset:512
    ds_read_b64 v[180:181], v224 offset:1024
    ds_read_b64 v[182:183], v224 offset:1536
    ds_read_b64 v[184:185], v224 offset:2048
    ds_read_b64 v[186:187], v224 offset:2560
    ds_read_b64 v[188:189], v224 offset:3072
    ds_read_b64 v[190:191], v224 offset:3584
    s_waitcnt lgkmcnt(0)
    v_mov_b32 v200, v176
    v_mov_b32 v201, v177
    v_mov_b32 v202, v178
    v_mov_b32 v203, v179
    v_mov_b32 v204, v180
    v_mov_b32 v205, v181
    v_mov_b32 v206, v182
    v_mov_b32 v207, v183
    s_nop 1
L_qkv_st_21:
    s_mov_b32 s56, s8
    s_mov_b32 s57, s9
    s_cmp_ge_u32 s40, 5
    s_cselect_b32 s58, s10, 0
    s_mov_b32 s59, 0x00020000
    s_waitcnt vmcnt(11)
    s_waitcnt lgkmcnt(14)
    v_mfma_f32_32x32x16_bf16 v[0:15], v[64:67], v[128:131], v[0:15]
    ds_read_b64_tr_b16 v[64:65], v192 offset:16384
    ds_read_b64_tr_b16 v[66:67], v192 offset:18432
    s_waitcnt vmcnt(10)
    s_waitcnt lgkmcnt(14)
    v_mfma_f32_32x32x16_bf16 v[0:15], v[68:71], v[132:135], v[0:15]
    ds_read_b64_tr_b16 v[68:69], v192 offset:20480
    ds_read_b64_tr_b16 v[70:71], v192 offset:22528
    s_waitcnt vmcnt(9)
    s_waitcnt lgkmcnt(14)
    v_mfma_f32_32x32x16_bf16 v[0:15], v[72:75], v[136:139], v[0:15]
    ds_read_b64_tr_b16 v[72:73], v192 offset:24576
    ds_read_b64_tr_b16 v[74:75], v192 offset:26624
    s_waitcnt vmcnt(8)
    s_waitcnt lgkmcnt(14)
    v_mfma_f32_32x32x16_bf16 v[0:15], v[76:79], v[140:143], v[0:15]
    ds_read_b64_tr_b16 v[76:77], v192 offset:28672
    ds_read_b64_tr_b16 v[78:79], v192 offset:30720
    s_waitcnt vmcnt(7)
    s_waitcnt lgkmcnt(14)
    v_mfma_f32_32x32x16_bf16 v[0:15], v[80:83], v[144:147], v[0:15]
    ds_read_b64_tr_b16 v[80:81], v193 offset:49152
    ds_read_b64_tr_b16 v[82:83], v193 offset:51200
    s_waitcnt vmcnt(6)
    s_waitcnt lgkmcnt(14)
    v_mfma_f32_32x32x16_bf16 v[0:15], v[84:87], v[148:151], v[0:15]
    ds_read_b64_tr_b16 v[84:85], v193 offset:53248
    ds_read_b64_tr_b16 v[86:87], v193 offset:55296
    s_waitcnt vmcnt(5)
    s_waitcnt lgkmcnt(14)
    v_mfma_f32_32x32x16_bf16 v[0:15], v[88:91], v[152:155], v[0:15]
    ds_read_b64_tr_b16 v[88:89], v193 offset:57344
    ds_read_b64_tr_b16 v[90:91], v193 offset:59392
    s_waitcnt vmcnt(4)
    s_waitcnt lgkmcnt(14)
    v_mfma_f32_32x32x16_bf16 v[0:15], v[92:95], v[156:159], v[0:15]
    ds_read_b64_tr_b16 v[92:93], v193 offset:61440
    ds_read_b64_tr_b16 v[94:95], v193 offset:63488
    s_waitcnt vmcnt(3)
    s_waitcnt lgkmcnt(14)
    v_mfma_f32_32x32x16_bf16 v[0:15], v[64:67], v[160:163], v[0:15]
    v_add_u32 v193, 0x10000, v193
    ds_read_b64_tr_b16 v[64:65], v193 offset:0
    ds_read_b64_tr_b16 v[66:67], v193 offset:2048
    s_waitcnt vmcnt(2)
    s_waitcnt lgkmcnt(14)
    v_mfma_f32_32x32x16_bf16 v[0:15], v[68:71], v[164:167], v[0:15]
    ds_read_b64_tr_b16 v[68:69], v193 offset:4096
    ds_read_b64_tr_b16 v[70:71], v193 offset:6144
    s_waitcnt vmcnt(1)
    s_waitcnt lgkmcnt(14)
    v_mfma_f32_32x32x16_bf16 v[0:15], v[72:75], v[168:171], v[0:15]
    ds_read_b64_tr_b16 v[72:73], v193 offset:8192
    ds_read_b64_tr_b16 v[74:75], v193 offset:10240
    s_waitcnt vmcnt(0)
    s_waitcnt lgkmcnt(14)
    v_mfma_f32_32x32x16_bf16 v[0:15], v[76:79], v[172:175], v[0:15]
    ds_read_b64_tr_b16 v[76:77], v193 offset:12288
    ds_read_b64_tr_b16 v[78:79], v193 offset:14336
    v_mfma_f32_32x32x8_bf16 v[0:15], v[200:201], v[196:197], v[0:15]
    s_waitcnt lgkmcnt(14)
    v_mfma_f32_32x32x16_bf16 v[16:31], v[80:83], v[128:131], v[16:31]
    ds_read_b64_tr_b16 v[80:81], v193 offset:16384
    ds_read_b64_tr_b16 v[82:83], v193 offset:18432
    s_waitcnt lgkmcnt(14)
    v_mfma_f32_32x32x16_bf16 v[16:31], v[84:87], v[132:135], v[16:31]
    ds_read_b64_tr_b16 v[84:85], v193 offset:20480
    ds_read_b64_tr_b16 v[86:87], v193 offset:22528
    s_waitcnt lgkmcnt(14)
    v_mfma_f32_32x32x16_bf16 v[16:31], v[88:91], v[136:139], v[16:31]
    ds_read_b64_tr_b16 v[88:89], v193 offset:24576
    ds_read_b64_tr_b16 v[90:91], v193 offset:26624
    v_mul_f32 v0, v0, v198
    v_mul_f32 v1, v1, v198
    v_mul_f32 v2, v2, v198
    s_waitcnt lgkmcnt(14)
    v_mfma_f32_32x32x16_bf16 v[16:31], v[92:95], v[140:143], v[16:31]
    ds_read_b64_tr_b16 v[92:93], v193 offset:28672
    ds_read_b64_tr_b16 v[94:95], v193 offset:30720
    v_mul_f32 v3, v3, v198
    v_mul_f32 v4, v4, v198
    v_mul_f32 v5, v5, v198
    s_waitcnt lgkmcnt(14)
    v_mfma_f32_32x32x16_bf16 v[16:31], v[64:67], v[144:147], v[16:31]
    ds_read_b64_tr_b16 v[64:65], v194 offset:49152
    ds_read_b64_tr_b16 v[66:67], v194 offset:51200
    v_mul_f32 v6, v6, v198
    v_mul_f32 v7, v7, v198
    v_cvt_pk_bf16_f32 v0, v0, v1
    s_waitcnt lgkmcnt(14)
    v_mfma_f32_32x32x16_bf16 v[16:31], v[68:71], v[148:151], v[16:31]
    ds_read_b64_tr_b16 v[68:69], v194 offset:53248
    ds_read_b64_tr_b16 v[70:71], v194 offset:55296
    v_cvt_pk_bf16_f32 v1, v2, v3
    v_cvt_pk_bf16_f32 v2, v4, v5
    v_cvt_pk_bf16_f32 v3, v6, v7
    s_waitcnt lgkmcnt(14)
    v_mfma_f32_32x32x16_bf16 v[16:31], v[72:75], v[152:155], v[16:31]
    ds_read_b64_tr_b16 v[72:73], v194 offset:57344
    ds_read_b64_tr_b16 v[74:75], v194 offset:59392
    v_mul_f32 v8, v8, v198
    v_mul_f32 v9, v9, v198
    v_mul_f32 v10, v10, v198
    s_waitcnt lgkmcnt(14)
    v_mfma_f32_32x32x16_bf16 v[16:31], v[76:79], v[156:159], v[16:31]
    ds_read_b64_tr_b16 v[76:77], v194 offset:61440
    ds_read_b64_tr_b16 v[78:79], v194 offset:63488
    v_mul_f32 v11, v11, v198
    v_mul_f32 v12, v12, v198
    v_mul_f32 v13, v13, v198
    s_waitcnt lgkmcnt(14)
    v_mfma_f32_32x32x16_bf16 v[16:31], v[80:83], v[160:163], v[16:31]
    v_add_u32 v194, 0x10000, v194
    ds_read_b64_tr_b16 v[80:81], v194 offset:0
    ds_read_b64_tr_b16 v[82:83], v194 offset:2048
    v_mul_f32 v14, v14, v198
    v_mul_f32 v15, v15, v198
    v_cvt_pk_bf16_f32 v8, v8, v9
    s_waitcnt lgkmcnt(14)
    v_mfma_f32_32x32x16_bf16 v[16:31], v[84:87], v[164:167], v[16:31]
    ds_read_b64_tr_b16 v[84:85], v194 offset:4096
    ds_read_b64_tr_b16 v[86:87], v194 offset:6144
    v_cvt_pk_bf16_f32 v9, v10, v11
    v_cvt_pk_bf16_f32 v10, v12, v13
    v_cvt_pk_bf16_f32 v11, v14, v15
    s_waitcnt lgkmcnt(14)
    v_mfma_f32_32x32x16_bf16 v[16:31], v[88:91], v[168:171], v[16:31]
    ds_read_b64_tr_b16 v[88:89], v194 offset:8192
    ds_read_b64_tr_b16 v[90:91], v194 offset:10240
    v_permlane32_swap_b32 v0, v2
    v_permlane32_swap_b32 v1, v3
    v_permlane32_swap_b32 v8, v10
    s_waitcnt lgkmcnt(14)
    v_mfma_f32_32x32x16_bf16 v[16:31], v[92:95], v[172:175], v[16:31]
    ds_read_b64_tr_b16 v[92:93], v194 offset:12288
    ds_read_b64_tr_b16 v[94:95], v194 offset:14336
    v_permlane32_swap_b32 v9, v11
    buffer_store_dwordx4 v[0:3], v255, s[56:59], s49 offen offset:0 sc1
    buffer_store_dwordx4 v[8:11], v255, s[56:59], s49 offen offset:1024 sc1
    v_mfma_f32_32x32x8_bf16 v[16:31], v[202:203], v[196:197], v[16:31]
    buffer_store_dwordx4 v[0:3], v255, s[8:11], s47 offen offset:0
    buffer_store_dwordx4 v[8:11], v255, s[8:11], s47 offen offset:1024
    s_waitcnt lgkmcnt(14)
    v_mfma_f32_32x32x16_bf16 v[32:47], v[64:67], v[128:131], v[32:47]
    ds_read_b64_tr_b16 v[64:65], v194 offset:16384
    ds_read_b64_tr_b16 v[66:67], v194 offset:18432
    s_waitcnt lgkmcnt(14)
    v_mfma_f32_32x32x16_bf16 v[32:47], v[68:71], v[132:135], v[32:47]
    ds_read_b64_tr_b16 v[68:69], v194 offset:20480
    ds_read_b64_tr_b16 v[70:71], v194 offset:22528
    s_waitcnt lgkmcnt(14)
    v_mfma_f32_32x32x16_bf16 v[32:47], v[72:75], v[136:139], v[32:47]
    ds_read_b64_tr_b16 v[72:73], v194 offset:24576
    ds_read_b64_tr_b16 v[74:75], v194 offset:26624
    v_mul_f32 v16, v16, v198
    v_mul_f32 v17, v17, v198
    v_mul_f32 v18, v18, v198
    s_waitcnt lgkmcnt(14)
    v_mfma_f32_32x32x16_bf16 v[32:47], v[76:79], v[140:143], v[32:47]
    ds_read_b64_tr_b16 v[76:77], v194 offset:28672
    ds_read_b64_tr_b16 v[78:79], v194 offset:30720
    v_mul_f32 v19, v19, v198
    v_mul_f32 v20, v20, v198
    v_mul_f32 v21, v21, v198
    s_waitcnt lgkmcnt(14)
    v_mfma_f32_32x32x16_bf16 v[32:47], v[80:83], v[144:147], v[32:47]
    ds_read_b64_tr_b16 v[80:81], v195 offset:49152
    ds_read_b64_tr_b16 v[82:83], v195 offset:51200
    v_mul_f32 v22, v22, v198
    v_mul_f32 v23, v23, v198
    v_cvt_pk_bf16_f32 v16, v16, v17
    s_waitcnt lgkmcnt(14)
    v_mfma_f32_32x32x16_bf16 v[32:47], v[84:87], v[148:151], v[32:47]
    ds_read_b64_tr_b16 v[84:85], v195 offset:53248
    ds_read_b64_tr_b16 v[86:87], v195 offset:55296
    v_cvt_pk_bf16_f32 v17, v18, v19
    v_cvt_pk_bf16_f32 v18, v20, v21
    v_cvt_pk_bf16_f32 v19, v22, v23
    s_waitcnt lgkmcnt(14)
    v_mfma_f32_32x32x16_bf16 v[32:47], v[88:91], v[152:155], v[32:47]
    ds_read_b64_tr_b16 v[88:89], v195 offset:57344
    ds_read_b64_tr_b16 v[90:91], v195 offset:59392
    v_mul_f32 v24, v24, v198
    v_mul_f32 v25, v25, v198
    v_mul_f32 v26, v26, v198
    s_waitcnt lgkmcnt(14)
    v_mfma_f32_32x32x16_bf16 v[32:47], v[92:95], v[156:159], v[32:47]
    ds_read_b64_tr_b16 v[92:93], v195 offset:61440
    ds_read_b64_tr_b16 v[94:95], v195 offset:63488
    v_mul_f32 v27, v27, v198
    v_mul_f32 v28, v28, v198
    v_mul_f32 v29, v29, v198
    s_waitcnt lgkmcnt(14)
    v_mfma_f32_32x32x16_bf16 v[32:47], v[64:67], v[160:163], v[32:47]
    v_add_u32 v195, 0x10000, v195
    ds_read_b64_tr_b16 v[64:65], v195 offset:0
    ds_read_b64_tr_b16 v[66:67], v195 offset:2048
    v_mul_f32 v30, v30, v198
    v_mul_f32 v31, v31, v198
    v_cvt_pk_bf16_f32 v24, v24, v25
    s_waitcnt lgkmcnt(14)
    v_mfma_f32_32x32x16_bf16 v[32:47], v[68:71], v[164:167], v[32:47]
    ds_read_b64_tr_b16 v[68:69], v195 offset:4096
    ds_read_b64_tr_b16 v[70:71], v195 offset:6144
    v_cvt_pk_bf16_f32 v25, v26, v27
    v_cvt_pk_bf16_f32 v26, v28, v29
    v_cvt_pk_bf16_f32 v27, v30, v31
    s_waitcnt lgkmcnt(14)
    v_mfma_f32_32x32x16_bf16 v[32:47], v[72:75], v[168:171], v[32:47]
    ds_read_b64_tr_b16 v[72:73], v195 offset:8192
    ds_read_b64_tr_b16 v[74:75], v195 offset:10240
    v_permlane32_swap_b32 v16, v18
    v_permlane32_swap_b32 v17, v19
    v_permlane32_swap_b32 v24, v26
    s_waitcnt lgkmcnt(14)
    v_mfma_f32_32x32x16_bf16 v[32:47], v[76:79], v[172:175], v[32:47]
    ds_read_b64_tr_b16 v[76:77], v195 offset:12288
    ds_read_b64_tr_b16 v[78:79], v195 offset:14336
    v_permlane32_swap_b32 v25, v27
    buffer_store_dwordx4 v[16:19], v255, s[56:59], s49 offen offset:2048 sc1
    buffer_store_dwordx4 v[24:27], v255, s[56:59], s49 offen offset:3072 sc1
    v_mfma_f32_32x32x8_bf16 v[32:47], v[204:205], v[196:197], v[32:47]
    buffer_store_dwordx4 v[16:19], v255, s[8:11], s47 offen offset:2048
    buffer_store_dwordx4 v[24:27], v255, s[8:11], s47 offen offset:3072
    s_waitcnt lgkmcnt(14)
    v_mfma_f32_32x32x16_bf16 v[48:63], v[80:83], v[128:131], v[48:63]
    ds_read_b64_tr_b16 v[80:81], v195 offset:16384
    ds_read_b64_tr_b16 v[82:83], v195 offset:18432
    s_waitcnt lgkmcnt(14)
    v_mfma_f32_32x32x16_bf16 v[48:63], v[84:87], v[132:135], v[48:63]
    ds_read_b64_tr_b16 v[84:85], v195 offset:20480
    ds_read_b64_tr_b16 v[86:87], v195 offset:22528
    s_waitcnt lgkmcnt(14)
    v_mfma_f32_32x32x16_bf16 v[48:63], v[88:91], v[136:139], v[48:63]
    ds_read_b64_tr_b16 v[88:89], v195 offset:24576
    ds_read_b64_tr_b16 v[90:91], v195 offset:26624
    v_mul_f32 v32, v32, v198
    v_mul_f32 v33, v33, v198
    v_mul_f32 v34, v34, v198
    s_waitcnt lgkmcnt(14)
    v_mfma_f32_32x32x16_bf16 v[48:63], v[92:95], v[140:143], v[48:63]
    ds_read_b64_tr_b16 v[92:93], v195 offset:28672
    ds_read_b64_tr_b16 v[94:95], v195 offset:30720
    v_mul_f32 v35, v35, v198
    v_mul_f32 v36, v36, v198
    v_mul_f32 v37, v37, v198
    s_waitcnt lgkmcnt(14)
    v_mfma_f32_32x32x16_bf16 v[48:63], v[64:67], v[144:147], v[48:63]
    v_mul_f32 v38, v38, v198
    v_mul_f32 v39, v39, v198
    v_cvt_pk_bf16_f32 v32, v32, v33
    s_waitcnt lgkmcnt(12)
    v_mfma_f32_32x32x16_bf16 v[48:63], v[68:71], v[148:151], v[48:63]
    v_cvt_pk_bf16_f32 v33, v34, v35
    v_cvt_pk_bf16_f32 v34, v36, v37
    v_cvt_pk_bf16_f32 v35, v38, v39
    s_waitcnt lgkmcnt(10)
    v_mfma_f32_32x32x16_bf16 v[48:63], v[72:75], v[152:155], v[48:63]
    v_mul_f32 v40, v40, v198
    v_mul_f32 v41, v41, v198
    v_mul_f32 v42, v42, v198
    s_waitcnt lgkmcnt(8)
    v_mfma_f32_32x32x16_bf16 v[48:63], v[76:79], v[156:159], v[48:63]
    v_mul_f32 v43, v43, v198
    v_mul_f32 v44, v44, v198
    v_mul_f32 v45, v45, v198
    s_waitcnt lgkmcnt(6)
    v_mfma_f32_32x32x16_bf16 v[48:63], v[80:83], v[160:163], v[48:63]
    v_mul_f32 v46, v46, v198
    v_mul_f32 v47, v47, v198
    v_cvt_pk_bf16_f32 v40, v40, v41
    s_waitcnt lgkmcnt(4)
    v_mfma_f32_32x32x16_bf16 v[48:63], v[84:87], v[164:167], v[48:63]
    v_cvt_pk_bf16_f32 v41, v42, v43
    v_cvt_pk_bf16_f32 v42, v44, v45
    v_cvt_pk_bf16_f32 v43, v46, v47
    s_waitcnt lgkmcnt(2)
    v_mfma_f32_32x32x16_bf16 v[48:63], v[88:91], v[168:171], v[48:63]
    v_permlane32_swap_b32 v32, v34
    v_permlane32_swap_b32 v33, v35
    v_permlane32_swap_b32 v40, v42
    s_waitcnt lgkmcnt(0)
    v_mfma_f32_32x32x16_bf16 v[48:63], v[92:95], v[172:175], v[48:63]
    v_permlane32_swap_b32 v41, v43
    buffer_store_dwordx4 v[32:35], v255, s[56:59], s50 offen offset:0 sc1
    buffer_store_dwordx4 v[40:43], v255, s[56:59], s50 offen offset:1024 sc1
    v_mfma_f32_32x32x8_bf16 v[48:63], v[206:207], v[196:197], v[48:63]
    buffer_store_dwordx4 v[32:35], v255, s[8:11], s48 offen offset:0
    buffer_store_dwordx4 v[40:43], v255, s[8:11], s48 offen offset:1024
    s_nop 11
    v_pk_mul_f32 v[48:49], v[48:49], v[198:199]
    v_pk_mul_f32 v[50:51], v[50:51], v[198:199]
    v_pk_mul_f32 v[52:53], v[52:53], v[198:199]
    v_pk_mul_f32 v[54:55], v[54:55], v[198:199]
    v_cvt_pk_bf16_f32 v48, v48, v49
    v_cvt_pk_bf16_f32 v49, v50, v51
    v_cvt_pk_bf16_f32 v50, v52, v53
    v_cvt_pk_bf16_f32 v51, v54, v55
    v_pk_mul_f32 v[56:57], v[56:57], v[198:199]
    v_pk_mul_f32 v[58:59], v[58:59], v[198:199]
    v_pk_mul_f32 v[60:61], v[60:61], v[198:199]
    v_pk_mul_f32 v[62:63], v[62:63], v[198:199]
    v_cvt_pk_bf16_f32 v56, v56, v57
    v_cvt_pk_bf16_f32 v57, v58, v59
    v_cvt_pk_bf16_f32 v58, v60, v61
    v_cvt_pk_bf16_f32 v59, v62, v63
    v_permlane32_swap_b32 v48, v50
    v_permlane32_swap_b32 v49, v51
    v_permlane32_swap_b32 v56, v58
    v_permlane32_swap_b32 v57, v59
    buffer_store_dwordx4 v[48:51], v255, s[56:59], s50 offen offset:2048 sc1
    buffer_store_dwordx4 v[56:59], v255, s[56:59], s50 offen offset:3072 sc1
    buffer_store_dwordx4 v[48:51], v255, s[8:11], s48 offen offset:2048
    buffer_store_dwordx4 v[56:59], v255, s[8:11], s48 offen offset:3072
    s_branch L_qkv_done
L_qkv_v:
    s_mul_i32 s47, s42, 82048
    s_lshl_b32 s48, s40, 11
    s_add_u32 s47, s47, s48
    s_add_u32 s47, s47, 0x785000
    s_add_u32 s48, s47, 20480
    s_add_u32 s49, s47, s51
    s_add_u32 s50, s48, s51
    s_mov_b32 s52, 0
    v_mul_u32_u24 v229, 10240, v253
    v_lshl_add_u32 v229, v254, 4, v229
    v_lshlrev_b32 v227, 4, v253
    s_cmp_eq_u32 s16, 0
    s_cbranch_scc1 L_qkv_nopoll_22
    buffer_load_dword v240, v252, s[8:11], s18 offen sc1
    s_barrier
    ds_read_b64_tr_b16 v[64:65], v192 offset:0
    ds_read_b64_tr_b16 v[66:67], v192 offset:2048
    ds_read_b64_tr_b16 v[68:69], v193 offset:0
    ds_read_b64_tr_b16 v[70:71], v193 offset:2048
    ds_read_b64_tr_b16 v[72:73], v194 offset:0
    ds_read_b64_tr_b16 v[74:75], v194 offset:2048
    ds_read_b64_tr_b16 v[76:77], v195 offset:0
    ds_read_b64_tr_b16 v[78:79], v195 offset:2048
    ds_read_b64_tr_b16 v[80:81], v192 offset:4096
    ds_read_b64_tr_b16 v[82:83], v192 offset:6144
    ds_read_b64_tr_b16 v[84:85], v193 offset:4096
    ds_read_b64_tr_b16 v[86:87], v193 offset:6144
    ds_read_b64_tr_b16 v[88:89], v194 offset:4096
    ds_read_b64_tr_b16 v[90:91], v194 offset:6144
    ds_read_b64_tr_b16 v[92:93], v195 offset:4096
    ds_read_b64_tr_b16 v[94:95], v195 offset:6144
    s_waitcnt vmcnt(0)
    v_cmp_gt_u32 vcc, s17, v240
    s_cbranch_vccz L_qkv_d_25
    s_mov_b32 s37, 400000
L_qkv_p_24:
    buffer_load_dword v240, v252, s[8:11], s18 offen sc1
    s_waitcnt vmcnt(0)
    v_cmp_gt_u32 vcc, s17, v240
    s_cbranch_vccz L_qkv_d_25
    s_sub_u32 s37, s37, 1
    s_cmp_lg_u32 s37, 0
    s_cbranch_scc1 L_qkv_p_24
L_qkv_d_25:
    s_add_u32 s46, s45, 0
    buffer_load_dwordx4 v[96:99], v255, s[8:11], s46 offen offset:0 sc1
    buffer_load_dwordx4 v[100:103], v255, s[8:11], s46 offen offset:1024 sc1
    buffer_load_dwordx4 v[104:107], v255, s[8:11], s46 offen offset:2048 sc1
    buffer_load_dwordx4 v[108:111], v255, s[8:11], s46 offen offset:3072 sc1
    s_add_u32 s46, s45, 4096
    buffer_load_dwordx4 v[112:115], v255, s[8:11], s46 offen offset:0 sc1
    buffer_load_dwordx4 v[116:119], v255, s[8:11], s46 offen offset:1024 sc1
    s_branch L_qkv_first_23
L_qkv_nopoll_22:
    s_add_u32 s46, s45, 0
    buffer_load_dwordx4 v[96:99], v255, s[8:11], s46 offen offset:0 sc1
    buffer_load_dwordx4 v[100:103], v255, s[8:11], s46 offen offset:1024 sc1
    buffer_load_dwordx4 v[104:107], v255, s[8:11], s46 offen offset:2048 sc1
    buffer_load_dwordx4 v[108:111], v255, s[8:11], s46 offen offset:3072 sc1
    s_add_u32 s46, s45, 4096
    buffer_load_dwordx4 v[112:115], v255, s[8:11], s46 offen offset:0 sc1
    buffer_load_dwordx4 v[116:119], v255, s[8:11], s46 offen offset:1024 sc1
    s_barrier
    ds_read_b64_tr_b16 v[64:65], v192 offset:0
    ds_read_b64_tr_b16 v[66:67], v192 offset:2048
    ds_read_b64_tr_b16 v[68:69], v193 offset:0
    ds_read_b64_tr_b16 v[70:71], v193 offset:2048
    ds_read_b64_tr_b16 v[72:73], v194 offset:0
    ds_read_b64_tr_b16 v[74:75], v194 offset:2048
    ds_read_b64_tr_b16 v[76:77], v195 offset:0
    ds_read_b64_tr_b16 v[78:79], v195 offset:2048
    ds_read_b64_tr_b16 v[80:81], v192 offset:4096
    ds_read_b64_tr_b16 v[82:83], v192 offset:6144
    ds_read_b64_tr_b16 v[84:85], v193 offset:4096
    ds_read_b64_tr_b16 v[86:87], v193 offset:6144
    ds_read_b64_tr_b16 v[88:89], v194 offset:4096
    ds_read_b64_tr_b16 v[90:91], v194 offset:6144
    ds_read_b64_tr_b16 v[92:93], v195 offset:4096
    ds_read_b64_tr_b16 v[94:95], v195 offset:6144
L_qkv_first_23:
    s_waitcnt vmcnt(5)
    s_waitcnt lgkmcnt(14)
    v_mfma_f32_32x32x16_bf16 v[0:15], v[96:99], v[64:67], 0
    ds_read_b64_tr_b16 v[64:65], v192 offset:8192
    ds_read_b64_tr_b16 v[66:67], v192 offset:10240
    s_waitcnt lgkmcnt(14)
    v_mfma_f32_32x32x16_bf16 v[16:31], v[96:99], v[68:71], 0
    ds_read_b64_tr_b16 v[68:69], v193 offset:8192
    ds_read_b64_tr_b16 v[70:71], v193 offset:10240
    buffer_load_dwordx4 v[120:123], v255, s[8:11], s46 offen offset:2048 sc1
    s_waitcnt lgkmcnt(14)
    v_mfma_f32_32x32x16_bf16 v[32:47], v[96:99], v[72:75], 0
    ds_read_b64_tr_b16 v[72:73], v194 offset:8192
    ds_read_b64_tr_b16 v[74:75], v194 offset:10240
    s_waitcnt lgkmcnt(14)
    v_mfma_f32_32x32x16_bf16 v[48:63], v[96:99], v[76:79], 0
    ds_read_b64_tr_b16 v[76:77], v195 offset:8192
    ds_read_b64_tr_b16 v[78:79], v195 offset:10240
    buffer_load_dwordx4 v[124:127], v255, s[8:11], s46 offen offset:3072 sc1
    s_waitcnt vmcnt(6)
    s_waitcnt lgkmcnt(14)
    v_mfma_f32_32x32x16_bf16 v[0:15], v[100:103], v[80:83], v[0:15]
    ds_read_b64_tr_b16 v[80:81], v192 offset:12288
    ds_read_b64_tr_b16 v[82:83], v192 offset:14336
    s_waitcnt lgkmcnt(14)
    v_mfma_f32_32x32x16_bf16 v[16:31], v[100:103], v[84:87], v[16:31]
    ds_read_b64_tr_b16 v[84:85], v193 offset:12288
    ds_read_b64_tr_b16 v[86:87], v193 offset:14336
    s_add_u32 s46, s45, 8192
    buffer_load_dwordx4 v[128:131], v255, s[8:11], s46 offen offset:0 sc1
    s_waitcnt lgkmcnt(14)
    v_mfma_f32_32x32x16_bf16 v[32:47], v[100:103], v[88:91], v[32:47]
    ds_read_b64_tr_b16 v[88:89], v194 offset:12288
    ds_read_b64_tr_b16 v[90:91], v194 offset:14336
    s_waitcnt lgkmcnt(14)
    v_mfma_f32_32x32x16_bf16 v[48:63], v[100:103], v[92:95], v[48:63]
    ds_read_b64_tr_b16 v[92:93], v195 offset:12288
    ds_read_b64_tr_b16 v[94:95], v195 offset:14336
    buffer_load_dwordx4 v[132:135], v255, s[8:11], s46 offen offset:1024 sc1
    s_waitcnt vmcnt(7)
    s_waitcnt lgkmcnt(14)
    v_mfma_f32_32x32x16_bf16 v[0:15], v[104:107], v[64:67], v[0:15]
    ds_read_b64_tr_b16 v[64:65], v192 offset:16384
    ds_read_b64_tr_b16 v[66:67], v192 offset:18432
    s_waitcnt lgkmcnt(14)
    v_mfma_f32_32x32x16_bf16 v[16:31], v[104:107], v[68:71], v[16:31]
    ds_read_b64_tr_b16 v[68:69], v193 offset:16384
    ds_read_b64_tr_b16 v[70:71], v193 offset:18432
    buffer_load_dwordx4 v[136:139], v255, s[8:11], s46 offen offset:2048 sc1
    s_waitcnt lgkmcnt(14)
    v_mfma_f32_32x32x16_bf16 v[32:47], v[104:107], v[72:75], v[32:47]
    ds_read_b64_tr_b16 v[72:73], v194 offset:16384
    ds_read_b64_tr_b16 v[74:75], v194 offset:18432
    s_waitcnt lgkmcnt(14)
    v_mfma_f32_32x32x16_bf16 v[48:63], v[104:107], v[76:79], v[48:63]
    ds_read_b64_tr_b16 v[76:77], v195 offset:16384
    ds_read_b64_tr_b16 v[78:79], v195 offset:18432
    buffer_load_dwordx4 v[140:143], v255, s[8:11], s46 offen offset:3072 sc1
    s_waitcnt vmcnt(8)
    s_waitcnt lgkmcnt(14)
    v_mfma_f32_32x32x16_bf16 v[0:15], v[108:111], v[80:83], v[0:15]
    ds_read_b64_tr_b16 v[80:81], v192 offset:20480
    ds_read_b64_tr_b16 v[82:83], v192 offset:22528
    s_waitcnt lgkmcnt(14)
    v_mfma_f32_32x32x16_bf16 v[16:31], v[108:111], v[84:87], v[16:31]
    ds_read_b64_tr_b16 v[84:85], v193 offset:20480
    ds_read_b64_tr_b16 v[86:87], v193 offset:22528
    s_add_u32 s46, s45, 12288
    buffer_load_dwordx4 v[144:147], v255, s[8:11], s46 offen offset:0 sc1
    s_waitcnt lgkmcnt(14)
    v_mfma_f32_32x32x16_bf16 v[32:47], v[108:111], v[88:91], v[32:47]
    ds_read_b64_tr_b16 v[88:89], v194 offset:20480
    ds_read_b64_tr_b16 v[90:91], v194 offset:22528
    s_waitcnt lgkmcnt(14)
    v_mfma_f32_32x32x16_bf16 v[48:63], v[108:111], v[92:95], v[48:63]
    ds_read_b64_tr_b16 v[92:93], v195 offset:20480
    ds_read_b64_tr_b16 v[94:95], v195 offset:22528
    buffer_load_dwordx4 v[148:151], v255, s[8:11], s46 offen offset:1024 sc1
    s_waitcnt vmcnt(9)
    s_waitcnt lgkmcnt(14)
    v_mfma_f32_32x32x16_bf16 v[0:15], v[112:115], v[64:67], v[0:15]
    ds_read_b64_tr_b16 v[64:65], v192 offset:24576
    ds_read_b64_tr_b16 v[66:67], v192 offset:26624
    buffer_load_dwordx4 v[208:211], v230, s[8:11], s44 offen offset:0 sc1
    s_waitcnt lgkmcnt(14)
    v_mfma_f32_32x32x16_bf16 v[16:31], v[112:115], v[68:71], v[16:31]
    ds_read_b64_tr_b16 v[68:69], v193 offset:24576
    ds_read_b64_tr_b16 v[70:71], v193 offset:26624
    buffer_load_dwordx4 v[152:155], v255, s[8:11], s46 offen offset:2048 sc1
    s_waitcnt lgkmcnt(14)
    v_mfma_f32_32x32x16_bf16 v[32:47], v[112:115], v[72:75], v[32:47]
    ds_read_b64_tr_b16 v[72:73], v194 offset:24576
    ds_read_b64_tr_b16 v[74:75], v194 offset:26624
    s_waitcnt lgkmcnt(14)
    v_mfma_f32_32x32x16_bf16 v[48:63], v[112:115], v[76:79], v[48:63]
    ds_read_b64_tr_b16 v[76:77], v195 offset:24576
    ds_read_b64_tr_b16 v[78:79], v195 offset:26624
    buffer_load_dwordx4 v[156:159], v255, s[8:11], s46 offen offset:3072 sc1
    s_waitcnt vmcnt(11)
    s_waitcnt lgkmcnt(14)
    v_mfma_f32_32x32x16_bf16 v[0:15], v[116:119], v[80:83], v[0:15]
    ds_read_b64_tr_b16 v[80:81], v192 offset:28672
    ds_read_b64_tr_b16 v[82:83], v192 offset:30720
    buffer_load_dwordx4 v[212:215], v230, s[8:11], s44 offen offset:16 sc1
    s_waitcnt lgkmcnt(14)
    v_mfma_f32_32x32x16_bf16 v[16:31], v[116:119], v[84:87], v[16:31]
    ds_read_b64_tr_b16 v[84:85], v193 offset:28672
    ds_read_b64_tr_b16 v[86:87], v193 offset:30720
    s_add_u32 s46, s45, 16384
    buffer_load_dwordx4 v[160:163], v255, s[8:11], s46 offen offset:0 sc1
    s_waitcnt lgkmcnt(14)
    v_mfma_f32_32x32x16_bf16 v[32:47], v[116:119], v[88:91], v[32:47]
    ds_read_b64_tr_b16 v[88:89], v194 offset:28672
    ds_read_b64_tr_b16 v[90:91], v194 offset:30720
    s_waitcnt lgkmcnt(14)
    v_mfma_f32_32x32x16_bf16 v[48:63], v[116:119], v[92:95], v[48:63]
    ds_read_b64_tr_b16 v[92:93], v195 offset:28672
    ds_read_b64_tr_b16 v[94:95], v195 offset:30720
    buffer_load_dwordx4 v[164:167], v255, s[8:11], s46 offen offset:1024 sc1
    s_waitcnt vmcnt(13)
    s_waitcnt lgkmcnt(14)
    v_mfma_f32_32x32x16_bf16 v[0:15], v[120:123], v[64:67], v[0:15]
    ds_read_b64_tr_b16 v[64:65], v192 offset:32768
    ds_read_b64_tr_b16 v[66:67], v192 offset:34816
    s_waitcnt lgkmcnt(14)
    v_mfma_f32_32x32x16_bf16 v[16:31], v[120:123], v[68:71], v[16:31]
    ds_read_b64_tr_b16 v[68:69], v193 offset:32768
    ds_read_b64_tr_b16 v[70:71], v193 offset:34816
    buffer_load_dwordx4 v[168:171], v255, s[8:11], s46 offen offset:2048 sc1
    s_waitcnt lgkmcnt(14)
    v_mfma_f32_32x32x16_bf16 v[32:47], v[120:123], v[72:75], v[32:47]
    ds_read_b64_tr_b16 v[72:73], v194 offset:32768
    ds_read_b64_tr_b16 v[74:75], v194 offset:34816
    s_waitcnt lgkmcnt(14)
    v_mfma_f32_32x32x16_bf16 v[48:63], v[120:123], v[76:79], v[48:63]
    ds_read_b64_tr_b16 v[76:77], v195 offset:32768
    ds_read_b64_tr_b16 v[78:79], v195 offset:34816
    buffer_load_dwordx4 v[172:175], v255, s[8:11], s46 offen offset:3072 sc1
    s_barrier
    s_waitcnt vmcnt(14)
    s_waitcnt lgkmcnt(14)
    v_mfma_f32_32x32x16_bf16 v[0:15], v[124:127], v[80:83], v[0:15]
    ds_read_b64_tr_b16 v[80:81], v192 offset:36864
    ds_read_b64_tr_b16 v[82:83], v192 offset:38912
    s_waitcnt lgkmcnt(14)
    v_mfma_f32_32x32x16_bf16 v[16:31], v[124:127], v[84:87], v[16:31]
    ds_read_b64_tr_b16 v[84:85], v193 offset:36864
    ds_read_b64_tr_b16 v[86:87], v193 offset:38912
    s_add_u32 s46, s45, 20480
    buffer_load_dwordx4 v[96:99], v255, s[8:11], s46 offen offset:0 sc1
    s_waitcnt lgkmcnt(14)
    v_mfma_f32_32x32x16_bf16 v[32:47], v[124:127], v[88:91], v[32:47]
    ds_read_b64_tr_b16 v[88:89], v194 offset:36864
    ds_read_b64_tr_b16 v[90:91], v194 offset:38912
    s_waitcnt lgkmcnt(14)
    v_mfma_f32_32x32x16_bf16 v[48:63], v[124:127], v[92:95], v[48:63]
    ds_read_b64_tr_b16 v[92:93], v195 offset:36864
    ds_read_b64_tr_b16 v[94:95], v195 offset:38912
    buffer_load_dwordx4 v[100:103], v255, s[8:11], s46 offen offset:1024 sc1
    s_waitcnt vmcnt(15)
    s_waitcnt lgkmcnt(14)
    v_mfma_f32_32x32x16_bf16 v[0:15], v[128:131], v[64:67], v[0:15]
    ds_read_b64_tr_b16 v[64:65], v192 offset:40960
    ds_read_b64_tr_b16 v[66:67], v192 offset:43008
    s_waitcnt lgkmcnt(14)
    v_mfma_f32_32x32x16_bf16 v[16:31], v[128:131], v[68:71], v[16:31]
    ds_read_b64_tr_b16 v[68:69], v193 offset:40960
    ds_read_b64_tr_b16 v[70:71], v193 offset:43008
    buffer_load_dwordx4 v[104:107], v255, s[8:11], s46 offen offset:2048 sc1
    s_waitcnt lgkmcnt(14)
    v_mfma_f32_32x32x16_bf16 v[32:47], v[128:131], v[72:75], v[32:47]
    ds_read_b64_tr_b16 v[72:73], v194 offset:40960
    ds_read_b64_tr_b16 v[74:75], v194 offset:43008
    s_waitcnt lgkmcnt(14)
    v_mfma_f32_32x32x16_bf16 v[48:63], v[128:131], v[76:79], v[48:63]
    ds_read_b64_tr_b16 v[76:77], v195 offset:40960
    ds_read_b64_tr_b16 v[78:79], v195 offset:43008
    buffer_load_dwordx4 v[108:111], v255, s[8:11], s46 offen offset:3072 sc1
    s_waitcnt vmcnt(16)
    s_waitcnt lgkmcnt(14)
    v_mfma_f32_32x32x16_bf16 v[0:15], v[132:135], v[80:83], v[0:15]
    ds_read_b64_tr_b16 v[80:81], v192 offset:45056
    ds_read_b64_tr_b16 v[82:83], v192 offset:47104
    s_waitcnt lgkmcnt(14)
    v_mfma_f32_32x32x16_bf16 v[16:31], v[132:135], v[84:87], v[16:31]
    ds_read_b64_tr_b16 v[84:85], v193 offset:45056
    ds_read_b64_tr_b16 v[86:87], v193 offset:47104
    s_add_u32 s46, s45, 24576
    buffer_load_dwordx4 v[112:115], v255, s[8:11], s46 offen offset:0 sc1
    s_waitcnt lgkmcnt(14)
    v_mfma_f32_32x32x16_bf16 v[32:47], v[132:135], v[88:91], v[32:47]
    ds_read_b64_tr_b16 v[88:89], v194 offset:45056
    ds_read_b64_tr_b16 v[90:91], v194 offset:47104
    s_waitcnt lgkmcnt(14)
    v_mfma_f32_32x32x16_bf16 v[48:63], v[132:135], v[92:95], v[48:63]
    ds_read_b64_tr_b16 v[92:93], v195 offset:45056
    ds_read_b64_tr_b16 v[94:95], v195 offset:47104
    buffer_load_dwordx4 v[116:119], v255, s[8:11], s46 offen offset:1024 sc1
    s_waitcnt vmcnt(17)
    s_waitcnt lgkmcnt(14)
    v_mfma_f32_32x32x16_bf16 v[0:15], v[136:139], v[64:67], v[0:15]
    ds_read_b64_tr_b16 v[64:65], v192 offset:49152
    ds_read_b64_tr_b16 v[66:67], v192 offset:51200
    s_waitcnt lgkmcnt(14)
    v_mfma_f32_32x32x16_bf16 v[16:31], v[136:139], v[68:71], v[16:31]
    ds_read_b64_tr_b16 v[68:69], v193 offset:49152
    ds_read_b64_tr_b16 v[70:71], v193 offset:51200
    buffer_load_dwordx4 v[120:123], v255, s[8:11], s46 offen offset:2048 sc1
    s_waitcnt lgkmcnt(14)
    v_mfma_f32_32x32x16_bf16 v[32:47], v[136:139], v[72:75], v[32:47]
    ds_read_b64_tr_b16 v[72:73], v194 offset:49152
    ds_read_b64_tr_b16 v[74:75], v194 offset:51200
    s_waitcnt lgkmcnt(14)
    v_mfma_f32_32x32x16_bf16 v[48:63], v[136:139], v[76:79], v[48:63]
    ds_read_b64_tr_b16 v[76:77], v195 offset:49152
    ds_read_b64_tr_b16 v[78:79], v195 offset:51200
    buffer_load_dwordx4 v[124:127], v255, s[8:11], s46 offen offset:3072 sc1
    s_waitcnt vmcnt(18)
    s_waitcnt lgkmcnt(14)
    v_mfma_f32_32x32x16_bf16 v[0:15], v[140:143], v[80:83], v[0:15]
    ds_read_b64_tr_b16 v[80:81], v192 offset:53248
    ds_read_b64_tr_b16 v[82:83], v192 offset:55296
    s_waitcnt vmcnt(12)
    v_add_f32 v208, v208, v210
    s_waitcnt lgkmcnt(14)
    v_mfma_f32_32x32x16_bf16 v[16:31], v[140:143], v[84:87], v[16:31]
    ds_read_b64_tr_b16 v[84:85], v193 offset:53248
    ds_read_b64_tr_b16 v[86:87], v193 offset:55296
    s_add_u32 s46, s45, 28672
    buffer_load_dwordx4 v[128:131], v255, s[8:11], s46 offen offset:0 sc1
    v_add_f32 v209, v209, v211
    v_add_f32 v208, v208, v212
    s_waitcnt lgkmcnt(14)
    v_mfma_f32_32x32x16_bf16 v[32:47], v[140:143], v[88:91], v[32:47]
    ds_read_b64_tr_b16 v[88:89], v194 offset:53248
    ds_read_b64_tr_b16 v[90:91], v194 offset:55296
    v_add_f32 v209, v209, v213
    v_add_f32 v208, v208, v214
    s_waitcnt lgkmcnt(14)
    v_mfma_f32_32x32x16_bf16 v[48:63], v[140:143], v[92:95], v[48:63]
    ds_read_b64_tr_b16 v[92:93], v195 offset:53248
    ds_read_b64_tr_b16 v[94:95], v195 offset:55296
    buffer_load_dwordx4 v[132:135], v255, s[8:11], s46 offen offset:1024 sc1
    s_waitcnt lgkmcnt(14)
    v_mfma_f32_32x32x16_bf16 v[0:15], v[144:147], v[64:67], v[0:15]
    ds_read_b64_tr_b16 v[64:65], v192 offset:57344
    ds_read_b64_tr_b16 v[66:67], v192 offset:59392
    v_add_f32 v209, v209, v215
    v_mov_b32 v210, v208
    s_waitcnt lgkmcnt(14)
    v_mfma_f32_32x32x16_bf16 v[16:31], v[144:147], v[68:71], v[16:31]
    ds_read_b64_tr_b16 v[68:69], v193 offset:57344
    ds_read_b64_tr_b16 v[70:71], v193 offset:59392
    buffer_load_dwordx4 v[136:139], v255, s[8:11], s46 offen offset:2048 sc1
    v_mov_b32 v211, v209
    s_nop 1
    s_waitcnt lgkmcnt(14)
    v_mfma_f32_32x32x16_bf16 v[32:47], v[144:147], v[72:75], v[32:47]
    ds_read_b64_tr_b16 v[72:73], v194 offset:57344
    ds_read_b64_tr_b16 v[74:75], v194 offset:59392
    v_permlane32_swap_b32 v208, v210
    v_permlane32_swap_b32 v209, v211
    s_waitcnt lgkmcnt(14)
    v_mfma_f32_32x32x16_bf16 v[48:63], v[144:147], v[76:79], v[48:63]
    ds_read_b64_tr_b16 v[76:77], v195 offset:57344
    ds_read_b64_tr_b16 v[78:79], v195 offset:59392
    buffer_load_dwordx4 v[140:143], v255, s[8:11], s46 offen offset:3072 sc1
    s_waitcnt lgkmcnt(14)
    v_mfma_f32_32x32x16_bf16 v[0:15], v[148:151], v[80:83], v[0:15]
    ds_read_b64_tr_b16 v[80:81], v192 offset:61440
    ds_read_b64_tr_b16 v[82:83], v192 offset:63488
    s_nop 0
    v_add_f32 v208, v208, v210
    s_waitcnt lgkmcnt(14)
    v_mfma_f32_32x32x16_bf16 v[16:31], v[148:151], v[84:87], v[16:31]
    ds_read_b64_tr_b16 v[84:85], v193 offset:61440
    ds_read_b64_tr_b16 v[86:87], v193 offset:63488
    s_add_u32 s46, s45, 32768
    buffer_load_dwordx4 v[144:147], v255, s[8:11], s46 offen offset:0 sc1
    v_add_f32 v209, v209, v211
    v_mul_f32 v224, 0x3acccccd, v208
    s_waitcnt lgkmcnt(14)
    v_mfma_f32_32x32x16_bf16 v[32:47], v[148:151], v[88:91], v[32:47]
    ds_read_b64_tr_b16 v[88:89], v194 offset:61440
    ds_read_b64_tr_b16 v[90:91], v194 offset:63488
    v_mul_f32 v225, 0x3acccccd, v209
    v_fma_f32 v225, -v224, v224, v225
    s_waitcnt lgkmcnt(14)
    v_mfma_f32_32x32x16_bf16 v[48:63], v[148:151], v[92:95], v[48:63]
    ds_read_b64_tr_b16 v[92:93], v195 offset:61440
    ds_read_b64_tr_b16 v[94:95], v195 offset:63488
    s_waitcnt lgkmcnt(14)
    v_mfma_f32_32x32x16_bf16 v[0:15], v[152:155], v[64:67], v[0:15]
    v_add_u32 v192, 0x10000, v192
    ds_read_b64_tr_b16 v[64:65], v192 offset:0
    ds_read_b64_tr_b16 v[66:67], v192 offset:2048
    v_max_f32 v225, 0, v225
    v_cvt_pk_bf16_f32 v225, v225, v225
    s_waitcnt lgkmcnt(14)
    v_mfma_f32_32x32x16_bf16 v[16:31], v[152:155], v[68:71], v[16:31]
    v_add_u32 v193, 0x10000, v193
    ds_read_b64_tr_b16 v[68:69], v193 offset:0
    ds_read_b64_tr_b16 v[70:71], v193 offset:2048
    buffer_load_dwordx4 v[148:151], v255, s[8:11], s46 offen offset:1024 sc1
    v_and_b32 v225, s31, v225
    v_add_f32 v225, 0x3727c5ac, v225
    s_waitcnt lgkmcnt(14)
    v_mfma_f32_32x32x16_bf16 v[32:47], v[152:155], v[72:75], v[32:47]
    v_add_u32 v194, 0x10000, v194
    ds_read_b64_tr_b16 v[72:73], v194 offset:0
    ds_read_b64_tr_b16 v[74:75], v194 offset:2048
    v_cvt_pk_bf16_f32 v225, v225, v225
    v_and_b32 v225, s31, v225
    s_waitcnt lgkmcnt(14)
    v_mfma_f32_32x32x16_bf16 v[48:63], v[152:155], v[76:79], v[48:63]
    v_add_u32 v195, 0x10000, v195
    ds_read_b64_tr_b16 v[76:77], v195 offset:0
    ds_read_b64_tr_b16 v[78:79], v195 offset:2048
    s_waitcnt lgkmcnt(14)
    v_mfma_f32_32x32x16_bf16 v[0:15], v[156:159], v[80:83], v[0:15]
    ds_read_b64_tr_b16 v[80:81], v192 offset:4096
    ds_read_b64_tr_b16 v[82:83], v192 offset:6144
    v_sqrt_f32 v225, v225
    v_sub_f32 v224, 0, v224
    s_waitcnt lgkmcnt(14)
    v_mfma_f32_32x32x16_bf16 v[16:31], v[156:159], v[84:87], v[16:31]
    ds_read_b64_tr_b16 v[84:85], v193 offset:4096
    ds_read_b64_tr_b16 v[86:87], v193 offset:6144
    buffer_load_dwordx4 v[152:155], v255, s[8:11], s46 offen offset:2048 sc1
    v_cvt_pk_bf16_f32 v225, v225, v225
    v_and_b32 v225, s31, v225
    s_waitcnt lgkmcnt(14)
    v_mfma_f32_32x32x16_bf16 v[32:47], v[156:159], v[88:91], v[32:47]
    ds_read_b64_tr_b16 v[88:89], v194 offset:4096
    ds_read_b64_tr_b16 v[90:91], v194 offset:6144
    v_rcp_f32 v198, v225
    v_cvt_pk_bf16_f32 v196, v224, v224
    s_waitcnt lgkmcnt(14)
    v_mfma_f32_32x32x16_bf16 v[48:63], v[156:159], v[92:95], v[48:63]
    ds_read_b64_tr_b16 v[92:93], v195 offset:4096
    ds_read_b64_tr_b16 v[94:95], v195 offset:6144
    s_waitcnt vmcnt(18)
    s_waitcnt lgkmcnt(14)
    v_mfma_f32_32x32x16_bf16 v[0:15], v[160:163], v[64:67], v[0:15]
    ds_read_b64_tr_b16 v[64:65], v192 offset:8192
    ds_read_b64_tr_b16 v[66:67], v192 offset:10240
    v_mov_b32 v226, 0
    v_and_b32 v197, 0xffff, v196
    s_waitcnt lgkmcnt(14)
    v_mfma_f32_32x32x16_bf16 v[16:31], v[160:163], v[68:71], v[16:31]
    ds_read_b64_tr_b16 v[68:69], v193 offset:8192
    ds_read_b64_tr_b16 v[70:71], v193 offset:10240
    buffer_load_dwordx4 v[156:159], v255, s[8:11], s46 offen offset:3072 sc1
    v_cndmask_b32 v196, v226, v196, s[28:29]
    v_cndmask_b32 v197, v226, v197, s[28:29]
    s_waitcnt lgkmcnt(14)
    v_mfma_f32_32x32x16_bf16 v[32:47], v[160:163], v[72:75], v[32:47]
    ds_read_b64_tr_b16 v[72:73], v194 offset:8192
    ds_read_b64_tr_b16 v[74:75], v194 offset:10240
    v_add_u32 v228, 0, v227
    ds_bpermute_b32 v208, v228, v198
    s_waitcnt lgkmcnt(15)
    v_mfma_f32_32x32x16_bf16 v[48:63], v[160:163], v[76:79], v[48:63]
    ds_read_b64_tr_b16 v[76:77], v195 offset:8192
    ds_read_b64_tr_b16 v[78:79], v195 offset:10240
    s_waitcnt vmcnt(18)
    s_waitcnt lgkmcnt(15)
    v_mfma_f32_32x32x16_bf16 v[0:15], v[164:167], v[80:83], v[0:15]
    ds_read_b64_tr_b16 v[80:81], v192 offset:12288
    ds_read_b64_tr_b16 v[82:83], v192 offset:14336
    v_add_u32 v228, 4, v227
    ds_bpermute_b32 v209, v228, v198
    s_waitcnt lgkmcnt(15)
    v_mfma_f32_32x32x16_bf16 v[16:31], v[164:167], v[84:87], v[16:31]
    ds_read_b64_tr_b16 v[84:85], v193 offset:12288
    ds_read_b64_tr_b16 v[86:87], v193 offset:14336
    s_add_u32 s46, s45, 36864
    buffer_load_dwordx4 v[160:163], v255, s[8:11], s46 offen offset:0 sc1
    v_add_u32 v228, 8, v227
    ds_bpermute_b32 v210, v228, v198
    s_waitcnt lgkmcnt(15)
    v_mfma_f32_32x32x16_bf16 v[32:47], v[164:167], v[88:91], v[32:47]
    ds_read_b64_tr_b16 v[88:89], v194 offset:12288
    ds_read_b64_tr_b16 v[90:91], v194 offset:14336
    v_add_u32 v228, 12, v227
    ds_bpermute_b32 v211, v228, v198
    v_mfma_f32_32x32x16_bf16 v[48:63], v[164:167], v[92:95], v[48:63]
    ds_read_b64_tr_b16 v[92:93], v195 offset:12288
    ds_read_b64_tr_b16 v[94:95], v195 offset:14336
    s_waitcnt vmcnt(18)
    s_waitcnt lgkmcnt(15)
    v_mfma_f32_32x32x16_bf16 v[0:15], v[168:171], v[64:67], v[0:15]
    ds_read_b64_tr_b16 v[64:65], v192 offset:16384
    ds_read_b64_tr_b16 v[66:67], v192 offset:18432
    v_add_u32 v228, 32, v227
    ds_bpermute_b32 v212, v228, v198
    v_mfma_f32_32x32x16_bf16 v[16:31], v[168:171], v[68:71], v[16:31]
    ds_read_b64_tr_b16 v[68:69], v193 offset:16384
    ds_read_b64_tr_b16 v[70:71], v193 offset:18432
    buffer_load_dwordx4 v[164:167], v255, s[8:11], s46 offen offset:1024 sc1
    v_add_u32 v228, 36, v227
    ds_bpermute_b32 v213, v228, v198
    s_waitcnt lgkmcnt(15)
    v_mfma_f32_32x32x16_bf16 v[32:47], v[168:171], v[72:75], v[32:47]
    ds_read_b64_tr_b16 v[72:73], v194 offset:16384
    ds_read_b64_tr_b16 v[74:75], v194 offset:18432
    v_add_u32 v228, 40, v227
    ds_bpermute_b32 v214, v228, v198
    v_mfma_f32_32x32x16_bf16 v[48:63], v[168:171], v[76:79], v[48:63]
    ds_read_b64_tr_b16 v[76:77], v195 offset:16384
    ds_read_b64_tr_b16 v[78:79], v195 offset:18432
    s_waitcnt vmcnt(18)
    v_mfma_f32_32x32x16_bf16 v[0:15], v[172:175], v[80:83], v[0:15]
    ds_read_b64_tr_b16 v[80:81], v192 offset:20480
    ds_read_b64_tr_b16 v[82:83], v192 offset:22528
    v_add_u32 v228, 44, v227
    ds_bpermute_b32 v215, v228, v198
    s_waitcnt lgkmcnt(15)
    v_mfma_f32_32x32x16_bf16 v[16:31], v[172:175], v[84:87], v[16:31]
    ds_read_b64_tr_b16 v[84:85], v193 offset:20480
    ds_read_b64_tr_b16 v[86:87], v193 offset:22528
    buffer_load_dwordx4 v[168:171], v255, s[8:11], s46 offen offset:2048 sc1
    v_add_u32 v228, 64, v227
    ds_bpermute_b32 v216, v228, v198
    v_mfma_f32_32x32x16_bf16 v[32:47], v[172:175], v[88:91], v[32:47]
    ds_read_b64_tr_b16 v[88:89], v194 offset:20480
    ds_read_b64_tr_b16 v[90:91], v194 offset:22528
    v_add_u32 v228, 68, v227
    ds_bpermute_b32 v217, v228, v198
    s_waitcnt lgkmcnt(15)
    v_mfma_f32_32x32x16_bf16 v[48:63], v[172:175], v[92:95], v[48:63]
    ds_read_b64_tr_b16 v[92:93], v195 offset:20480
    ds_read_b64_tr_b16 v[94:95], v195 offset:22528
    s_waitcnt vmcnt(18)
    v_mfma_f32_32x32x16_bf16 v[0:15], v[96:99], v[64:67], v[0:15]
    ds_read_b64_tr_b16 v[64:65], v192 offset:24576
    ds_read_b64_tr_b16 v[66:67], v192 offset:26624
    v_add_u32 v228, 72, v227
    ds_bpermute_b32 v218, v228, v198
    v_mfma_f32_32x32x16_bf16 v[16:31], v[96:99], v[68:71], v[16:31]
    ds_read_b64_tr_b16 v[68:69], v193 offset:24576
    ds_read_b64_tr_b16 v[70:71], v193 offset:26624
    buffer_load_dwordx4 v[172:175], v255, s[8:11], s46 offen offset:3072 sc1
    v_add_u32 v228, 76, v227
    ds_bpermute_b32 v219, v228, v198
    s_waitcnt lgkmcnt(15)
    v_mfma_f32_32x32x16_bf16 v[32:47], v[96:99], v[72:75], v[32:47]
    ds_read_b64_tr_b16 v[72:73], v194 offset:24576
    ds_read_b64_tr_b16 v[74:75], v194 offset:26624
    v_add_u32 v228, 96, v227
    ds_bpermute_b32 v220, v228, v198
    v_mfma_f32_32x32x16_bf16 v[48:63], v[96:99], v[76:79], v[48:63]
    ds_read_b64_tr_b16 v[76:77], v195 offset:24576
    ds_read_b64_tr_b16 v[78:79], v195 offset:26624
    s_bitcmp0_b32 s16, 0
    s_cbranch_scc1 L_go_27
    s_barrier
L_go_27:
    s_waitcnt vmcnt(18)
    v_mfma_f32_32x32x16_bf16 v[0:15], v[100:103], v[80:83], v[0:15]
    ds_read_b64_tr_b16 v[80:81], v192 offset:28672
    ds_read_b64_tr_b16 v[82:83], v192 offset:30720
    v_add_u32 v228, 100, v227
    ds_bpermute_b32 v221, v228, v198
    s_waitcnt lgkmcnt(15)
    v_mfma_f32_32x32x16_bf16 v[16:31], v[100:103], v[84:87], v[16:31]
    ds_read_b64_tr_b16 v[84:85], v193 offset:28672
    ds_read_b64_tr_b16 v[86:87], v193 offset:30720
    v_add_u32 v228, 104, v227
    ds_bpermute_b32 v222, v228, v198
    v_mfma_f32_32x32x16_bf16 v[32:47], v[100:103], v[88:91], v[32:47]
    ds_read_b64_tr_b16 v[88:89], v194 offset:28672
    ds_read_b64_tr_b16 v[90:91], v194 offset:30720
    v_add_u32 v228, 108, v227
    ds_bpermute_b32 v223, v228, v198
    s_waitcnt lgkmcnt(15)
    v_mfma_f32_32x32x16_bf16 v[48:63], v[100:103], v[92:95], v[48:63]
    ds_read_b64_tr_b16 v[92:93], v195 offset:28672
    ds_read_b64_tr_b16 v[94:95], v195 offset:30720
    s_waitcnt vmcnt(17)
    v_mfma_f32_32x32x16_bf16 v[0:15], v[104:107], v[64:67], v[0:15]
    ds_read_b64_tr_b16 v[64:65], v192 offset:32768
    ds_read_b64_tr_b16 v[66:67], v192 offset:34816
    v_cndmask_b32 v200, v176, v184, s[54:55]
    v_cndmask_b32 v201, v177, v185, s[54:55]
    v_mfma_f32_32x32x16_bf16 v[16:31], v[104:107], v[68:71], v[16:31]
    ds_read_b64_tr_b16 v[68:69], v193 offset:32768
    ds_read_b64_tr_b16 v[70:71], v193 offset:34816
    v_cndmask_b32 v202, v178, v186, s[54:55]
    v_cndmask_b32 v203, v179, v187, s[54:55]
    s_waitcnt lgkmcnt(15)
    v_mfma_f32_32x32x16_bf16 v[32:47], v[104:107], v[72:75], v[32:47]
    ds_read_b64_tr_b16 v[72:73], v194 offset:32768
    ds_read_b64_tr_b16 v[74:75], v194 offset:34816
    v_cndmask_b32 v204, v180, v188, s[54:55]
    v_cndmask_b32 v205, v181, v189, s[54:55]
    v_mfma_f32_32x32x16_bf16 v[48:63], v[104:107], v[76:79], v[48:63]
    ds_read_b64_tr_b16 v[76:77], v195 offset:32768
    ds_read_b64_tr_b16 v[78:79], v195 offset:34816
    s_waitcnt vmcnt(16)
    s_waitcnt lgkmcnt(15)
    v_mfma_f32_32x32x16_bf16 v[0:15], v[108:111], v[80:83], v[0:15]
    ds_read_b64_tr_b16 v[80:81], v192 offset:36864
    ds_read_b64_tr_b16 v[82:83], v192 offset:38912
    v_cndmask_b32 v206, v182, v190, s[54:55]
    v_cndmask_b32 v207, v183, v191, s[54:55]
    s_waitcnt lgkmcnt(15)
    v_mfma_f32_32x32x16_bf16 v[16:31], v[108:111], v[84:87], v[16:31]
    ds_read_b64_tr_b16 v[84:85], v193 offset:36864
    ds_read_b64_tr_b16 v[86:87], v193 offset:38912
    s_waitcnt lgkmcnt(15)
    v_mfma_f32_32x32x16_bf16 v[32:47], v[108:111], v[88:91], v[32:47]
    ds_read_b64_tr_b16 v[88:89], v194 offset:36864
    ds_read_b64_tr_b16 v[90:91], v194 offset:38912
    s_waitcnt lgkmcnt(14)
    v_mfma_f32_32x32x16_bf16 v[48:63], v[108:111], v[92:95], v[48:63]
    ds_read_b64_tr_b16 v[92:93], v195 offset:36864
    ds_read_b64_tr_b16 v[94:95], v195 offset:38912
    s_waitcnt vmcnt(15)
    s_waitcnt lgkmcnt(14)
    v_mfma_f32_32x32x16_bf16 v[0:15], v[112:115], v[64:67], v[0:15]
    ds_read_b64_tr_b16 v[64:65], v192 offset:40960
    ds_read_b64_tr_b16 v[66:67], v192 offset:43008
    s_waitcnt lgkmcnt(14)
    v_mfma_f32_32x32x16_bf16 v[16:31], v[112:115], v[68:71], v[16:31]
    ds_read_b64_tr_b16 v[68:69], v193 offset:40960
    ds_read_b64_tr_b16 v[70:71], v193 offset:43008
    s_waitcnt lgkmcnt(14)
    v_mfma_f32_32x32x16_bf16 v[32:47], v[112:115], v[72:75], v[32:47]
    ds_read_b64_tr_b16 v[72:73], v194 offset:40960
    ds_read_b64_tr_b16 v[74:75], v194 offset:43008
    s_waitcnt lgkmcnt(14)
    v_mfma_f32_32x32x16_bf16 v[48:63], v[112:115], v[76:79], v[48:63]
    ds_read_b64_tr_b16 v[76:77], v195 offset:40960
    ds_read_b64_tr_b16 v[78:79], v195 offset:43008
    s_waitcnt vmcnt(14)
    s_waitcnt lgkmcnt(14)
    v_mfma_f32_32x32x16_bf16 v[0:15], v[116:119], v[80:83], v[0:15]
    ds_read_b64_tr_b16 v[80:81], v192 offset:45056
    ds_read_b64_tr_b16 v[82:83], v192 offset:47104
    s_waitcnt lgkmcnt(14)
    v_mfma_f32_32x32x16_bf16 v[16:31], v[116:119], v[84:87], v[16:31]
    ds_read_b64_tr_b16 v[84:85], v193 offset:45056
    ds_read_b64_tr_b16 v[86:87], v193 offset:47104
    s_waitcnt lgkmcnt(14)
    v_mfma_f32_32x32x16_bf16 v[32:47], v[116:119], v[88:91], v[32:47]
    ds_read_b64_tr_b16 v[88:89], v194 offset:45056
    ds_read_b64_tr_b16 v[90:91], v194 offset:47104
    s_waitcnt lgkmcnt(14)
    v_mfma_f32_32x32x16_bf16 v[48:63], v[116:119], v[92:95], v[48:63]
    ds_read_b64_tr_b16 v[92:93], v195 offset:45056
    ds_read_b64_tr_b16 v[94:95], v195 offset:47104
    s_waitcnt vmcnt(13)
    s_waitcnt lgkmcnt(14)
    v_mfma_f32_32x32x16_bf16 v[0:15], v[120:123], v[64:67], v[0:15]
    ds_read_b64_tr_b16 v[64:65], v192 offset:49152
    ds_read_b64_tr_b16 v[66:67], v192 offset:51200
    s_waitcnt lgkmcnt(14)
    v_mfma_f32_32x32x16_bf16 v[16:31], v[120:123], v[68:71], v[16:31]
    ds_read_b64_tr_b16 v[68:69], v192 offset:53248
    ds_read_b64_tr_b16 v[70:71], v192 offset:55296
    s_waitcnt lgkmcnt(14)
    v_mfma_f32_32x32x16_bf16 v[32:47], v[120:123], v[72:75], v[32:47]
    ds_read_b64_tr_b16 v[72:73], v192 offset:57344
    ds_read_b64_tr_b16 v[74:75], v192 offset:59392
    s_waitcnt lgkmcnt(14)
    v_mfma_f32_32x32x16_bf16 v[48:63], v[120:123], v[76:79], v[48:63]
    ds_read_b64_tr_b16 v[76:77], v192 offset:61440
    ds_read_b64_tr_b16 v[78:79], v192 offset:63488
    s_waitcnt vmcnt(12)
    s_waitcnt lgkmcnt(14)
    v_mfma_f32_32x32x16_bf16 v[0:15], v[124:127], v[80:83], v[0:15]
    v_add_u32 v192, 0x10000, v192
    ds_read_b64_tr_b16 v[80:81], v192 offset:0
    ds_read_b64_tr_b16 v[82:83], v192 offset:2048
    s_waitcnt lgkmcnt(14)
    v_mfma_f32_32x32x16_bf16 v[16:31], v[124:127], v[84:87], v[16:31]
    ds_read_b64_tr_b16 v[84:85], v192 offset:4096
    ds_read_b64_tr_b16 v[86:87], v192 offset:6144
    s_waitcnt lgkmcnt(14)
    v_mfma_f32_32x32x16_bf16 v[32:47], v[124:127], v[88:91], v[32:47]
    ds_read_b64_tr_b16 v[88:89], v192 offset:8192
    ds_read_b64_tr_b16 v[90:91], v192 offset:10240
    s_waitcnt lgkmcnt(14)
    v_mfma_f32_32x32x16_bf16 v[48:63], v[124:127], v[92:95], v[48:63]
    ds_read_b64_tr_b16 v[92:93], v192 offset:12288
    ds_read_b64_tr_b16 v[94:95], v192 offset:14336
    s_cmp_lg_u32 s16, 0
    s_cbranch_scc1 L_qkv_st_28
    v_lshrrev_b32 v224, 1, v255
    s_lshl_b32 s59, s12, 9
    v_add_u32 v225, s59, v224
    s_barrier
    ds_read_b64 v[176:177], v224 offset:0
    ds_read_b64 v[178:179], v224 offset:512
    ds_read_b64 v[180:181], v224 offset:1024
    ds_read_b64 v[182:183], v224 offset:1536
    ds_read_b64 v[184:185], v224 offset:2048
    ds_read_b64 v[186:187], v224 offset:2560
    ds_read_b64 v[188:189], v224 offset:3072
    ds_read_b64 v[190:191], v224 offset:3584
    s_waitcnt lgkmcnt(0)
    v_mov_b32 v200, v176
    v_mov_b32 v201, v177
    v_mov_b32 v202, v178
    v_mov_b32 v203, v179
    v_mov_b32 v204, v180
    v_mov_b32 v205, v181
    v_mov_b32 v206, v182
    v_mov_b32 v207, v183
    s_nop 1
L_qkv_st_28:
    s_mov_b32 s56, s8
    s_mov_b32 s57, s9
    s_cmp_ge_u32 s40, 5
    s_cselect_b32 s58, s10, 0
    s_mov_b32 s59, 0x00020000
    s_waitcnt vmcnt(11)
    s_waitcnt lgkmcnt(14)
    v_mfma_f32_32x32x16_bf16 v[0:15], v[128:131], v[64:67], v[0:15]
    ds_read_b64_tr_b16 v[64:65], v192 offset:16384
    ds_read_b64_tr_b16 v[66:67], v192 offset:18432
    s_waitcnt vmcnt(10)
    s_waitcnt lgkmcnt(14)
    v_mfma_f32_32x32x16_bf16 v[0:15], v[132:135], v[68:71], v[0:15]
    ds_read_b64_tr_b16 v[68:69], v192 offset:20480
    ds_read_b64_tr_b16 v[70:71], v192 offset:22528
    s_waitcnt vmcnt(9)
    s_waitcnt lgkmcnt(14)
    v_mfma_f32_32x32x16_bf16 v[0:15], v[136:139], v[72:75], v[0:15]
    ds_read_b64_tr_b16 v[72:73], v192 offset:24576
    ds_read_b64_tr_b16 v[74:75], v192 offset:26624
    s_waitcnt vmcnt(8)
    s_waitcnt lgkmcnt(14)
    v_mfma_f32_32x32x16_bf16 v[0:15], v[140:143], v[76:79], v[0:15]
    ds_read_b64_tr_b16 v[76:77], v192 offset:28672
    ds_read_b64_tr_b16 v[78:79], v192 offset:30720
    s_waitcnt vmcnt(7)
    s_waitcnt lgkmcnt(14)
    v_mfma_f32_32x32x16_bf16 v[0:15], v[144:147], v[80:83], v[0:15]
    ds_read_b64_tr_b16 v[80:81], v193 offset:49152
    ds_read_b64_tr_b16 v[82:83], v193 offset:51200
    s_waitcnt vmcnt(6)
    s_waitcnt lgkmcnt(14)
    v_mfma_f32_32x32x16_bf16 v[0:15], v[148:151], v[84:87], v[0:15]
    ds_read_b64_tr_b16 v[84:85], v193 offset:53248
    ds_read_b64_tr_b16 v[86:87], v193 offset:55296
    s_waitcnt vmcnt(5)
    s_waitcnt lgkmcnt(14)
    v_mfma_f32_32x32x16_bf16 v[0:15], v[152:155], v[88:91], v[0:15]
    ds_read_b64_tr_b16 v[88:89], v193 offset:57344
    ds_read_b64_tr_b16 v[90:91], v193 offset:59392
    s_waitcnt vmcnt(4)
    s_waitcnt lgkmcnt(14)
    v_mfma_f32_32x32x16_bf16 v[0:15], v[156:159], v[92:95], v[0:15]
    ds_read_b64_tr_b16 v[92:93], v193 offset:61440
    ds_read_b64_tr_b16 v[94:95], v193 offset:63488
    s_waitcnt vmcnt(3)
    s_waitcnt lgkmcnt(14)
    v_mfma_f32_32x32x16_bf16 v[0:15], v[160:163], v[64:67], v[0:15]
    v_add_u32 v193, 0x10000, v193
    ds_read_b64_tr_b16 v[64:65], v193 offset:0
    ds_read_b64_tr_b16 v[66:67], v193 offset:2048
    s_waitcnt vmcnt(2)
    s_waitcnt lgkmcnt(14)
    v_mfma_f32_32x32x16_bf16 v[0:15], v[164:167], v[68:71], v[0:15]
    ds_read_b64_tr_b16 v[68:69], v193 offset:4096
    ds_read_b64_tr_b16 v[70:71], v193 offset:6144
    s_waitcnt vmcnt(1)
    s_waitcnt lgkmcnt(14)
    v_mfma_f32_32x32x16_bf16 v[0:15], v[168:171], v[72:75], v[0:15]
    ds_read_b64_tr_b16 v[72:73], v193 offset:8192
    ds_read_b64_tr_b16 v[74:75], v193 offset:10240
    s_waitcnt vmcnt(0)
    s_waitcnt lgkmcnt(14)
    v_mfma_f32_32x32x16_bf16 v[0:15], v[172:175], v[76:79], v[0:15]
    ds_read_b64_tr_b16 v[76:77], v193 offset:12288
    ds_read_b64_tr_b16 v[78:79], v193 offset:14336
    v_mfma_f32_32x32x8_bf16 v[0:15], v[196:197], v[200:201], v[0:15]
    s_waitcnt lgkmcnt(14)
    v_mfma_f32_32x32x16_bf16 v[16:31], v[128:131], v[80:83], v[16:31]
    ds_read_b64_tr_b16 v[80:81], v193 offset:16384
    ds_read_b64_tr_b16 v[82:83], v193 offset:18432
    s_waitcnt lgkmcnt(14)
    v_mfma_f32_32x32x16_bf16 v[16:31], v[132:135], v[84:87], v[16:31]
    ds_read_b64_tr_b16 v[84:85], v193 offset:20480
    ds_read_b64_tr_b16 v[86:87], v193 offset:22528
    s_waitcnt lgkmcnt(14)
    v_mfma_f32_32x32x16_bf16 v[16:31], v[136:139], v[88:91], v[16:31]
    ds_read_b64_tr_b16 v[88:89], v193 offset:24576
    ds_read_b64_tr_b16 v[90:91], v193 offset:26624
    v_mul_f32 v0, v0, v208
    v_mul_f32 v1, v1, v209
    v_mul_f32 v2, v2, v210
    s_waitcnt lgkmcnt(14)
    v_mfma_f32_32x32x16_bf16 v[16:31], v[140:143], v[92:95], v[16:31]
    ds_read_b64_tr_b16 v[92:93], v193 offset:28672
    ds_read_b64_tr_b16 v[94:95], v193 offset:30720
    v_mul_f32 v3, v3, v211
    v_mul_f32 v4, v4, v212
    v_mul_f32 v5, v5, v213
    s_waitcnt lgkmcnt(14)
    v_mfma_f32_32x32x16_bf16 v[16:31], v[144:147], v[64:67], v[16:31]
    ds_read_b64_tr_b16 v[64:65], v194 offset:49152
    ds_read_b64_tr_b16 v[66:67], v194 offset:51200
    v_mul_f32 v6, v6, v214
    v_mul_f32 v7, v7, v215
    v_cvt_pk_bf16_f32 v0, v0, v1
    s_waitcnt lgkmcnt(14)
    v_mfma_f32_32x32x16_bf16 v[16:31], v[148:151], v[68:71], v[16:31]
    ds_read_b64_tr_b16 v[68:69], v194 offset:53248
    ds_read_b64_tr_b16 v[70:71], v194 offset:55296
    v_cvt_pk_bf16_f32 v1, v2, v3
    v_cvt_pk_bf16_f32 v2, v4, v5
    v_cvt_pk_bf16_f32 v3, v6, v7
    s_waitcnt lgkmcnt(14)
    v_mfma_f32_32x32x16_bf16 v[16:31], v[152:155], v[72:75], v[16:31]
    ds_read_b64_tr_b16 v[72:73], v194 offset:57344
    ds_read_b64_tr_b16 v[74:75], v194 offset:59392
    v_mul_f32 v8, v8, v216
    v_mul_f32 v9, v9, v217
    v_mul_f32 v10, v10, v218
    s_waitcnt lgkmcnt(14)
    v_mfma_f32_32x32x16_bf16 v[16:31], v[156:159], v[76:79], v[16:31]
    ds_read_b64_tr_b16 v[76:77], v194 offset:61440
    ds_read_b64_tr_b16 v[78:79], v194 offset:63488
    v_mul_f32 v11, v11, v219
    v_mul_f32 v12, v12, v220
    v_mul_f32 v13, v13, v221
    s_waitcnt lgkmcnt(14)
    v_mfma_f32_32x32x16_bf16 v[16:31], v[160:163], v[80:83], v[16:31]
    v_add_u32 v194, 0x10000, v194
    ds_read_b64_tr_b16 v[80:81], v194 offset:0
    ds_read_b64_tr_b16 v[82:83], v194 offset:2048
    v_mul_f32 v14, v14, v222
    v_mul_f32 v15, v15, v223
    v_cvt_pk_bf16_f32 v8, v8, v9
    s_waitcnt lgkmcnt(14)
    v_mfma_f32_32x32x16_bf16 v[16:31], v[164:167], v[84:87], v[16:31]
    ds_read_b64_tr_b16 v[84:85], v194 offset:4096
    ds_read_b64_tr_b16 v[86:87], v194 offset:6144
    v_cvt_pk_bf16_f32 v9, v10, v11
    v_cvt_pk_bf16_f32 v10, v12, v13
    v_cvt_pk_bf16_f32 v11, v14, v15
    s_waitcnt lgkmcnt(14)
    v_mfma_f32_32x32x16_bf16 v[16:31], v[168:171], v[88:91], v[16:31]
    ds_read_b64_tr_b16 v[88:89], v194 offset:8192
    ds_read_b64_tr_b16 v[90:91], v194 offset:10240
    buffer_store_dwordx4 v[0:3], v229, s[56:59], s49 offen offset:0 sc1
    buffer_store_dwordx4 v[8:11], v229, s[56:59], s50 offen offset:0 sc1
    buffer_store_dwordx4 v[0:3], v229, s[8:11], s47 offen offset:0
    s_waitcnt lgkmcnt(14)
    v_mfma_f32_32x32x16_bf16 v[16:31], v[172:175], v[92:95], v[16:31]
    ds_read_b64_tr_b16 v[92:93], v194 offset:12288
    ds_read_b64_tr_b16 v[94:95], v194 offset:14336
    buffer_store_dwordx4 v[8:11], v229, s[8:11], s48 offen offset:0
    v_mfma_f32_32x32x8_bf16 v[16:31], v[196:197], v[202:203], v[16:31]
    s_waitcnt lgkmcnt(14)
    v_mfma_f32_32x32x16_bf16 v[32:47], v[128:131], v[64:67], v[32:47]
    ds_read_b64_tr_b16 v[64:65], v194 offset:16384
    ds_read_b64_tr_b16 v[66:67], v194 offset:18432
    s_waitcnt lgkmcnt(14)
    v_mfma_f32_32x32x16_bf16 v[32:47], v[132:135], v[68:71], v[32:47]
    ds_read_b64_tr_b16 v[68:69], v194 offset:20480
    ds_read_b64_tr_b16 v[70:71], v194 offset:22528
    s_waitcnt lgkmcnt(14)
    v_mfma_f32_32x32x16_bf16 v[32:47], v[136:139], v[72:75], v[32:47]
    ds_read_b64_tr_b16 v[72:73], v194 offset:24576
    ds_read_b64_tr_b16 v[74:75], v194 offset:26624
    v_mul_f32 v16, v16, v208
    v_mul_f32 v17, v17, v209
    v_mul_f32 v18, v18, v210
    s_waitcnt lgkmcnt(14)
    v_mfma_f32_32x32x16_bf16 v[32:47], v[140:143], v[76:79], v[32:47]
    ds_read_b64_tr_b16 v[76:77], v194 offset:28672
    ds_read_b64_tr_b16 v[78:79], v194 offset:30720
    v_mul_f32 v19, v19, v211
    v_mul_f32 v20, v20, v212
    v_mul_f32 v21, v21, v213
    s_waitcnt lgkmcnt(14)
    v_mfma_f32_32x32x16_bf16 v[32:47], v[144:147], v[80:83], v[32:47]
    ds_read_b64_tr_b16 v[80:81], v195 offset:49152
    ds_read_b64_tr_b16 v[82:83], v195 offset:51200
    v_mul_f32 v22, v22, v214
    v_mul_f32 v23, v23, v215
    v_cvt_pk_bf16_f32 v16, v16, v17
    s_waitcnt lgkmcnt(14)
    v_mfma_f32_32x32x16_bf16 v[32:47], v[148:151], v[84:87], v[32:47]
    ds_read_b64_tr_b16 v[84:85], v195 offset:53248
    ds_read_b64_tr_b16 v[86:87], v195 offset:55296
    v_cvt_pk_bf16_f32 v17, v18, v19
    v_cvt_pk_bf16_f32 v18, v20, v21
    v_cvt_pk_bf16_f32 v19, v22, v23
    s_waitcnt lgkmcnt(14)
    v_mfma_f32_32x32x16_bf16 v[32:47], v[152:155], v[88:91], v[32:47]
    ds_read_b64_tr_b16 v[88:89], v195 offset:57344
    ds_read_b64_tr_b16 v[90:91], v195 offset:59392
    v_mul_f32 v24, v24, v216
    v_mul_f32 v25, v25, v217
    v_mul_f32 v26, v26, v218
    s_waitcnt lgkmcnt(14)
    v_mfma_f32_32x32x16_bf16 v[32:47], v[156:159], v[92:95], v[32:47]
    ds_read_b64_tr_b16 v[92:93], v195 offset:61440
    ds_read_b64_tr_b16 v[94:95], v195 offset:63488
    v_mul_f32 v27, v27, v219
    v_mul_f32 v28, v28, v220
    v_mul_f32 v29, v29, v221
    s_waitcnt lgkmcnt(14)
    v_mfma_f32_32x32x16_bf16 v[32:47], v[160:163], v[64:67], v[32:47]
    v_add_u32 v195, 0x10000, v195
    ds_read_b64_tr_b16 v[64:65], v195 offset:0
    ds_read_b64_tr_b16 v[66:67], v195 offset:2048
    v_mul_f32 v30, v30, v222
    v_mul_f32 v31, v31, v223
    v_cvt_pk_bf16_f32 v24, v24, v25
    s_waitcnt lgkmcnt(14)
    v_mfma_f32_32x32x16_bf16 v[32:47], v[164:167], v[68:71], v[32:47]
    ds_read_b64_tr_b16 v[68:69], v195 offset:4096
    ds_read_b64_tr_b16 v[70:71], v195 offset:6144
    v_cvt_pk_bf16_f32 v25, v26, v27
    v_cvt_pk_bf16_f32 v26, v28, v29
    v_cvt_pk_bf16_f32 v27, v30, v31
    s_waitcnt lgkmcnt(14)
    v_mfma_f32_32x32x16_bf16 v[32:47], v[168:171], v[72:75], v[32:47]
    ds_read_b64_tr_b16 v[72:73], v195 offset:8192
    ds_read_b64_tr_b16 v[74:75], v195 offset:10240
    buffer_store_dwordx4 v[16:19], v229, s[56:59], s49 offen offset:512 sc1
    buffer_store_dwordx4 v[24:27], v229, s[56:59], s50 offen offset:512 sc1
    buffer_store_dwordx4 v[16:19], v229, s[8:11], s47 offen offset:512
    s_waitcnt lgkmcnt(14)
    v_mfma_f32_32x32x16_bf16 v[32:47], v[172:175], v[76:79], v[32:47]
    ds_read_b64_tr_b16 v[76:77], v195 offset:12288
    ds_read_b64_tr_b16 v[78:79], v195 offset:14336
    buffer_store_dwordx4 v[24:27], v229, s[8:11], s48 offen offset:512
    v_mfma_f32_32x32x8_bf16 v[32:47], v[196:197], v[204:205], v[32:47]
    s_waitcnt lgkmcnt(14)
    v_mfma_f32_32x32x16_bf16 v[48:63], v[128:131], v[80:83], v[48:63]
    ds_read_b64_tr_b16 v[80:81], v195 offset:16384
    ds_read_b64_tr_b16 v[82:83], v195 offset:18432
    s_waitcnt lgkmcnt(14)
    v_mfma_f32_32x32x16_bf16 v[48:63], v[132:135], v[84:87], v[48:63]
    ds_read_b64_tr_b16 v[84:85], v195 offset:20480
    ds_read_b64_tr_b16 v[86:87], v195 offset:22528
    s_waitcnt lgkmcnt(14)
    v_mfma_f32_32x32x16_bf16 v[48:63], v[136:139], v[88:91], v[48:63]
    ds_read_b64_tr_b16 v[88:89], v195 offset:24576
    ds_read_b64_tr_b16 v[90:91], v195 offset:26624
    v_mul_f32 v32, v32, v208
    v_mul_f32 v33, v33, v209
    v_mul_f32 v34, v34, v210
    s_waitcnt lgkmcnt(14)
    v_mfma_f32_32x32x16_bf16 v[48:63], v[140:143], v[92:95], v[48:63]
    ds_read_b64_tr_b16 v[92:93], v195 offset:28672
    ds_read_b64_tr_b16 v[94:95], v195 offset:30720
    v_mul_f32 v35, v35, v211
    v_mul_f32 v36, v36, v212
    v_mul_f32 v37, v37, v213
    s_waitcnt lgkmcnt(14)
    v_mfma_f32_32x32x16_bf16 v[48:63], v[144:147], v[64:67], v[48:63]
    v_mul_f32 v38, v38, v214
    v_mul_f32 v39, v39, v215
    v_cvt_pk_bf16_f32 v32, v32, v33
    s_waitcnt lgkmcnt(12)
    v_mfma_f32_32x32x16_bf16 v[48:63], v[148:151], v[68:71], v[48:63]
    v_cvt_pk_bf16_f32 v33, v34, v35
    v_cvt_pk_bf16_f32 v34, v36, v37
    v_cvt_pk_bf16_f32 v35, v38, v39
    s_waitcnt lgkmcnt(10)
    v_mfma_f32_32x32x16_bf16 v[48:63], v[152:155], v[72:75], v[48:63]
    v_mul_f32 v40, v40, v216
    v_mul_f32 v41, v41, v217
    v_mul_f32 v42, v42, v218
    s_waitcnt lgkmcnt(8)
    v_mfma_f32_32x32x16_bf16 v[48:63], v[156:159], v[76:79], v[48:63]
    v_mul_f32 v43, v43, v219
    v_mul_f32 v44, v44, v220
    v_mul_f32 v45, v45, v221
    s_waitcnt lgkmcnt(6)
    v_mfma_f32_32x32x16_bf16 v[48:63], v[160:163], v[80:83], v[48:63]
    v_mul_f32 v46, v46, v222
    v_mul_f32 v47, v47, v223
    v_cvt_pk_bf16_f32 v40, v40, v41
    s_waitcnt lgkmcnt(4)
    v_mfma_f32_32x32x16_bf16 v[48:63], v[164:167], v[84:87], v[48:63]
    v_cvt_pk_bf16_f32 v41, v42, v43
    v_cvt_pk_bf16_f32 v42, v44, v45
    v_cvt_pk_bf16_f32 v43, v46, v47
    s_waitcnt lgkmcnt(2)
    v_mfma_f32_32x32x16_bf16 v[48:63], v[168:171], v[88:91], v[48:63]
    buffer_store_dwordx4 v[32:35], v229, s[56:59], s49 offen offset:1024 sc1
    buffer_store_dwordx4 v[40:43], v229, s[56:59], s50 offen offset:1024 sc1
    buffer_store_dwordx4 v[32:35], v229, s[8:11], s47 offen offset:1024
    s_waitcnt lgkmcnt(0)
    v_mfma_f32_32x32x16_bf16 v[48:63], v[172:175], v[92:95], v[48:63]
    buffer_store_dwordx4 v[40:43], v229, s[8:11], s48 offen offset:1024
    v_mfma_f32_32x32x8_bf16 v[48:63], v[196:197], v[206:207], v[48:63]
    s_nop 11
    v_pk_mul_f32 v[48:49], v[48:49], v[208:209]
    v_pk_mul_f32 v[50:51], v[50:51], v[210:211]
    v_pk_mul_f32 v[52:53], v[52:53], v[212:213]
    v_pk_mul_f32 v[54:55], v[54:55], v[214:215]
    v_cvt_pk_bf16_f32 v48, v48, v49
    v_cvt_pk_bf16_f32 v49, v50, v51
    v_cvt_pk_bf16_f32 v50, v52, v53
    v_cvt_pk_bf16_f32 v51, v54, v55
    v_pk_mul_f32 v[56:57], v[56:57], v[216:217]
    v_pk_mul_f32 v[58:59], v[58:59], v[218:219]
    v_pk_mul_f32 v[60:61], v[60:61], v[220:221]
    v_pk_mul_f32 v[62:63], v[62:63], v[222:223]
    v_cvt_pk_bf16_f32 v56, v56, v57
    v_cvt_pk_bf16_f32 v57, v58, v59
    v_cvt_pk_bf16_f32 v58, v60, v61
    v_cvt_pk_bf16_f32 v59, v62, v63
    buffer_store_dwordx4 v[48:51], v229, s[56:59], s49 offen offset:1536 sc1
    buffer_store_dwordx4 v[56:59], v229, s[56:59], s50 offen offset:1536 sc1
    buffer_store_dwordx4 v[48:51], v229, s[8:11], s47 offen offset:1536
    buffer_store_dwordx4 v[56:59], v229, s[8:11], s48 offen offset:1536
    s_branch L_qkv_done
L_qkv_idle:
    s_cmp_eq_u32 s16, 0
    s_cbranch_scc1 L_idle0_29
    s_branch L_qkv_done
L_idle0_29:
    s_branch L_qkv_done
L_qkv_help:
    s_cmp_eq_u32 s16, 0
    s_cbranch_scc1 L_h0_32
    s_waitcnt vmcnt(0)
    s_barrier
    ds_write_b128 v1, v[178:181] offset:36864
    ds_write_b128 v1, v[182:185] offset:40960
    ds_write_b128 v1, v[186:189] offset:45056
    ds_write_b128 v1, v[190:193] offset:49152
    ds_write_b128 v1, v[194:197] offset:53248
    ds_write_b128 v1, v[198:201] offset:57344
    ds_write_b128 v1, v[202:205] offset:61440
    ds_write_b128 v2, v[206:209] offset:0
    ds_write_b128 v2, v[210:213] offset:4096
    ds_write_b128 v2, v[214:217] offset:8192
    ds_write_b128 v2, v[218:221] offset:12288
    ds_write_b128 v2, v[222:225] offset:16384
    ds_write_b128 v2, v[226:229] offset:20480
    ds_write_b128 v2, v[230:233] offset:24576
    ds_write_b128 v2, v[234:237] offset:28672
    s_cmp_lg_u32 s16, 2
    s_cbranch_scc1 L_h1_34
    s_waitcnt lgkmcnt(0)
    s_bitcmp0_b32 s16, 0
    s_cselect_b32 s20, s26, s24
    s_cselect_b32 s21, s27, s25
    s_and_b32 s21, s21, 0xffff
    s_add_u32 s36, s61, 921600
    buffer_load_dwordx4 v[138:141], v244, s[20:23], s36 offen
    s_add_u32 s36, s61, 983040
    buffer_load_dwordx4 v[142:145], v244, s[20:23], s36 offen
    s_add_u32 s36, s61, 1044480
    buffer_load_dwordx4 v[146:149], v244, s[20:23], s36 offen
    s_add_u32 s36, s61, 1105920
    buffer_load_dwordx4 v[150:153], v244, s[20:23], s36 offen
    s_add_u32 s36, s61, 1167360
    buffer_load_dwordx4 v[154:157], v244, s[20:23], s36 offen
    s_add_u32 s36, s61, 1228800
    buffer_load_dwordx4 v[158:161], v244, s[20:23], s36 offen
    s_add_u32 s36, s61, 1290240
    buffer_load_dwordx4 v[162:165], v244, s[20:23], s36 offen
    s_add_u32 s36, s61, 1351680
    buffer_load_dwordx4 v[166:169], v244, s[20:23], s36 offen
    s_add_u32 s36, s61, 1413120
    buffer_load_dwordx4 v[170:173], v244, s[20:23], s36 offen
    s_add_u32 s36, s61, 1474560
    buffer_load_dwordx4 v[174:177], v244, s[20:23], s36 offen
    s_barrier
    s_branch L_h3_35
    s_branch L_h1_34
L_h0_32:
    s_waitcnt vmcnt(31)
    s_barrier
    s_bitcmp0_b32 s16, 0
    s_cselect_b32 s20, s26, s24
    s_cselect_b32 s21, s27, s25
    s_and_b32 s21, s21, 0xffff
    s_add_u32 s36, s61, 2396160
    buffer_load_dwordx4 v[234:237], v244, s[20:23], s36 offen
    s_add_u32 s36, s61, 2334720
    buffer_load_dwordx4 v[230:233], v244, s[20:23], s36 offen
    s_add_u32 s36, s61, 2273280
    buffer_load_dwordx4 v[226:229], v244, s[20:23], s36 offen
    s_add_u32 s36, s61, 2211840
    buffer_load_dwordx4 v[222:225], v244, s[20:23], s36 offen
    s_add_u32 s36, s61, 2150400
    buffer_load_dwordx4 v[218:221], v244, s[20:23], s36 offen
    s_add_u32 s36, s61, 2088960
    buffer_load_dwordx4 v[214:217], v244, s[20:23], s36 offen
    s_add_u32 s36, s61, 2027520
    buffer_load_dwordx4 v[210:213], v244, s[20:23], s36 offen
    s_add_u32 s36, s61, 1966080
    buffer_load_dwordx4 v[206:209], v244, s[20:23], s36 offen
    s_waitcnt vmcnt(8)
    s_barrier
    s_branch L_h2_36
L_h1_34:
    s_waitcnt vmcnt(0) lgkmcnt(0)
    s_barrier
L_h2_36:
L_h3_35:
    s_mul_i32 s36, s13, 656384
    s_add_u32 s36, s36, 0x794000
    s_mov_b32 s37, 82048
    v_and_b32 v242, 7, v254
    v_mul_lo_u32 v242, v242, s37
    buffer_load_dword v238, v242, s[8:11], s36 offen sc1
    s_bitcmp0_b32 s16, 0
    s_cselect_b32 s20, s26, s24
    s_cselect_b32 s21, s27, s25
    s_and_b32 s21, s21, 0xffff
    s_bitcmp1_b32 s16, 0
    s_cbranch_scc1 L_hodd_30
    s_cmp_eq_u32 s16, 0
    s_cbranch_scc1 L_hcs_33
    s_bitcmp1_b32 s14, 0
    s_cbranch_scc1 L_rev_31
L_rev_31:
    s_add_u32 s36, s61, 1536000
    buffer_load_dwordx4 v[178:181], v244, s[20:23], s36 offen
    s_add_u32 s36, s61, 1597440
    buffer_load_dwordx4 v[182:185], v244, s[20:23], s36 offen
    s_add_u32 s36, s61, 1658880
    buffer_load_dwordx4 v[186:189], v244, s[20:23], s36 offen
    s_add_u32 s36, s61, 1720320
    buffer_load_dwordx4 v[190:193], v244, s[20:23], s36 offen
    s_add_u32 s36, s61, 1781760
    buffer_load_dwordx4 v[194:197], v244, s[20:23], s36 offen
    s_add_u32 s36, s61, 1843200
    buffer_load_dwordx4 v[198:201], v244, s[20:23], s36 offen
    s_add_u32 s36, s61, 1904640
    buffer_load_dwordx4 v[202:205], v244, s[20:23], s36 offen
    s_add_u32 s36, s61, 1966080
    buffer_load_dwordx4 v[206:209], v244, s[20:23], s36 offen
    s_add_u32 s36, s61, 2027520
    buffer_load_dwordx4 v[210:213], v244, s[20:23], s36 offen
    s_waitcnt vmcnt(8)
    s_add_u32 s36, s61, 2088960
    buffer_load_dwordx4 v[214:217], v244, s[20:23], s36 offen
    s_waitcnt vmcnt(8)
    s_add_u32 s36, s61, 2150400
    buffer_load_dwordx4 v[218:221], v244, s[20:23], s36 offen
    s_waitcnt vmcnt(8)
    s_add_u32 s36, s61, 2211840
    buffer_load_dwordx4 v[222:225], v244, s[20:23], s36 offen
    s_waitcnt vmcnt(8)
    s_add_u32 s36, s61, 2273280
    buffer_load_dwordx4 v[226:229], v244, s[20:23], s36 offen
    s_waitcnt vmcnt(8)
    s_add_u32 s36, s61, 2334720
    buffer_load_dwordx4 v[230:233], v244, s[20:23], s36 offen
    s_waitcnt vmcnt(8)
    s_add_u32 s36, s61, 2396160
    buffer_load_dwordx4 v[234:237], v244, s[20:23], s36 offen
    s_waitcnt vmcnt(8)
    s_and_b32 s37, s14, 1
    s_lshl_b32 s37, s37, 2
    s_add_u32 s37, s37, s12
    s_sub_u32 s37, s37, 4
    s_mul_i32 s36, s37, 122880
    buffer_load_dword v238, v239, s[20:23], s36 offen
    s_branch L_qkv_done
L_hcs_33:
    s_lshr_b32 s39, s14, 1
    s_lshl_b32 s39, s39, 9
    s_lshr_b32 s40, s63, 3
    s_add_u32 s39, s39, s40
    s_add_u32 s39, s39, 0x1e10000
    s_lshl_b32 s40, s13, 1
    s_and_b32 s41, s14, 1
    s_add_u32 s40, s40, s41
    s_lshl_b32 s40, s40, 13
    s_lshl_b32 s41, s63, 1
    s_add_u32 s40, s40, s41
    s_add_u32 s40, s40, 0x1e30000
    v_lshl_add_u32 v0, v253, 15, v252
    v_lshlrev_b32 v1, 6, v254
    v_lshl_add_u32 v1, v253, 5, v1
    v_lshrrev_b32 v2, 1, v255
    s_lshr_b32 s41, s63, 1
    v_add_u32 v2, s41, v2
    s_lshr_b32 s58, s14, 1
    s_lshl_b32 s58, s58, 5
    s_add_u32 s58, s58, 0x1e50c00
    v_and_b32 v3, 7, v254
    v_lshlrev_b32 v3, 2, v3
    v_mul_u32_u24 v4, 480, v253
    v_add_u32 v3, v3, v4
    buffer_load_dword v240, v3, s[8:11], s58 offen sc1
    s_add_u32 s36, s61, 921600
    buffer_load_dwordx4 v[138:141], v244, s[20:23], s36 offen
    s_add_u32 s36, s61, 983040
    buffer_load_dwordx4 v[142:145], v244, s[20:23], s36 offen
    s_add_u32 s36, s61, 1044480
    buffer_load_dwordx4 v[146:149], v244, s[20:23], s36 offen
    s_add_u32 s36, s61, 1105920
    buffer_load_dwordx4 v[150:153], v244, s[20:23], s36 offen
    s_waitcnt vmcnt(4)
    v_cmp_eq_u32 vcc, 0, v240
    s_cbranch_vccz L_hs_d_38
    s_mov_b32 s37, 400000
L_hs_p_37:
    buffer_load_dword v240, v3, s[8:11], s58 offen sc1
    s_waitcnt vmcnt(0)
    v_cmp_eq_u32 vcc, 0, v240
    s_cbranch_vccz L_hs_d_38
    s_sub_u32 s37, s37, 1
    s_cmp_lg_u32 s37, 0
    s_cbranch_scc1 L_hs_p_37
L_hs_d_38:
    s_add_u32 s36, s39, 0
    buffer_load_dword v8, v0, s[8:11], s36 offen sc1
    s_add_u32 s36, s39, 8192
    buffer_load_dword v9, v0, s[8:11], s36 offen sc1
    s_add_u32 s36, s39, 16384
    buffer_load_dword v10, v0, s[8:11], s36 offen sc1
    s_add_u32 s36, s39, 24576
    buffer_load_dword v11, v0, s[8:11], s36 offen sc1
    s_add_u32 s36, s39, 65536
    buffer_load_dword v12, v0, s[8:11], s36 offen sc1
    s_add_u32 s36, s39, 73728
    buffer_load_dword v13, v0, s[8:11], s36 offen sc1
    s_add_u32 s36, s39, 81920
    buffer_load_dword v14, v0, s[8:11], s36 offen sc1
    s_add_u32 s36, s39, 90112
    buffer_load_dword v15, v0, s[8:11], s36 offen sc1
    s_add_u32 s36, s61, 1167360
    buffer_load_dwordx4 v[154:157], v244, s[20:23], s36 offen
    s_add_u32 s36, s61, 1228800
    buffer_load_dwordx4 v[158:161], v244, s[20:23], s36 offen
    s_add_u32 s36, s61, 1290240
    buffer_load_dwordx4 v[162:165], v244, s[20:23], s36 offen
    s_add_u32 s36, s61, 1351680
    buffer_load_dwordx4 v[166:169], v244, s[20:23], s36 offen
    s_add_u32 s36, s61, 1413120
    buffer_load_dwordx4 v[170:173], v244, s[20:23], s36 offen
    s_waitcnt vmcnt(16)
    s_add_u32 s36, s61, 1474560
    buffer_load_dwordx4 v[174:177], v244, s[20:23], s36 offen
    s_waitcnt vmcnt(16)
    s_add_u32 s36, s61, 1536000
    buffer_load_dwordx4 v[178:181], v244, s[20:23], s36 offen
    s_waitcnt vmcnt(16)
    s_add_u32 s36, s61, 1597440
    buffer_load_dwordx4 v[182:185], v244, s[20:23], s36 offen
    s_waitcnt vmcnt(16)
    s_add_u32 s36, s61, 1658880
    buffer_load_dwordx4 v[186:189], v244, s[20:23], s36 offen
    s_waitcnt vmcnt(8)
    s_add_u32 s36, s61, 1720320
    buffer_load_dwordx4 v[190:193], v244, s[20:23], s36 offen
    s_waitcnt vmcnt(8)
    s_add_u32 s36, s61, 1781760
    buffer_load_dwordx4 v[194:197], v244, s[20:23], s36 offen
    s_waitcnt vmcnt(8)
    s_add_u32 s36, s61, 1843200
    buffer_load_dwordx4 v[198:201], v244, s[20:23], s36 offen
    s_waitcnt vmcnt(8)
    s_add_u32 s36, s61, 1904640
    buffer_load_dwordx4 v[202:205], v244, s[20:23], s36 offen
    s_waitcnt vmcnt(8)
    v_add_f32 v8, v8, v9
    v_add_f32 v10, v10, v11
    v_add_f32 v8, v8, v10
    v_mov_b32 v9, v8
    v_add_f32 v12, v12, v13
    v_add_f32 v14, v14, v15
    v_add_f32 v12, v12, v14
    v_mov_b32 v13, v12
    s_nop 1
    v_permlane32_swap_b32 v8, v9
    v_permlane32_swap_b32 v12, v13
    v_add_f32 v8, v8, v9
    v_and_b32 v10, s31, v8
    v_sub_f32 v11, v8, v10
    v_and_b32 v33, s31, v11
    v_perm_b32 v32, v33, v10, s30
    v_sub_f32 v11, v11, v33
    v_lshrrev_b32 v33, 16, v11
    v_add_f32 v12, v12, v13
    v_and_b32 v14, s31, v12
    v_sub_f32 v15, v12, v14
    v_and_b32 v35, s31, v15
    v_perm_b32 v34, v35, v14, s30
    v_sub_f32 v15, v15, v35
    v_lshrrev_b32 v35, 16, v15
    ds_write_b64 v2, v[32:33]
    ds_write_b64 v2, v[34:35] offset:2048
    s_waitcnt lgkmcnt(0)
    s_barrier
    s_and_b32 s37, s14, 1
    s_lshl_b32 s37, s37, 2
    s_add_u32 s37, s37, s12
    s_sub_u32 s37, s37, 4
    s_mul_i32 s36, s37, 122880
    buffer_load_dword v238, v239, s[20:23], s36 offen
    s_branch L_qkv_done
L_hodd_30:
    s_barrier
    s_cmp_eq_u32 s16, 3
    s_cbranch_scc1 L_qkv_done
    s_add_u32 s36, s61, 921600
    buffer_load_dwordx4 v[138:141], v244, s[20:23], s36 offen
    s_add_u32 s36, s61, 983040
    buffer_load_dwordx4 v[142:145], v244, s[20:23], s36 offen
    s_add_u32 s36, s61, 1044480
    buffer_load_dwordx4 v[146:149], v244, s[20:23], s36 offen
    s_add_u32 s36, s61, 1105920
    buffer_load_dwordx4 v[150:153], v244, s[20:23], s36 offen
    s_add_u32 s36, s61, 1167360
    buffer_load_dwordx4 v[154:157], v244, s[20:23], s36 offen
    s_add_u32 s36, s61, 1228800
    buffer_load_dwordx4 v[158:161], v244, s[20:23], s36 offen
    s_add_u32 s36, s61, 1290240
    buffer_load_dwordx4 v[162:165], v244, s[20:23], s36 offen
    s_add_u32 s36, s61, 1351680
    buffer_load_dwordx4 v[166:169], v244, s[20:23], s36 offen
    s_add_u32 s36, s61, 1413120
    buffer_load_dwordx4 v[170:173], v244, s[20:23], s36 offen
    s_add_u32 s36, s61, 1474560
    buffer_load_dwordx4 v[174:177], v244, s[20:23], s36 offen
    s_add_u32 s36, s61, 1536000
    buffer_load_dwordx4 v[178:181], v244, s[20:23], s36 offen
    s_add_u32 s36, s61, 1597440
    buffer_load_dwordx4 v[182:185], v244, s[20:23], s36 offen
    s_add_u32 s36, s61, 1658880
    buffer_load_dwordx4 v[186:189], v244, s[20:23], s36 offen
    s_add_u32 s36, s61, 1720320
    buffer_load_dwordx4 v[190:193], v244, s[20:23], s36 offen
    s_add_u32 s36, s61, 1781760
    buffer_load_dwordx4 v[194:197], v244, s[20:23], s36 offen
L_qkv_done:
    s_cmp_eq_u32 s16, 3
    s_cselect_b32 s22, 0, s22
    s_bitcmp0_b32 s16, 0
    s_cselect_b32 s20, s26, s24
    s_cselect_b32 s21, s27, s25
    s_and_b32 s21, s21, 0xffff
    s_and_b32 s62, s16, 1
    s_mul_i32 s62, s62, 819200
    s_add_u32 s62, s62, 0x1c80000
    s_lshr_b32 s36, s14, 2
    s_mul_i32 s36, s36, 102400
    s_add_u32 s62, s62, s36
    s_bitcmp1_b32 s16, 0
    s_cbranch_scc1 L_attf
L_atts:
    s_lshl_b32 s39, s13, 3
    s_add_u32 s39, s39, s12
    s_mul_i32 s40, s39, 40960
    s_add_u32 s40, s40, 0x280000
    s_mul_i32 s41, s12, 3072
    s_mul_i32 s45, s39, 82048
    s_add_u32 s45, s45, 0x780000
    s_add_u32 s57, s16, 2
    s_lshl_b32 s36, s12, 10
    s_add_u32 s58, s36, 76800
    s_add_u32 s59, s36, s62
    v_mov_b32 v32, 0
    v_mov_b32 v33, 0
    v_mov_b32 v34, 0
    v_mov_b32 v35, 0
    v_mov_b32 v36, 0
    v_mov_b32 v37, 0
    v_mov_b32 v38, 0
    v_mov_b32 v39, 0
    v_mov_b32 v40, 0
    v_mov_b32 v41, 0
    v_mov_b32 v42, 0
    v_mov_b32 v43, 0
    v_mov_b32 v44, 0
    v_mov_b32 v45, 0
    v_mov_b32 v46, 0
    v_mov_b32 v47, 0
    s_sub_u32 s47, s45, 0x820400
    s_add_u32 s56, s13, 7
    s_and_b32 s56, s56, 7
    s_lshl_b32 s56, s56, 7
    s_add_u32 s56, s56, 0x1e50400
    v_add_u32 v92, s47, v249
    v_add_u32 v93, s47, v250
    v_add_u32 v94, s47, v251
    v_add_u32 v76, s41, v255
    v_add_u32 v77, s41, v246
    v_add_u32 v78, s41, v247
    v_add_u32 v79, s41, v248
    v_mov_b32 v88, 0
    v_mov_b32 v89, 0xf149f2ca
    v_lshlrev_b32 v90, 2, v253
    v_sub_u32 v90, v254, v90
    v_cmp_le_i32 s[48:49], 0, v90
    v_cmp_le_i32 s[50:51], 1, v90
    v_cmp_le_i32 s[52:53], 2, v90
    v_cmp_le_i32 s[54:55], 3, v90
    v_cndmask_b32 v100, v89, v88, s[48:49]
    v_cndmask_b32 v116, v88, v89, s[48:49]
    v_cndmask_b32 v101, v89, v88, s[50:51]
    v_cndmask_b32 v117, v88, v89, s[50:51]
    v_cndmask_b32 v102, v89, v88, s[52:53]
    v_cndmask_b32 v118, v88, v89, s[52:53]
    v_cndmask_b32 v103, v89, v88, s[54:55]
    v_cndmask_b32 v119, v88, v89, s[54:55]
    v_cmp_le_i32 s[48:49], 8, v90
    v_cmp_le_i32 s[50:51], 9, v90
    v_cmp_le_i32 s[52:53], 10, v90
    v_cmp_le_i32 s[54:55], 11, v90
    v_cndmask_b32 v104, v89, v88, s[48:49]
    v_cndmask_b32 v120, v88, v89, s[48:49]
    v_cndmask_b32 v105, v89, v88, s[50:51]
    v_cndmask_b32 v121, v88, v89, s[50:51]
    v_cndmask_b32 v106, v89, v88, s[52:53]
    v_cndmask_b32 v122, v88, v89, s[52:53]
    v_cndmask_b32 v107, v89, v88, s[54:55]
    v_cndmask_b32 v123, v88, v89, s[54:55]
    v_cmp_le_i32 s[48:49], 16, v90
    v_cmp_le_i32 s[50:51], 17, v90
    v_cmp_le_i32 s[52:53], 18, v90
    v_cmp_le_i32 s[54:55], 19, v90
    v_cndmask_b32 v108, v89, v88, s[48:49]
    v_cndmask_b32 v124, v88, v89, s[48:49]
    v_cndmask_b32 v109, v89, v88, s[50:51]
    v_cndmask_b32 v125, v88, v89, s[50:51]
    v_cndmask_b32 v110, v89, v88, s[52:53]
    v_cndmask_b32 v126, v88, v89, s[52:53]
    v_cndmask_b32 v111, v89, v88, s[54:55]
    v_cndmask_b32 v127, v88, v89, s[54:55]
    v_cmp_le_i32 s[48:49], 24, v90
    v_cmp_le_i32 s[50:51], 25, v90
    v_cmp_le_i32 s[52:53], 26, v90
    v_cmp_le_i32 s[54:55], 27, v90
    v_cndmask_b32 v112, v89, v88, s[48:49]
    v_cndmask_b32 v128, v88, v89, s[48:49]
    v_cndmask_b32 v113, v89, v88, s[50:51]
    v_cndmask_b32 v129, v88, v89, s[50:51]
    v_cndmask_b32 v114, v89, v88, s[52:53]
    v_cndmask_b32 v130, v88, v89, s[52:53]
    v_cndmask_b32 v115, v89, v88, s[54:55]
    v_cndmask_b32 v131, v88, v89, s[54:55]
    s_lshl_b32 s52, s13, 4
    s_and_b32 s53, s14, 3
    s_lshl_b32 s53, s53, 2
    s_add_u32 s52, s52, s53
    s_add_u32 s52, s52, s12
    s_and_b32 s54, s52, 1
    s_lshl_b32 s54, s54, 8
    s_lshr_b32 s52, s52, 1
    s_mul_i32 s52, s52, 40960
    s_lshr_b32 s53, s14, 2
    s_mul_i32 s53, s53, 5120
    s_add_u32 s52, s52, s53
    s_add_u32 s52, s52, s54
    s_add_u32 s52, s52, 0x0
    v_bfe_u32 v240, v255, 8, 1
    v_lshlrev_b32 v137, 9, v240
    v_and_b32 v240, 0xf0, v255
    v_add_u32 v137, v137, v240
    v_lshl_add_u32 v137, v253, 3, v137
    s_cmp_lg_u32 s16, 0
    s_cbranch_scc1 L_as_m_41
    s_cmp_lg_u32 s12, 4
    s_cbranch_scc1 L_as_m_41
    s_add_u32 s36, s18, 0x800
    s_mov_b32 s37, 400000
L_m4_p_43:
    buffer_load_dword v240, v252, s[8:11], s36 offen sc1
    s_waitcnt vmcnt(0)
    v_cmp_eq_u32 vcc, 0, v240
    s_cbranch_vccz L_m4_d_44
    s_sub_u32 s37, s37, 1
    s_cmp_lg_u32 s37, 0
    s_cbranch_scc1 L_m4_p_43
L_m4_d_44:
    s_add_u32 s36, s3, 1
    v_cmp_ne_u32 vcc, s36, v240
    s_cmp_lg_u64 vcc, 0
    s_cselect_b32 s15, 1, 0
    s_mov_b32 s36, 0x1e50478
    v_and_b32 v242, 7, v254
    v_lshlrev_b32 v242, 7, v242
    s_mov_b32 s37, 400000
L_as4b_p_46:
    buffer_load_dwordx2 v[240:241], v242, s[8:11], s36 offen sc1
    s_waitcnt vmcnt(0)
    v_min_u32 v240, v240, v241
    v_cmp_eq_u32 vcc, 0, v240
    s_cbranch_vccz L_as4b_d_47
    s_sub_u32 s37, s37, 1
    s_cmp_lg_u32 s37, 0
    s_cbranch_scc1 L_as4b_p_46
L_as4b_d_47:
L_as_m_41:
    s_cmp_ge_u32 s12, 4
    s_cbranch_scc1 L_as_c_42
    s_waitcnt vmcnt(0)
L_as_c_42:
    s_add_u32 s17, s17, 1
    s_barrier
    s_cmp_lg_u32 s12, 4
    s_cbranch_scc1 L_as_t_sk_49
    s_mov_b64 exec, 1
    v_mov_b32 v240, s17
    v_mov_b32 v241, s19
    s_cmp_lg_u32 s15, 0
    s_cbranch_scc1 L_as_t_sf_50
    buffer_store_dword v240, v241, s[8:11], 0 offen
    s_branch L_as_t_g_51
L_as_t_sf_50:
    buffer_wbl2 sc1
    s_waitcnt vmcnt(0)
    buffer_store_dword v240, v241, s[8:11], 0 offen sc1
L_as_t_g_51:
    s_mov_b64 exec, -1
L_as_t_sk_49:
    s_mov_b32 s48, 0
    s_cmp_lg_u32 s12, 7
    s_cbranch_scc1 L_as_w_40
    s_mov_b32 s37, 400000
L_as_p_52:
    buffer_load_dword v240, v252, s[8:11], s18 offen sc1
    s_waitcnt vmcnt(0)
    v_cmp_gt_u32 vcc, s17, v240
    s_cbranch_vccz L_as_d_53
    s_sub_u32 s37, s37, 1
    s_cmp_lg_u32 s37, 0
    s_cbranch_scc1 L_as_p_52
L_as_d_53:
    s_cmp_lg_u32 s14, 31
    s_cbranch_scc1 L_as_w_40
    s_lshl_b32 s36, s13, 7
    s_add_u32 s36, s36, 0x1e50400
    v_mov_b32 v240, s57
    s_mov_b64 exec, 1
    buffer_store_dword v240, off, s[8:11], s36 sc1
    s_mov_b64 exec, -1
L_as_w_40:
    s_cmp_lg_u32 s12, 6
    s_cbranch_scc1 L_as_r_55
    s_cmp_eq_u32 s13, 0
    s_cbranch_scc1 L_as_r_55
    s_mov_b32 s37, 400000
L_as_rf_p_56:
    buffer_load_dword v136, off, s[8:11], s56 sc1
    s_waitcnt vmcnt(0)
    v_cmp_gt_u32 vcc, s57, v136
    s_cbranch_vccz L_as_rf_d_57
    s_sub_u32 s37, s37, 1
    s_cmp_lg_u32 s37, 0
    s_cbranch_scc1 L_as_rf_p_56
L_as_rf_d_57:
L_as_r_55:
    s_barrier
    buffer_load_dwordx4 v[64:67], v249, s[8:11], s40 offen sc1
    buffer_load_dwordx2 v[62:63], v245, s[8:11], s40 offen sc1
    s_add_u32 m0, s41, 24576
    s_nop 0
    buffer_load_dwordx4 v249, s[8:11], s45 offen offset:0 sc1 lds
    buffer_load_dwordx4 v250, s[8:11], s45 offen offset:1024 sc1 lds
    buffer_load_dwordx4 v251, s[8:11], s45 offen offset:2048 sc1 lds
    s_mov_b32 m0, s41
    s_nop 0
    buffer_load_dwordx4 v92, s[32:35], 0 offen offset:0 sc1 lds
    buffer_load_dwordx4 v93, s[32:35], 0 offen offset:1024 sc1 lds
    buffer_load_dwordx4 v94, s[32:35], 0 offen offset:2048 sc1 lds
    s_waitcnt vmcnt(6)
    v_mov_b32 v80, 0
    v_cndmask_b32 v62, v80, v62, s[28:29]
    v_cndmask_b32 v63, v80, v63, s[28:29]
    s_waitcnt vmcnt(3)
    ds_read_b128 v[56:59], v76 offset:24576
    ds_read_b64 v[60:61], v77 offset:24576
    s_waitcnt lgkmcnt(0)
    v_mfma_f32_32x32x16_bf16 v[16:31], v[56:59], v[64:67], v[100:115]
    v_mfma_f32_32x32x8_bf16 v[16:31], v[60:61], v[62:63], v[16:31]
    v_mfma_f32_32x32x16_bf16 v[0:15], v[56:59], v[64:67], v[100:115]
    s_nop 10
    v_max3_f32 v80, v16, v17, v18
    v_max3_f32 v80, v80, v19, v20
    v_max3_f32 v80, v80, v21, v22
    v_max3_f32 v80, v80, v23, v24
    v_max3_f32 v80, v80, v25, v26
    v_max3_f32 v80, v80, v27, v28
    v_max3_f32 v80, v80, v29, v30
    v_max_f32 v80, v80, v31
    v_mov_b32 v81, v80
    s_nop 1
    v_permlane32_swap_b32 v80, v81
    s_nop 1
    v_max_f32 v80, v80, v81
    v_sub_f32 v80, 0, v80
    v_and_b32 v84, s31, v80
    v_sub_f32 v85, v80, v84
    v_and_b32 v83, s31, v85
    v_perm_b32 v82, v83, v84, s30
    v_sub_f32 v85, v85, v83
    v_lshrrev_b32 v83, 16, v85
    v_cndmask_b32 v62, v82, v62, s[28:29]
    v_cndmask_b32 v63, v83, v63, s[28:29]
    s_nop 1
    v_mfma_f32_32x32x8_bf16 v[0:15], v[60:61], v[62:63], v[0:15]
    s_waitcnt vmcnt(0)
    s_barrier
    ds_read_b128 v[56:59], v76 offset:21504
    ds_read_b64 v[60:61], v77 offset:21504
    ds_read_b128 v[68:71], v78 offset:24576
    s_setprio 3
    s_add_u32 m0, s58, 0
    s_add_u32 s36, s59, 0
    buffer_load_dwordx4 v255, s[8:11], s36 offen lds
    s_waitcnt lgkmcnt(2)
    v_mfma_f32_32x32x16_bf16 v[16:31], v[56:59], v[64:67], 0
    ds_read_b128 v[56:59], v76 offset:18432
    v_exp_f32 v0, v0
    v_exp_f32 v1, v1
    v_exp_f32 v2, v2
    v_exp_f32 v3, v3
    v_cvt_pk_bf16_f32 v48, v0, v1
    v_cvt_pk_bf16_f32 v49, v2, v3
    s_waitcnt lgkmcnt(2)
    v_mfma_f32_32x32x8_bf16 v[16:31], v[60:61], v[62:63], v[16:31]
    ds_read_b64 v[60:61], v77 offset:18432
    v_exp_f32 v4, v4
    v_exp_f32 v5, v5
    v_exp_f32 v6, v6
    v_exp_f32 v7, v7
    v_cvt_pk_bf16_f32 v50, v4, v5
    v_cvt_pk_bf16_f32 v51, v6, v7
    ds_read_b128 v[72:75], v79 offset:24576
    s_add_u32 m0, s58, 8192
    s_add_u32 s36, s59, 8192
    buffer_load_dwordx4 v255, s[8:11], s36 offen lds
    v_exp_f32 v8, v8
    v_exp_f32 v9, v9
    v_exp_f32 v10, v10
    v_exp_f32 v11, v11
    v_cvt_pk_bf16_f32 v52, v8, v9
    v_cvt_pk_bf16_f32 v53, v10, v11
    s_cmp_ge_u32 s12, 4
    s_cbranch_scc1 L_b2h_59
    s_lshl_b32 s36, s12, 12
    s_add_u32 s36, s36, s62
    s_add_u32 s36, s36, 87040
    v_lshlrev_b32 v242, 7, v254
    buffer_load_dword v238, v242, s[8:11], s36 offen
    s_branch L_b2e_60
L_b2h_59:
L_b2e_60:
    s_waitcnt lgkmcnt(3)
    v_mfma_f32_32x32x16_bf16 v[32:47], v[68:71], v[48:51], v[32:47]
    ds_read_b128 v[68:71], v78 offset:21504
    v_exp_f32 v12, v12
    v_exp_f32 v13, v13
    v_exp_f32 v14, v14
    v_exp_f32 v15, v15
    v_cvt_pk_bf16_f32 v54, v12, v13
    v_cvt_pk_bf16_f32 v55, v14, v15
    s_add_u32 m0, s58, 16384
    s_add_u32 s36, s59, 16384
    buffer_load_dwordx4 v255, s[8:11], s36 offen lds
    s_waitcnt lgkmcnt(3)
    v_mfma_f32_32x32x16_bf16 v[0:15], v[56:59], v[64:67], 0
    ds_read_b128 v[56:59], v76 offset:15360
    v_exp_f32 v16, v16
    v_exp_f32 v17, v17
    v_exp_f32 v18, v18
    v_exp_f32 v19, v19
    v_cvt_pk_bf16_f32 v48, v16, v17
    v_cvt_pk_bf16_f32 v49, v18, v19
    s_waitcnt lgkmcnt(3)
    v_mfma_f32_32x32x8_bf16 v[0:15], v[60:61], v[62:63], v[0:15]
    ds_read_b64 v[60:61], v77 offset:15360
    v_exp_f32 v20, v20
    v_exp_f32 v21, v21
    v_exp_f32 v22, v22
    v_exp_f32 v23, v23
    v_cvt_pk_bf16_f32 v50, v20, v21
    v_cvt_pk_bf16_f32 v51, v22, v23
    s_waitcnt lgkmcnt(3)
    v_mfma_f32_32x32x16_bf16 v[32:47], v[72:75], v[52:55], v[32:47]
    ds_read_b128 v[72:75], v79 offset:21504
    s_add_u32 m0, s58, 24576
    s_add_u32 s36, s59, 24576
    buffer_load_dwordx4 v255, s[8:11], s36 offen lds
    v_exp_f32 v24, v24
    v_exp_f32 v25, v25
    v_exp_f32 v26, v26
    v_exp_f32 v27, v27
    v_cvt_pk_bf16_f32 v52, v24, v25
    v_cvt_pk_bf16_f32 v53, v26, v27
    s_cmp_ge_u32 s12, 4
    s_cbranch_scc1 L_b2h_61
    s_add_u32 s36, s52, 0
    buffer_load_dwordx2 v[138:139], v137, s[8:11], s36 offen sc1
    s_branch L_b2e_62
L_b2h_61:
L_b2e_62:
    s_waitcnt lgkmcnt(3)
    v_mfma_f32_32x32x16_bf16 v[32:47], v[68:71], v[48:51], v[32:47]
    ds_read_b128 v[68:71], v78 offset:18432
    v_exp_f32 v28, v28
    v_exp_f32 v29, v29
    v_exp_f32 v30, v30
    v_exp_f32 v31, v31
    v_cvt_pk_bf16_f32 v54, v28, v29
    v_cvt_pk_bf16_f32 v55, v30, v31
    s_add_u32 m0, s58, 32768
    s_add_u32 s36, s59, 32768
    buffer_load_dwordx4 v255, s[8:11], s36 offen lds
    s_waitcnt lgkmcnt(3)
    v_mfma_f32_32x32x16_bf16 v[16:31], v[56:59], v[64:67], 0
    ds_read_b128 v[56:59], v76 offset:12288
    v_exp_f32 v0, v0
    v_exp_f32 v1, v1
    v_exp_f32 v2, v2
    v_exp_f32 v3, v3
    v_cvt_pk_bf16_f32 v48, v0, v1
    v_cvt_pk_bf16_f32 v49, v2, v3
    s_waitcnt lgkmcnt(3)
    v_mfma_f32_32x32x8_bf16 v[16:31], v[60:61], v[62:63], v[16:31]
    ds_read_b64 v[60:61], v77 offset:12288
    v_exp_f32 v4, v4
    v_exp_f32 v5, v5
    v_exp_f32 v6, v6
    v_exp_f32 v7, v7
    v_cvt_pk_bf16_f32 v50, v4, v5
    v_cvt_pk_bf16_f32 v51, v6, v7
    s_waitcnt lgkmcnt(3)
    v_mfma_f32_32x32x16_bf16 v[32:47], v[72:75], v[52:55], v[32:47]
    ds_read_b128 v[72:75], v79 offset:18432
    s_add_u32 m0, s58, 40960
    s_add_u32 s36, s59, 40960
    buffer_load_dwordx4 v255, s[8:11], s36 offen lds
    v_exp_f32 v8, v8
    v_exp_f32 v9, v9
    v_exp_f32 v10, v10
    v_exp_f32 v11, v11
    v_cvt_pk_bf16_f32 v52, v8, v9
    v_cvt_pk_bf16_f32 v53, v10, v11
    s_cmp_ge_u32 s12, 4
    s_cbranch_scc1 L_b2h_63
    s_add_u32 s36, s52, 1024
    buffer_load_dwordx2 v[140:141], v137, s[8:11], s36 offen sc1
    s_branch L_b2e_64
L_b2h_63:
L_b2e_64:
    s_waitcnt lgkmcnt(3)
    v_mfma_f32_32x32x16_bf16 v[32:47], v[68:71], v[48:51], v[32:47]
    ds_read_b128 v[68:71], v78 offset:15360
    v_exp_f32 v12, v12
    v_exp_f32 v13, v13
    v_exp_f32 v14, v14
    v_exp_f32 v15, v15
    v_cvt_pk_bf16_f32 v54, v12, v13
    v_cvt_pk_bf16_f32 v55, v14, v15
    s_add_u32 m0, s58, 49152
    s_add_u32 s36, s59, 49152
    buffer_load_dwordx4 v255, s[8:11], s36 offen lds
    s_waitcnt lgkmcnt(3)
    v_mfma_f32_32x32x16_bf16 v[0:15], v[56:59], v[64:67], 0
    ds_read_b128 v[56:59], v76 offset:9216
    v_exp_f32 v16, v16
    v_exp_f32 v17, v17
    v_exp_f32 v18, v18
    v_exp_f32 v19, v19
    v_cvt_pk_bf16_f32 v48, v16, v17
    v_cvt_pk_bf16_f32 v49, v18, v19
    s_waitcnt lgkmcnt(3)
    v_mfma_f32_32x32x8_bf16 v[0:15], v[60:61], v[62:63], v[0:15]
    ds_read_b64 v[60:61], v77 offset:9216
    v_exp_f32 v20, v20
    v_exp_f32 v21, v21
    v_exp_f32 v22, v22
    v_exp_f32 v23, v23
    v_cvt_pk_bf16_f32 v50, v20, v21
    v_cvt_pk_bf16_f32 v51, v22, v23
    s_waitcnt lgkmcnt(3)
    v_mfma_f32_32x32x16_bf16 v[32:47], v[72:75], v[52:55], v[32:47]
    ds_read_b128 v[72:75], v79 offset:15360
    s_add_u32 m0, s58, 57344
    s_add_u32 s36, s59, 57344
    buffer_load_dwordx4 v255, s[8:11], s36 offen lds
    v_exp_f32 v24, v24
    v_exp_f32 v25, v25
    v_exp_f32 v26, v26
    v_exp_f32 v27, v27
    v_cvt_pk_bf16_f32 v52, v24, v25
    v_cvt_pk_bf16_f32 v53, v26, v27
    s_cmp_ge_u32 s12, 4
    s_cbranch_scc1 L_b2h_65
    s_add_u32 s36, s52, 2048
    buffer_load_dwordx2 v[142:143], v137, s[8:11], s36 offen sc1
    s_branch L_b2e_66
L_b2h_65:
L_b2e_66:
    s_waitcnt lgkmcnt(3)
    v_mfma_f32_32x32x16_bf16 v[32:47], v[68:71], v[48:51], v[32:47]
    ds_read_b128 v[68:71], v78 offset:12288
    v_exp_f32 v28, v28
    v_exp_f32 v29, v29
    v_exp_f32 v30, v30
    v_exp_f32 v31, v31
    v_cvt_pk_bf16_f32 v54, v28, v29
    v_cvt_pk_bf16_f32 v55, v30, v31
    s_setprio 2
    s_add_u32 m0, s58, 65536
    s_add_u32 s36, s59, 65536
    buffer_load_dwordx4 v255, s[8:11], s36 offen lds
    s_waitcnt lgkmcnt(3)
    v_mfma_f32_32x32x16_bf16 v[16:31], v[56:59], v[64:67], 0
    ds_read_b128 v[56:59], v76 offset:6144
    v_exp_f32 v0, v0
    v_exp_f32 v1, v1
    v_exp_f32 v2, v2
    v_exp_f32 v3, v3
    v_cvt_pk_bf16_f32 v48, v0, v1
    v_cvt_pk_bf16_f32 v49, v2, v3
    s_waitcnt lgkmcnt(3)
    v_mfma_f32_32x32x8_bf16 v[16:31], v[60:61], v[62:63], v[16:31]
    ds_read_b64 v[60:61], v77 offset:6144
    v_exp_f32 v4, v4
    v_exp_f32 v5, v5
    v_exp_f32 v6, v6
    v_exp_f32 v7, v7
    v_cvt_pk_bf16_f32 v50, v4, v5
    v_cvt_pk_bf16_f32 v51, v6, v7
    s_waitcnt lgkmcnt(3)
    v_mfma_f32_32x32x16_bf16 v[32:47], v[72:75], v[52:55], v[32:47]
    ds_read_b128 v[72:75], v79 offset:12288
    s_add_u32 m0, s58, 73728
    s_add_u32 s36, s59, 73728
    buffer_load_dwordx4 v255, s[8:11], s36 offen lds
    v_exp_f32 v8, v8
    v_exp_f32 v9, v9
    v_exp_f32 v10, v10
    v_exp_f32 v11, v11
    v_cvt_pk_bf16_f32 v52, v8, v9
    v_cvt_pk_bf16_f32 v53, v10, v11
    s_cmp_ge_u32 s12, 4
    s_cbranch_scc1 L_b2h_67
    s_add_u32 s36, s52, 3072
    buffer_load_dwordx2 v[144:145], v137, s[8:11], s36 offen sc1
    s_branch L_b2e_68
L_b2h_67:
L_b2e_68:
    s_waitcnt lgkmcnt(3)
    v_mfma_f32_32x32x16_bf16 v[32:47], v[68:71], v[48:51], v[32:47]
    ds_read_b128 v[68:71], v78 offset:9216
    v_exp_f32 v12, v12
    v_exp_f32 v13, v13
    v_exp_f32 v14, v14
    v_exp_f32 v15, v15
    v_cvt_pk_bf16_f32 v54, v12, v13
    v_cvt_pk_bf16_f32 v55, v14, v15
    s_min_u32 s36, s12, 4
    s_lshl_b32 s36, s36, 10
    s_add_u32 m0, s36, 158720
    s_add_u32 s36, s36, s62
    s_add_u32 s36, s36, 81920
    buffer_load_dwordx4 v255, s[8:11], s36 offen lds
    s_waitcnt lgkmcnt(3)
    v_mfma_f32_32x32x16_bf16 v[0:15], v[56:59], v[64:67], 0
    ds_read_b128 v[56:59], v76 offset:3072
    v_exp_f32 v16, v16
    v_exp_f32 v17, v17
    v_exp_f32 v18, v18
    v_exp_f32 v19, v19
    v_cvt_pk_bf16_f32 v48, v16, v17
    v_cvt_pk_bf16_f32 v49, v18, v19
    s_waitcnt lgkmcnt(3)
    v_mfma_f32_32x32x8_bf16 v[0:15], v[60:61], v[62:63], v[0:15]
    ds_read_b64 v[60:61], v77 offset:3072
    v_exp_f32 v20, v20
    v_exp_f32 v21, v21
    v_exp_f32 v22, v22
    v_exp_f32 v23, v23
    v_cvt_pk_bf16_f32 v50, v20, v21
    v_cvt_pk_bf16_f32 v51, v22, v23
    s_waitcnt lgkmcnt(3)
    v_mfma_f32_32x32x16_bf16 v[32:47], v[72:75], v[52:55], v[32:47]
    ds_read_b128 v[72:75], v79 offset:9216
    v_exp_f32 v24, v24
    v_exp_f32 v25, v25
    v_exp_f32 v26, v26
    v_exp_f32 v27, v27
    v_cvt_pk_bf16_f32 v52, v24, v25
    v_cvt_pk_bf16_f32 v53, v26, v27
    s_cmp_ge_u32 s12, 4
    s_cbranch_scc1 L_b2h_69
    s_add_u32 s36, s52, 4096
    buffer_load_dwordx2 v[146:147], v137, s[8:11], s36 offen sc1
    s_branch L_b2e_70
L_b2h_69:
L_b2e_70:
    s_waitcnt lgkmcnt(3)
    v_mfma_f32_32x32x16_bf16 v[32:47], v[68:71], v[48:51], v[32:47]
    ds_read_b128 v[68:71], v78 offset:6144
    v_exp_f32 v28, v28
    v_exp_f32 v29, v29
    v_exp_f32 v30, v30
    v_exp_f32 v31, v31
    v_cvt_pk_bf16_f32 v54, v28, v29
    v_cvt_pk_bf16_f32 v55, v30, v31
    s_setprio 1
    s_waitcnt lgkmcnt(3)
    v_mfma_f32_32x32x16_bf16 v[16:31], v[56:59], v[64:67], 0
    ds_read_b128 v[56:59], v76 offset:0
    v_exp_f32 v0, v0
    v_exp_f32 v1, v1
    v_exp_f32 v2, v2
    v_exp_f32 v3, v3
    v_cvt_pk_bf16_f32 v48, v0, v1
    v_cvt_pk_bf16_f32 v49, v2, v3
    s_waitcnt lgkmcnt(3)
    v_mfma_f32_32x32x8_bf16 v[16:31], v[60:61], v[62:63], v[16:31]
    ds_read_b64 v[60:61], v77 offset:0
    v_exp_f32 v4, v4
    v_exp_f32 v5, v5
    v_exp_f32 v6, v6
    v_exp_f32 v7, v7
    v_cvt_pk_bf16_f32 v50, v4, v5
    v_cvt_pk_bf16_f32 v51, v6, v7
    s_waitcnt lgkmcnt(3)
    v_mfma_f32_32x32x16_bf16 v[32:47], v[72:75], v[52:55], v[32:47]
    ds_read_b128 v[72:75], v79 offset:6144
    v_exp_f32 v8, v8
    v_exp_f32 v9, v9
    v_exp_f32 v10, v10
    v_exp_f32 v11, v11
    v_cvt_pk_bf16_f32 v52, v8, v9
    v_cvt_pk_bf16_f32 v53, v10, v11
    s_waitcnt lgkmcnt(3)
    v_mfma_f32_32x32x16_bf16 v[32:47], v[68:71], v[48:51], v[32:47]
    ds_read_b128 v[68:71], v78 offset:3072
    v_exp_f32 v12, v12
    v_exp_f32 v13, v13
    v_exp_f32 v14, v14
    v_exp_f32 v15, v15
    v_cvt_pk_bf16_f32 v54, v12, v13
    v_cvt_pk_bf16_f32 v55, v14, v15
    s_setprio 0
    s_waitcnt lgkmcnt(3)
    v_mfma_f32_32x32x16_bf16 v[0:15], v[56:59], v[64:67], v[116:131]
    v_exp_f32 v16, v16
    v_exp_f32 v17, v17
    v_exp_f32 v18, v18
    v_exp_f32 v19, v19
    v_cvt_pk_bf16_f32 v48, v16, v17
    v_cvt_pk_bf16_f32 v49, v18, v19
    s_waitcnt lgkmcnt(2)
    v_mfma_f32_32x32x8_bf16 v[0:15], v[60:61], v[62:63], v[0:15]
    v_exp_f32 v20, v20
    v_exp_f32 v21, v21
    v_exp_f32 v22, v22
    v_exp_f32 v23, v23
    v_cvt_pk_bf16_f32 v50, v20, v21
    v_cvt_pk_bf16_f32 v51, v22, v23
    s_waitcnt lgkmcnt(1)
    v_mfma_f32_32x32x16_bf16 v[32:47], v[72:75], v[52:55], v[32:47]
    ds_read_b128 v[72:75], v79 offset:3072
    v_exp_f32 v24, v24
    v_exp_f32 v25, v25
    v_exp_f32 v26, v26
    v_exp_f32 v27, v27
    v_cvt_pk_bf16_f32 v52, v24, v25
    v_cvt_pk_bf16_f32 v53, v26, v27
    s_waitcnt lgkmcnt(1)
    v_mfma_f32_32x32x16_bf16 v[32:47], v[68:71], v[48:51], v[32:47]
    ds_read_b128 v[68:71], v78 offset:0
    v_exp_f32 v28, v28
    v_exp_f32 v29, v29
    v_exp_f32 v30, v30
    v_exp_f32 v31, v31
    v_cvt_pk_bf16_f32 v54, v28, v29
    v_cvt_pk_bf16_f32 v55, v30, v31
    v_exp_f32 v0, v0
    v_exp_f32 v1, v1
    v_exp_f32 v2, v2
    v_exp_f32 v3, v3
    v_cvt_pk_bf16_f32 v48, v0, v1
    v_cvt_pk_bf16_f32 v49, v2, v3
    v_exp_f32 v4, v4
    v_exp_f32 v5, v5
    v_exp_f32 v6, v6
    v_exp_f32 v7, v7
    v_cvt_pk_bf16_f32 v50, v4, v5
    v_cvt_pk_bf16_f32 v51, v6, v7
    s_waitcnt lgkmcnt(1)
    v_mfma_f32_32x32x16_bf16 v[32:47], v[72:75], v[52:55], v[32:47]
    ds_read_b128 v[72:75], v79 offset:0
    v_exp_f32 v8, v8
    v_exp_f32 v9, v9
    v_exp_f32 v10, v10
    v_exp_f32 v11, v11
    v_cvt_pk_bf16_f32 v52, v8, v9
    v_cvt_pk_bf16_f32 v53, v10, v11
    s_waitcnt lgkmcnt(1)
    v_mfma_f32_32x32x16_bf16 v[32:47], v[68:71], v[48:51], v[32:47]
    v_exp_f32 v12, v12
    v_exp_f32 v13, v13
    v_exp_f32 v14, v14
    v_exp_f32 v15, v15
    v_cvt_pk_bf16_f32 v54, v12, v13
    v_cvt_pk_bf16_f32 v55, v14, v15
    s_waitcnt lgkmcnt(0)
    s_nop 0
    v_mfma_f32_32x32x16_bf16 v[32:47], v[72:75], v[52:55], v[32:47]
    s_mov_b32 s36, 0x5d800000
    s_lshl_b32 s43, s39, 15
    s_add_u32 s43, s43, 0x500000
    s_lshl_b32 s44, s14, 9
    s_add_u32 s43, s43, s44
    s_lshl_b32 s44, s14, 14
    s_lshl_b32 s45, s39, 8
    s_add_u32 s44, s44, s45
    s_add_u32 s44, s44, 0x700000
    v_lshrrev_b32 v84, 4, v254
    v_lshlrev_b32 v84, 14, v84
    v_lshl_add_u32 v84, v253, 8, v84
    v_and_b32 v85, 15, v254
    v_lshl_add_u32 v84, v85, 4, v84
    v_lshlrev_b32 v85, 3, v254
    v_cmp_ngt_f32 vcc, s36, v44
    s_cbranch_vccnz L_as_fb
L_as_store:
    v_rcp_f32 v82, v44
    s_nop 0
    v_mov_b32 v83, v82
    v_pk_mul_f32 v[32:33], v[32:33], v[82:83]
    v_pk_mul_f32 v[34:35], v[34:35], v[82:83]
    v_pk_mul_f32 v[36:37], v[36:37], v[82:83]
    v_pk_mul_f32 v[38:39], v[38:39], v[82:83]
    v_pk_mul_f32 v[40:41], v[40:41], v[82:83]
    v_pk_mul_f32 v[42:43], v[42:43], v[82:83]
    v_cvt_pk_bf16_f32 v32, v32, v33
    v_cvt_pk_bf16_f32 v33, v34, v35
    v_cvt_pk_bf16_f32 v34, v36, v37
    v_cvt_pk_bf16_f32 v35, v38, v39
    v_cvt_pk_bf16_f32 v36, v40, v41
    v_cvt_pk_bf16_f32 v37, v42, v43
    v_permlane32_swap_b32 v32, v34
    v_permlane32_swap_b32 v33, v35
    buffer_store_dwordx4 v[32:35], v84, s[8:11], s43 offen
    s_mov_b64 exec, s[28:29]
    buffer_store_dwordx2 v[36:37], v85, s[8:11], s44 offen
    s_mov_b64 exec, -1
    s_branch L_att_done
L_as_fb:
    s_sub_u32 s46, s39, 8
    s_cmp_lt_u32 s39, 8
    s_cselect_b32 s46, 0, s46
    s_mov_b32 s47, s39
    v_mov_b32 v86, 81920
    v_cndmask_b32 v95, v86, v245, s[28:29]
    s_and_b32 s48, s14, 1
    s_lshl_b32 s48, s48, 2
    v_add_u32 v87, s48, v254
    v_subrev_u32 v88, 20, v87
    v_cmp_gt_u32 s[50:51], 20, v87
    v_cmp_gt_u32 s[52:53], 20, v254
    s_mul_i32 s48, s14, 320
    s_add_u32 s48, s48, 40960
    v_cndmask_b32 v87, v88, v87, s[50:51]
    v_mul_u32_u24 v88, 10240, v253
    v_lshl_add_u32 v87, v87, 4, v88
    v_add_u32 v87, s48, v87
    v_add_u32 v88, 20480, v87
    v_cndmask_b32 v96, v86, v87, s[52:53]
    v_cndmask_b32 v97, v86, v88, s[52:53]
    v_mov_b32 v80, 0
    v_cndmask_b32 v62, v80, v62, s[28:29]
    v_cndmask_b32 v63, v80, v63, s[28:29]
    v_mov_b32 v92, 0xf149f2ca
    v_mov_b32 v32, 0
    v_mov_b32 v33, 0
    v_mov_b32 v34, 0
    v_mov_b32 v35, 0
    v_mov_b32 v36, 0
    v_mov_b32 v37, 0
    v_mov_b32 v38, 0
    v_mov_b32 v39, 0
    v_mov_b32 v40, 0
    v_mov_b32 v41, 0
    v_mov_b32 v42, 0
    v_mov_b32 v43, 0
    v_mov_b32 v44, 0
    v_mov_b32 v45, 0
    v_mov_b32 v46, 0
    v_mov_b32 v47, 0
    s_mov_b32 s49, 0
L_fbpass_71:
    s_mov_b32 s48, s46
L_fbtile_72:
    s_mul_i32 s50, s48, 82048
    buffer_load_dwordx4 v[56:59], v249, s[32:35], s50 offen sc1
    buffer_load_dwordx2 v[60:61], v95, s[32:35], s50 offen sc1
    buffer_load_dwordx4 v[68:71], v96, s[32:35], s50 offen sc1
    buffer_load_dwordx4 v[72:75], v97, s[32:35], s50 offen sc1
    v_mov_b32 v16, 0
    v_mov_b32 v17, 0
    v_mov_b32 v18, 0
    v_mov_b32 v19, 0
    v_mov_b32 v20, 0
    v_mov_b32 v21, 0
    v_mov_b32 v22, 0
    v_mov_b32 v23, 0
    v_mov_b32 v24, 0
    v_mov_b32 v25, 0
    v_mov_b32 v26, 0
    v_mov_b32 v27, 0
    v_mov_b32 v28, 0
    v_mov_b32 v29, 0
    v_mov_b32 v30, 0
    v_mov_b32 v31, 0
    s_cmp_lg_u32 s48, s39
    s_cbranch_scc1 L_fbnd_75
    v_mov_b32 v16, v100
    v_mov_b32 v17, v101
    v_mov_b32 v18, v102
    v_mov_b32 v19, v103
    v_mov_b32 v20, v104
    v_mov_b32 v21, v105
    v_mov_b32 v22, v106
    v_mov_b32 v23, v107
    v_mov_b32 v24, v108
    v_mov_b32 v25, v109
    v_mov_b32 v26, v110
    v_mov_b32 v27, v111
    v_mov_b32 v28, v112
    v_mov_b32 v29, v113
    v_mov_b32 v30, v114
    v_mov_b32 v31, v115
L_fbnd_75:
    s_add_u32 s51, s48, 8
    s_cmp_lg_u32 s51, s39
    s_cbranch_scc1 L_fbnf_76
    v_mov_b32 v16, v116
    v_mov_b32 v17, v117
    v_mov_b32 v18, v118
    v_mov_b32 v19, v119
    v_mov_b32 v20, v120
    v_mov_b32 v21, v121
    v_mov_b32 v22, v122
    v_mov_b32 v23, v123
    v_mov_b32 v24, v124
    v_mov_b32 v25, v125
    v_mov_b32 v26, v126
    v_mov_b32 v27, v127
    v_mov_b32 v28, v128
    v_mov_b32 v29, v129
    v_mov_b32 v30, v130
    v_mov_b32 v31, v131
L_fbnf_76:
    s_waitcnt vmcnt(0)
    s_nop 1
    v_mfma_f32_32x32x16_bf16 v[0:15], v[56:59], v[64:67], v[16:31]
    v_mfma_f32_32x32x8_bf16 v[0:15], v[60:61], v[62:63], v[0:15]
    s_nop 15
    s_cmp_lg_u32 s49, 0
    s_cbranch_scc1 L_fbp2_73
    v_max3_f32 v92, v92, v0, v1
    v_max3_f32 v92, v92, v2, v3
    v_max3_f32 v92, v92, v4, v5
    v_max3_f32 v92, v92, v6, v7
    v_max3_f32 v92, v92, v8, v9
    v_max3_f32 v92, v92, v10, v11
    v_max3_f32 v92, v92, v12, v13
    v_max3_f32 v92, v92, v14, v15
    s_branch L_fbnext_74
L_fbp2_73:
    v_exp_f32 v0, v0
    v_exp_f32 v1, v1
    v_exp_f32 v2, v2
    v_exp_f32 v3, v3
    v_exp_f32 v4, v4
    v_exp_f32 v5, v5
    v_exp_f32 v6, v6
    v_exp_f32 v7, v7
    v_exp_f32 v8, v8
    v_exp_f32 v9, v9
    v_exp_f32 v10, v10
    v_exp_f32 v11, v11
    v_exp_f32 v12, v12
    v_exp_f32 v13, v13
    v_exp_f32 v14, v14
    v_exp_f32 v15, v15
    s_nop 0
    v_cvt_pk_bf16_f32 v48, v0, v1
    v_cvt_pk_bf16_f32 v49, v2, v3
    v_cvt_pk_bf16_f32 v50, v4, v5
    v_cvt_pk_bf16_f32 v51, v6, v7
    v_cvt_pk_bf16_f32 v52, v8, v9
    v_cvt_pk_bf16_f32 v53, v10, v11
    v_cvt_pk_bf16_f32 v54, v12, v13
    v_cvt_pk_bf16_f32 v55, v14, v15
    s_nop 1
    v_mfma_f32_32x32x16_bf16 v[32:47], v[68:71], v[48:51], v[32:47]
    v_mfma_f32_32x32x16_bf16 v[32:47], v[72:75], v[52:55], v[32:47]
    s_nop 15
L_fbnext_74:
    s_add_u32 s48, s48, 1
    s_cmp_le_u32 s48, s47
    s_cbranch_scc1 L_fbtile_72
    s_cmp_lg_u32 s49, 0
    s_cbranch_scc1 L_as_store
    s_mov_b32 s49, 1
    v_mov_b32 v93, v84
    v_mov_b32 v94, v85
    v_mov_b32 v80, v92
    v_mov_b32 v81, v80
    s_nop 1
    v_permlane32_swap_b32 v80, v81
    s_nop 1
    v_max_f32 v80, v80, v81
    v_sub_f32 v80, 0, v80
    v_and_b32 v84, s31, v80
    v_sub_f32 v85, v80, v84
    v_and_b32 v83, s31, v85
    v_perm_b32 v82, v83, v84, s30
    v_sub_f32 v85, v85, v83
    v_lshrrev_b32 v83, 16, v85
    v_cndmask_b32 v62, v82, v62, s[28:29]
    v_cndmask_b32 v63, v83, v63, s[28:29]
    v_mov_b32 v84, v93
    v_mov_b32 v85, v94
    s_branch L_fbpass_71
L_attf:
    s_lshl_b32 s39, s13, 3
    s_add_u32 s39, s39, s12
    s_mul_i32 s40, s39, 40960
    s_add_u32 s40, s40, 0x280000
    s_mul_i32 s41, s12, 3072
    s_mul_i32 s45, s39, 82048
    s_add_u32 s45, s45, 0x780000
    s_add_u32 s57, s16, 2
    s_lshl_b32 s36, s12, 10
    s_add_u32 s58, s36, 76800
    s_add_u32 s59, s36, s62
    v_mov_b32 v32, 0
    v_mov_b32 v33, 0
    v_mov_b32 v34, 0
    v_mov_b32 v35, 0
    v_mov_b32 v36, 0
    v_mov_b32 v37, 0
    v_mov_b32 v38, 0
    v_mov_b32 v39, 0
    v_mov_b32 v40, 0
    v_mov_b32 v41, 0
    v_mov_b32 v42, 0
    v_mov_b32 v43, 0
    v_mov_b32 v44, 0
    v_mov_b32 v45, 0
    v_mov_b32 v46, 0
    v_mov_b32 v47, 0
    v_mov_b32 v76, v255
    v_mov_b32 v77, v246
    v_mov_b32 v78, v247
    v_mov_b32 v79, v248
    v_add_u32 v132, 0x8000, v255
    v_add_u32 v133, 0x8000, v246
    v_add_u32 v134, 0x8000, v247
    v_add_u32 v135, 0x8000, v248
    s_mul_i32 s46, s12, 82048
    s_add_u32 s55, s13, 1
    s_and_b32 s55, s55, 7
    s_lshl_b32 s56, s55, 7
    s_add_u32 s56, s56, 0x1e50400
    s_mov_b32 s42, 0x1e50400
    v_and_b32 v88, 7, v254
    v_lshlrev_b32 v88, 7, v88
    s_lshl_b32 s52, s13, 4
    s_and_b32 s53, s14, 3
    s_lshl_b32 s53, s53, 2
    s_add_u32 s52, s52, s53
    s_add_u32 s52, s52, s12
    s_and_b32 s54, s52, 1
    s_lshl_b32 s54, s54, 8
    s_lshr_b32 s52, s52, 1
    s_mul_i32 s52, s52, 40960
    s_lshr_b32 s53, s14, 2
    s_mul_i32 s53, s53, 5120
    s_add_u32 s52, s52, s53
    s_add_u32 s52, s52, s54
    s_add_u32 s52, s52, 0x0
    v_bfe_u32 v240, v255, 8, 1
    v_lshlrev_b32 v137, 9, v240
    v_and_b32 v240, 0xf0, v255
    v_add_u32 v137, v137, v240
    v_lshl_add_u32 v137, v253, 3, v137
    s_cmp_ge_u32 s12, 4
    s_cbranch_scc1 L_af_c_79
    s_waitcnt vmcnt(0)
L_af_c_79:
    s_add_u32 s17, s17, 1
    s_barrier
    s_cmp_lg_u32 s12, 4
    s_cbranch_scc1 L_af_t_sk_80
    s_mov_b64 exec, 1
    v_mov_b32 v240, s17
    v_mov_b32 v241, s19
    s_cmp_lg_u32 s15, 0
    s_cbranch_scc1 L_af_t_sf_81
    buffer_store_dword v240, v241, s[8:11], 0 offen
    s_branch L_af_t_g_82
L_af_t_sf_81:
    buffer_wbl2 sc1
    s_waitcnt vmcnt(0)
    buffer_store_dword v240, v241, s[8:11], 0 offen sc1
L_af_t_g_82:
    s_mov_b64 exec, -1
L_af_t_sk_80:
    s_mov_b32 s48, 0
    s_cmp_lg_u32 s12, 7
    s_cbranch_scc1 L_af_w_77
    s_mov_b32 s37, 400000
L_af_p_83:
    buffer_load_dword v240, v252, s[8:11], s18 offen sc1
    s_waitcnt vmcnt(0)
    v_cmp_gt_u32 vcc, s17, v240
    s_cbranch_vccz L_af_d_84
    s_sub_u32 s37, s37, 1
    s_cmp_lg_u32 s37, 0
    s_cbranch_scc1 L_af_p_83
L_af_d_84:
    s_cmp_lg_u32 s14, 31
    s_cbranch_scc1 L_af_w_77
    s_mov_b32 s48, 1
L_af_w_77:
    s_barrier
    buffer_load_dwordx4 v[64:67], v249, s[8:11], s40 offen sc1
    buffer_load_dwordx2 v[62:63], v245, s[8:11], s40 offen sc1
    s_mov_b32 m0, s41
    s_nop 0
    buffer_load_dwordx4 v249, s[8:11], s45 offen offset:0 sc1 lds
    buffer_load_dwordx4 v250, s[8:11], s45 offen offset:1024 sc1 lds
    buffer_load_dwordx4 v251, s[8:11], s45 offen offset:2048 sc1 lds
    s_cmp_eq_u32 s48, 0
    s_cbranch_scc1 L_af_go_86
    s_lshl_b32 s36, s13, 7
    s_add_u32 s36, s36, 0x1e50400
    v_mov_b32 v240, s57
    s_mov_b64 exec, 1
    buffer_store_dword v240, off, s[8:11], s36 sc1
    s_mov_b64 exec, -1
    s_waitcnt vmcnt(1)
    v_mov_b32 v80, 0
    v_cndmask_b32 v62, v80, v62, s[28:29]
    v_cndmask_b32 v63, v80, v63, s[28:29]
    s_branch L_af_gb_87
L_af_go_86:
    s_waitcnt vmcnt(3)
    v_mov_b32 v80, 0
    v_cndmask_b32 v62, v80, v62, s[28:29]
    v_cndmask_b32 v63, v80, v63, s[28:29]
    s_waitcnt vmcnt(0)
L_af_gb_87:
    s_barrier
    buffer_load_dword v136, v88, s[8:11], s42 offen sc1
    ds_read_b128 v[56:59], v76 offset:0
    ds_read_b64 v[60:61], v77 offset:0
    s_waitcnt lgkmcnt(0)
    v_mfma_f32_32x32x16_bf16 v[16:31], v[56:59], v[64:67], 0
    v_mfma_f32_32x32x8_bf16 v[16:31], v[60:61], v[62:63], v[16:31]
    v_mfma_f32_32x32x16_bf16 v[0:15], v[56:59], v[64:67], 0
    s_nop 10
    v_max3_f32 v80, v16, v17, v18
    v_max3_f32 v80, v80, v19, v20
    v_max3_f32 v80, v80, v21, v22
    v_max3_f32 v80, v80, v23, v24
    v_max3_f32 v80, v80, v25, v26
    v_max3_f32 v80, v80, v27, v28
    v_max3_f32 v80, v80, v29, v30
    v_max_f32 v80, v80, v31
    v_mov_b32 v81, v80
    s_nop 1
    v_permlane32_swap_b32 v80, v81
    s_nop 1
    v_max_f32 v80, v80, v81
    v_sub_f32 v80, 0, v80
    v_and_b32 v84, s31, v80
    v_sub_f32 v85, v80, v84
    v_and_b32 v83, s31, v85
    v_perm_b32 v82, v83, v84, s30
    v_sub_f32 v85, v85, v83
    v_lshrrev_b32 v83, 16, v85
    v_cndmask_b32 v62, v82, v62, s[28:29]
    v_cndmask_b32 v63, v83, v63, s[28:29]
    s_nop 1
    v_mfma_f32_32x32x8_bf16 v[0:15], v[60:61], v[62:63], v[0:15]
    ds_read_b128 v[56:59], v76 offset:3072
    ds_read_b64 v[60:61], v77 offset:3072
    ds_read_b128 v[68:71], v78
    s_setprio 3
    s_nop 6
    s_add_u32 s36, s13, 1
    s_lshl_b32 s44, 0x7f, s36
    s_waitcnt lgkmcnt(2)
    v_mfma_f32_32x32x16_bf16 v[16:31], v[56:59], v[64:67], 0
    ds_read_b128 v[56:59], v76 offset:6144
    v_exp_f32 v0, v0
    v_exp_f32 v1, v1
    v_exp_f32 v2, v2
    v_exp_f32 v3, v3
    v_cvt_pk_bf16_f32 v48, v0, v1
    v_cvt_pk_bf16_f32 v49, v2, v3
    s_waitcnt lgkmcnt(2)
    v_mfma_f32_32x32x8_bf16 v[16:31], v[60:61], v[62:63], v[16:31]
    ds_read_b64 v[60:61], v77 offset:6144
    v_exp_f32 v4, v4
    v_exp_f32 v5, v5
    v_exp_f32 v6, v6
    v_exp_f32 v7, v7
    v_cvt_pk_bf16_f32 v50, v4, v5
    v_cvt_pk_bf16_f32 v51, v6, v7
    ds_read_b128 v[72:75], v79 offset:0
    v_exp_f32 v8, v8
    v_exp_f32 v9, v9
    v_exp_f32 v10, v10
    v_exp_f32 v11, v11
    v_cvt_pk_bf16_f32 v52, v8, v9
    v_cvt_pk_bf16_f32 v53, v10, v11
    s_waitcnt lgkmcnt(3)
    v_mfma_f32_32x32x16_bf16 v[32:47], v[68:71], v[48:51], v[32:47]
    ds_read_b128 v[68:71], v78 offset:3072
    v_exp_f32 v12, v12
    v_exp_f32 v13, v13
    v_exp_f32 v14, v14
    v_exp_f32 v15, v15
    v_cvt_pk_bf16_f32 v54, v12, v13
    v_cvt_pk_bf16_f32 v55, v14, v15
    s_waitcnt lgkmcnt(3)
    v_mfma_f32_32x32x16_bf16 v[0:15], v[56:59], v[64:67], 0
    ds_read_b128 v[56:59], v76 offset:9216
    v_exp_f32 v16, v16
    v_exp_f32 v17, v17
    v_exp_f32 v18, v18
    v_exp_f32 v19, v19
    v_cvt_pk_bf16_f32 v48, v16, v17
    v_cvt_pk_bf16_f32 v49, v18, v19
    s_waitcnt lgkmcnt(3)
    v_mfma_f32_32x32x8_bf16 v[0:15], v[60:61], v[62:63], v[0:15]
    ds_read_b64 v[60:61], v77 offset:9216
    v_exp_f32 v20, v20
    v_exp_f32 v21, v21
    v_exp_f32 v22, v22
    v_exp_f32 v23, v23
    v_cvt_pk_bf16_f32 v50, v20, v21
    v_cvt_pk_bf16_f32 v51, v22, v23
    s_waitcnt lgkmcnt(3)
    v_mfma_f32_32x32x16_bf16 v[32:47], v[72:75], v[52:55], v[32:47]
    ds_read_b128 v[72:75], v79 offset:3072
    s_waitcnt vmcnt(0)
    v_cmp_gt_u32 vcc, s57, v136
    s_mov_b32 s43, vcc_lo
    s_andn2_b32 s55, s44, s43
    s_cbranch_scc1 L_af_ok_88
    s_mov_b32 s37, 400000
L_af_sp_89:
    buffer_load_dword v136, v88, s[8:11], s42 offen sc1
    s_waitcnt vmcnt(0)
    v_cmp_gt_u32 vcc, s57, v136
    s_mov_b32 s43, vcc_lo
    s_andn2_b32 s55, s44, s43
    s_cbranch_scc1 L_af_ok_88
    s_sub_u32 s37, s37, 1
    s_cmp_lg_u32 s37, 0
    s_cbranch_scc1 L_af_sp_89
    s_mov_b32 s55, s44
L_af_ok_88:
    s_flbit_i32_b32 s55, s55
    s_sub_u32 s55, 31, s55
    s_bitset0_b32 s44, s55
    s_and_b32 s55, s55, 7
    s_mul_i32 s47, s55, 656384
    s_add_u32 s47, s47, s46
    s_add_u32 m0, s41, 24576
    s_nop 0
    buffer_load_dwordx4 v249, s[32:35], s47 offen offset:0 sc1 lds
    s_add_u32 m0, s41, 24576
    s_nop 0
    buffer_load_dwordx4 v250, s[32:35], s47 offen offset:1024 sc1 lds
    s_add_u32 m0, s41, 24576
    s_nop 0
    buffer_load_dwordx4 v251, s[32:35], s47 offen offset:2048 sc1 lds
    v_exp_f32 v24, v24
    v_exp_f32 v25, v25
    v_exp_f32 v26, v26
    v_exp_f32 v27, v27
    v_cvt_pk_bf16_f32 v52, v24, v25
    v_cvt_pk_bf16_f32 v53, v26, v27
    s_waitcnt lgkmcnt(3)
    v_mfma_f32_32x32x16_bf16 v[32:47], v[68:71], v[48:51], v[32:47]
    ds_read_b128 v[68:71], v78 offset:6144
    v_exp_f32 v28, v28
    v_exp_f32 v29, v29
    v_exp_f32 v30, v30
    v_exp_f32 v31, v31
    v_cvt_pk_bf16_f32 v54, v28, v29
    v_cvt_pk_bf16_f32 v55, v30, v31
    s_setprio 2
    s_waitcnt lgkmcnt(3)
    v_mfma_f32_32x32x16_bf16 v[16:31], v[56:59], v[64:67], 0
    ds_read_b128 v[56:59], v76 offset:12288
    v_exp_f32 v0, v0
    v_exp_f32 v1, v1
    v_exp_f32 v2, v2
    v_exp_f32 v3, v3
    v_cvt_pk_bf16_f32 v48, v0, v1
    v_cvt_pk_bf16_f32 v49, v2, v3
    s_waitcnt lgkmcnt(3)
    v_mfma_f32_32x32x8_bf16 v[16:31], v[60:61], v[62:63], v[16:31]
    ds_read_b64 v[60:61], v77 offset:12288
    v_exp_f32 v4, v4
    v_exp_f32 v5, v5
    v_exp_f32 v6, v6
    v_exp_f32 v7, v7
    v_cvt_pk_bf16_f32 v50, v4, v5
    v_cvt_pk_bf16_f32 v51, v6, v7
    s_waitcnt lgkmcnt(3)
    v_mfma_f32_32x32x16_bf16 v[32:47], v[72:75], v[52:55], v[32:47]
    ds_read_b128 v[72:75], v79 offset:6144
    v_exp_f32 v8, v8
    v_exp_f32 v9, v9
    v_exp_f32 v10, v10
    v_exp_f32 v11, v11
    v_cvt_pk_bf16_f32 v52, v8, v9
    v_cvt_pk_bf16_f32 v53, v10, v11
    s_waitcnt lgkmcnt(3)
    v_mfma_f32_32x32x16_bf16 v[32:47], v[68:71], v[48:51], v[32:47]
    ds_read_b128 v[68:71], v78 offset:9216
    v_exp_f32 v12, v12
    v_exp_f32 v13, v13
    v_exp_f32 v14, v14
    v_exp_f32 v15, v15
    v_cvt_pk_bf16_f32 v54, v12, v13
    v_cvt_pk_bf16_f32 v55, v14, v15
    s_waitcnt lgkmcnt(3)
    v_mfma_f32_32x32x16_bf16 v[0:15], v[56:59], v[64:67], 0
    ds_read_b128 v[56:59], v76 offset:15360
    v_exp_f32 v16, v16
    v_exp_f32 v17, v17
    v_exp_f32 v18, v18
    v_exp_f32 v19, v19
    v_cvt_pk_bf16_f32 v48, v16, v17
    v_cvt_pk_bf16_f32 v49, v18, v19
    s_waitcnt lgkmcnt(3)
    v_mfma_f32_32x32x8_bf16 v[0:15], v[60:61], v[62:63], v[0:15]
    ds_read_b64 v[60:61], v77 offset:15360
    v_exp_f32 v20, v20
    v_exp_f32 v21, v21
    v_exp_f32 v22, v22
    v_exp_f32 v23, v23
    v_cvt_pk_bf16_f32 v50, v20, v21
    v_cvt_pk_bf16_f32 v51, v22, v23
    s_waitcnt lgkmcnt(3)
    v_mfma_f32_32x32x16_bf16 v[32:47], v[72:75], v[52:55], v[32:47]
    ds_read_b128 v[72:75], v79 offset:9216
    v_exp_f32 v24, v24
    v_exp_f32 v25, v25
    v_exp_f32 v26, v26
    v_exp_f32 v27, v27
    v_cvt_pk_bf16_f32 v52, v24, v25
    v_cvt_pk_bf16_f32 v53, v26, v27
    buffer_load_dword v136, v88, s[8:11], s42 offen sc1
    s_waitcnt lgkmcnt(3)
    v_mfma_f32_32x32x16_bf16 v[32:47], v[68:71], v[48:51], v[32:47]
    ds_read_b128 v[68:71], v78 offset:12288
    v_exp_f32 v28, v28
    v_exp_f32 v29, v29
    v_exp_f32 v30, v30
    v_exp_f32 v31, v31
    v_cvt_pk_bf16_f32 v54, v28, v29
    v_cvt_pk_bf16_f32 v55, v30, v31
    s_setprio 1
    s_waitcnt lgkmcnt(3)
    v_mfma_f32_32x32x16_bf16 v[16:31], v[56:59], v[64:67], 0
    ds_read_b128 v[56:59], v76 offset:18432
    v_exp_f32 v0, v0
    v_exp_f32 v1, v1
    v_exp_f32 v2, v2
    v_exp_f32 v3, v3
    v_cvt_pk_bf16_f32 v48, v0, v1
    v_cvt_pk_bf16_f32 v49, v2, v3
    s_waitcnt lgkmcnt(3)
    v_mfma_f32_32x32x8_bf16 v[16:31], v[60:61], v[62:63], v[16:31]
    ds_read_b64 v[60:61], v77 offset:18432
    v_exp_f32 v4, v4
    v_exp_f32 v5, v5
    v_exp_f32 v6, v6
    v_exp_f32 v7, v7
    v_cvt_pk_bf16_f32 v50, v4, v5
    v_cvt_pk_bf16_f32 v51, v6, v7
    s_waitcnt lgkmcnt(3)
    v_mfma_f32_32x32x16_bf16 v[32:47], v[72:75], v[52:55], v[32:47]
    ds_read_b128 v[72:75], v79 offset:12288
    v_exp_f32 v8, v8
    v_exp_f32 v9, v9
    v_exp_f32 v10, v10
    v_exp_f32 v11, v11
    v_cvt_pk_bf16_f32 v52, v8, v9
    v_cvt_pk_bf16_f32 v53, v10, v11
    s_waitcnt lgkmcnt(3)
    v_mfma_f32_32x32x16_bf16 v[32:47], v[68:71], v[48:51], v[32:47]
    ds_read_b128 v[68:71], v78 offset:15360
    v_exp_f32 v12, v12
    v_exp_f32 v13, v13
    v_exp_f32 v14, v14
    v_exp_f32 v15, v15
    v_cvt_pk_bf16_f32 v54, v12, v13
    v_cvt_pk_bf16_f32 v55, v14, v15
    s_setprio 0
    s_waitcnt lgkmcnt(3)
    v_mfma_f32_32x32x16_bf16 v[0:15], v[56:59], v[64:67], 0
    ds_read_b128 v[56:59], v76 offset:21504
    v_exp_f32 v16, v16
    v_exp_f32 v17, v17
    v_exp_f32 v18, v18
    v_exp_f32 v19, v19
    v_cvt_pk_bf16_f32 v48, v16, v17
    v_cvt_pk_bf16_f32 v49, v18, v19
    s_waitcnt lgkmcnt(3)
    v_mfma_f32_32x32x8_bf16 v[0:15], v[60:61], v[62:63], v[0:15]
    ds_read_b64 v[60:61], v77 offset:21504
    v_exp_f32 v20, v20
    v_exp_f32 v21, v21
    v_exp_f32 v22, v22
    v_exp_f32 v23, v23
    v_cvt_pk_bf16_f32 v50, v20, v21
    v_cvt_pk_bf16_f32 v51, v22, v23
    s_waitcnt lgkmcnt(3)
    v_mfma_f32_32x32x16_bf16 v[32:47], v[72:75], v[52:55], v[32:47]
    ds_read_b128 v[72:75], v79 offset:15360
    v_exp_f32 v24, v24
    v_exp_f32 v25, v25
    v_exp_f32 v26, v26
    v_exp_f32 v27, v27
    v_cvt_pk_bf16_f32 v52, v24, v25
    v_cvt_pk_bf16_f32 v53, v26, v27
    s_waitcnt lgkmcnt(3)
    v_mfma_f32_32x32x16_bf16 v[32:47], v[68:71], v[48:51], v[32:47]
    ds_read_b128 v[68:71], v78 offset:18432
    v_exp_f32 v28, v28
    v_exp_f32 v29, v29
    v_exp_f32 v30, v30
    v_exp_f32 v31, v31
    v_cvt_pk_bf16_f32 v54, v28, v29
    v_cvt_pk_bf16_f32 v55, v30, v31
    s_waitcnt vmcnt(1)
    s_waitcnt vmcnt(0)
    s_barrier
    s_setprio 3
    v_cmp_gt_u32 vcc, s57, v136
    s_mov_b32 s43, vcc_lo
    s_andn2_b32 s55, s44, s43
    s_cbranch_scc1 L_af_ok_90
    s_mov_b32 s37, 400000
L_af_sp_91:
    buffer_load_dword v136, v88, s[8:11], s42 offen sc1
    s_waitcnt vmcnt(0)
    v_cmp_gt_u32 vcc, s57, v136
    s_mov_b32 s43, vcc_lo
    s_andn2_b32 s55, s44, s43
    s_cbranch_scc1 L_af_ok_90
    s_sub_u32 s37, s37, 1
    s_cmp_lg_u32 s37, 0
    s_cbranch_scc1 L_af_sp_91
    s_mov_b32 s55, s44
L_af_ok_90:
    s_flbit_i32_b32 s55, s55
    s_sub_u32 s55, 31, s55
    s_bitset0_b32 s44, s55
    s_and_b32 s55, s55, 7
    s_mul_i32 s47, s55, 656384
    s_add_u32 s47, s47, s46
    s_waitcnt lgkmcnt(3)
    v_mfma_f32_32x32x16_bf16 v[16:31], v[56:59], v[64:67], 0
    ds_read_b128 v[56:59], v76 offset:24576
    v_exp_f32 v0, v0
    v_exp_f32 v1, v1
    v_exp_f32 v2, v2
    v_exp_f32 v3, v3
    v_cvt_pk_bf16_f32 v48, v0, v1
    v_cvt_pk_bf16_f32 v49, v2, v3
    s_waitcnt lgkmcnt(3)
    v_mfma_f32_32x32x8_bf16 v[16:31], v[60:61], v[62:63], v[16:31]
    ds_read_b64 v[60:61], v77 offset:24576
    v_exp_f32 v4, v4
    v_exp_f32 v5, v5
    v_exp_f32 v6, v6
    v_exp_f32 v7, v7
    v_cvt_pk_bf16_f32 v50, v4, v5
    v_cvt_pk_bf16_f32 v51, v6, v7
    s_waitcnt lgkmcnt(3)
    v_mfma_f32_32x32x16_bf16 v[32:47], v[72:75], v[52:55], v[32:47]
    ds_read_b128 v[72:75], v79 offset:18432
    s_add_u32 m0, s41, 49152
    s_nop 0
    buffer_load_dwordx4 v249, s[32:35], s47 offen offset:0 sc1 lds
    v_exp_f32 v8, v8
    v_exp_f32 v9, v9
    v_exp_f32 v10, v10
    v_exp_f32 v11, v11
    v_cvt_pk_bf16_f32 v52, v8, v9
    v_cvt_pk_bf16_f32 v53, v10, v11
    s_waitcnt lgkmcnt(3)
    v_mfma_f32_32x32x16_bf16 v[32:47], v[68:71], v[48:51], v[32:47]
    ds_read_b128 v[68:71], v78 offset:21504
    v_exp_f32 v12, v12
    v_exp_f32 v13, v13
    v_exp_f32 v14, v14
    v_exp_f32 v15, v15
    v_cvt_pk_bf16_f32 v54, v12, v13
    v_cvt_pk_bf16_f32 v55, v14, v15
    s_add_u32 m0, s41, 49152
    s_nop 0
    buffer_load_dwordx4 v250, s[32:35], s47 offen offset:1024 sc1 lds
    s_waitcnt lgkmcnt(3)
    v_mfma_f32_32x32x16_bf16 v[0:15], v[56:59], v[64:67], 0
    ds_read_b128 v[56:59], v76 offset:27648
    v_exp_f32 v16, v16
    v_exp_f32 v17, v17
    v_exp_f32 v18, v18
    v_exp_f32 v19, v19
    v_cvt_pk_bf16_f32 v48, v16, v17
    v_cvt_pk_bf16_f32 v49, v18, v19
    s_waitcnt lgkmcnt(3)
    v_mfma_f32_32x32x8_bf16 v[0:15], v[60:61], v[62:63], v[0:15]
    ds_read_b64 v[60:61], v77 offset:27648
    v_exp_f32 v20, v20
    v_exp_f32 v21, v21
    v_exp_f32 v22, v22
    v_exp_f32 v23, v23
    v_cvt_pk_bf16_f32 v50, v20, v21
    v_cvt_pk_bf16_f32 v51, v22, v23
    s_waitcnt lgkmcnt(3)
    v_mfma_f32_32x32x16_bf16 v[32:47], v[72:75], v[52:55], v[32:47]
    ds_read_b128 v[72:75], v79 offset:21504
    s_add_u32 m0, s41, 49152
    s_nop 0
    buffer_load_dwordx4 v251, s[32:35], s47 offen offset:2048 sc1 lds
    v_exp_f32 v24, v24
    v_exp_f32 v25, v25
    v_exp_f32 v26, v26
    v_exp_f32 v27, v27
    v_cvt_pk_bf16_f32 v52, v24, v25
    v_cvt_pk_bf16_f32 v53, v26, v27
    s_waitcnt lgkmcnt(3)
    v_mfma_f32_32x32x16_bf16 v[32:47], v[68:71], v[48:51], v[32:47]
    ds_read_b128 v[68:71], v78 offset:24576
    v_exp_f32 v28, v28
    v_exp_f32 v29, v29
    v_exp_f32 v30, v30
    v_exp_f32 v31, v31
    v_cvt_pk_bf16_f32 v54, v28, v29
    v_cvt_pk_bf16_f32 v55, v30, v31
    s_waitcnt lgkmcnt(3)
    v_mfma_f32_32x32x16_bf16 v[16:31], v[56:59], v[64:67], 0
    ds_read_b128 v[56:59], v76 offset:30720
    v_exp_f32 v0, v0
    v_exp_f32 v1, v1
    v_exp_f32 v2, v2
    v_exp_f32 v3, v3
    v_cvt_pk_bf16_f32 v48, v0, v1
    v_cvt_pk_bf16_f32 v49, v2, v3
    s_waitcnt lgkmcnt(3)
    v_mfma_f32_32x32x8_bf16 v[16:31], v[60:61], v[62:63], v[16:31]
    ds_read_b64 v[60:61], v77 offset:30720
    v_exp_f32 v4, v4
    v_exp_f32 v5, v5
    v_exp_f32 v6, v6
    v_exp_f32 v7, v7
    v_cvt_pk_bf16_f32 v50, v4, v5
    v_cvt_pk_bf16_f32 v51, v6, v7
    s_waitcnt lgkmcnt(3)
    v_mfma_f32_32x32x16_bf16 v[32:47], v[72:75], v[52:55], v[32:47]
    ds_read_b128 v[72:75], v79 offset:24576
    s_cmp_ge_u32 s12, 4
    s_cbranch_scc1 L_b2h_92
    s_add_u32 s36, s52, 0
    buffer_load_dwordx2 v[138:139], v137, s[8:11], s36 offen sc1
    s_branch L_b2e_93
L_b2h_92:
    s_add_u32 s36, s61, 1843200
    buffer_load_dwordx4 v[198:201], v244, s[20:23], s36 offen
L_b2e_93:
    v_exp_f32 v8, v8
    v_exp_f32 v9, v9
    v_exp_f32 v10, v10
    v_exp_f32 v11, v11
    v_cvt_pk_bf16_f32 v52, v8, v9
    v_cvt_pk_bf16_f32 v53, v10, v11
    s_waitcnt lgkmcnt(3)
    v_mfma_f32_32x32x16_bf16 v[32:47], v[68:71], v[48:51], v[32:47]
    ds_read_b128 v[68:71], v78 offset:27648
    v_exp_f32 v12, v12
    v_exp_f32 v13, v13
    v_exp_f32 v14, v14
    v_exp_f32 v15, v15
    v_cvt_pk_bf16_f32 v54, v12, v13
    v_cvt_pk_bf16_f32 v55, v14, v15
    s_waitcnt lgkmcnt(3)
    v_mfma_f32_32x32x16_bf16 v[0:15], v[56:59], v[64:67], 0
    ds_read_b128 v[56:59], v76 offset:33792
    v_exp_f32 v16, v16
    v_exp_f32 v17, v17
    v_exp_f32 v18, v18
    v_exp_f32 v19, v19
    v_cvt_pk_bf16_f32 v48, v16, v17
    v_cvt_pk_bf16_f32 v49, v18, v19
    s_waitcnt lgkmcnt(3)
    v_mfma_f32_32x32x8_bf16 v[0:15], v[60:61], v[62:63], v[0:15]
    ds_read_b64 v[60:61], v77 offset:33792
    v_exp_f32 v20, v20
    v_exp_f32 v21, v21
    v_exp_f32 v22, v22
    v_exp_f32 v23, v23
    v_cvt_pk_bf16_f32 v50, v20, v21
    v_cvt_pk_bf16_f32 v51, v22, v23
    s_waitcnt lgkmcnt(3)
    v_mfma_f32_32x32x16_bf16 v[32:47], v[72:75], v[52:55], v[32:47]
    ds_read_b128 v[72:75], v79 offset:27648
    s_add_u32 m0, s58, 0
    s_add_u32 s36, s59, 0
    buffer_load_dwordx4 v255, s[8:11], s36 offen lds
    v_exp_f32 v24, v24
    v_exp_f32 v25, v25
    v_exp_f32 v26, v26
    v_exp_f32 v27, v27
    v_cvt_pk_bf16_f32 v52, v24, v25
    v_cvt_pk_bf16_f32 v53, v26, v27
    s_waitcnt lgkmcnt(3)
    v_mfma_f32_32x32x16_bf16 v[32:47], v[68:71], v[48:51], v[32:47]
    ds_read_b128 v[68:71], v78 offset:30720
    v_exp_f32 v28, v28
    v_exp_f32 v29, v29
    v_exp_f32 v30, v30
    v_exp_f32 v31, v31
    v_cvt_pk_bf16_f32 v54, v28, v29
    v_cvt_pk_bf16_f32 v55, v30, v31
    s_setprio 2
    s_waitcnt lgkmcnt(3)
    v_mfma_f32_32x32x16_bf16 v[16:31], v[56:59], v[64:67], 0
    ds_read_b128 v[56:59], v76 offset:36864
    v_exp_f32 v0, v0
    v_exp_f32 v1, v1
    v_exp_f32 v2, v2
    v_exp_f32 v3, v3
    v_cvt_pk_bf16_f32 v48, v0, v1
    v_cvt_pk_bf16_f32 v49, v2, v3
    s_waitcnt lgkmcnt(3)
    v_mfma_f32_32x32x8_bf16 v[16:31], v[60:61], v[62:63], v[16:31]
    ds_read_b64 v[60:61], v77 offset:36864
    v_exp_f32 v4, v4
    v_exp_f32 v5, v5
    v_exp_f32 v6, v6
    v_exp_f32 v7, v7
    v_cvt_pk_bf16_f32 v50, v4, v5
    v_cvt_pk_bf16_f32 v51, v6, v7
    s_waitcnt lgkmcnt(3)
    v_mfma_f32_32x32x16_bf16 v[32:47], v[72:75], v[52:55], v[32:47]
    ds_read_b128 v[72:75], v79 offset:30720
    s_cmp_ge_u32 s12, 4
    s_cbranch_scc1 L_b2h_94
    s_add_u32 s36, s52, 1024
    buffer_load_dwordx2 v[140:141], v137, s[8:11], s36 offen sc1
    s_branch L_b2e_95
L_b2h_94:
    s_add_u32 s36, s61, 1904640
    buffer_load_dwordx4 v[202:205], v244, s[20:23], s36 offen
L_b2e_95:
    v_exp_f32 v8, v8
    v_exp_f32 v9, v9
    v_exp_f32 v10, v10
    v_exp_f32 v11, v11
    v_cvt_pk_bf16_f32 v52, v8, v9
    v_cvt_pk_bf16_f32 v53, v10, v11
    s_waitcnt lgkmcnt(3)
    v_mfma_f32_32x32x16_bf16 v[32:47], v[68:71], v[48:51], v[32:47]
    ds_read_b128 v[68:71], v78 offset:33792
    v_exp_f32 v12, v12
    v_exp_f32 v13, v13
    v_exp_f32 v14, v14
    v_exp_f32 v15, v15
    v_cvt_pk_bf16_f32 v54, v12, v13
    v_cvt_pk_bf16_f32 v55, v14, v15
    s_waitcnt lgkmcnt(3)
    v_mfma_f32_32x32x16_bf16 v[0:15], v[56:59], v[64:67], 0
    ds_read_b128 v[56:59], v76 offset:39936
    v_exp_f32 v16, v16
    v_exp_f32 v17, v17
    v_exp_f32 v18, v18
    v_exp_f32 v19, v19
    v_cvt_pk_bf16_f32 v48, v16, v17
    v_cvt_pk_bf16_f32 v49, v18, v19
    s_waitcnt lgkmcnt(3)
    v_mfma_f32_32x32x8_bf16 v[0:15], v[60:61], v[62:63], v[0:15]
    ds_read_b64 v[60:61], v77 offset:39936
    v_exp_f32 v20, v20
    v_exp_f32 v21, v21
    v_exp_f32 v22, v22
    v_exp_f32 v23, v23
    v_cvt_pk_bf16_f32 v50, v20, v21
    v_cvt_pk_bf16_f32 v51, v22, v23
    s_waitcnt lgkmcnt(3)
    v_mfma_f32_32x32x16_bf16 v[32:47], v[72:75], v[52:55], v[32:47]
    ds_read_b128 v[72:75], v79 offset:33792
    s_add_u32 m0, s58, 8192
    s_add_u32 s36, s59, 8192
    buffer_load_dwordx4 v255, s[8:11], s36 offen lds
    v_exp_f32 v24, v24
    v_exp_f32 v25, v25
    v_exp_f32 v26, v26
    v_exp_f32 v27, v27
    v_cvt_pk_bf16_f32 v52, v24, v25
    v_cvt_pk_bf16_f32 v53, v26, v27
    buffer_load_dword v136, v88, s[8:11], s42 offen sc1
    s_waitcnt lgkmcnt(3)
    v_mfma_f32_32x32x16_bf16 v[32:47], v[68:71], v[48:51], v[32:47]
    ds_read_b128 v[68:71], v78 offset:36864
    v_exp_f32 v28, v28
    v_exp_f32 v29, v29
    v_exp_f32 v30, v30
    v_exp_f32 v31, v31
    v_cvt_pk_bf16_f32 v54, v28, v29
    v_cvt_pk_bf16_f32 v55, v30, v31
    s_setprio 1
    s_waitcnt lgkmcnt(3)
    v_mfma_f32_32x32x16_bf16 v[16:31], v[56:59], v[64:67], 0
    ds_read_b128 v[56:59], v76 offset:43008
    v_exp_f32 v0, v0
    v_exp_f32 v1, v1
    v_exp_f32 v2, v2
    v_exp_f32 v3, v3
    v_cvt_pk_bf16_f32 v48, v0, v1
    v_cvt_pk_bf16_f32 v49, v2, v3
    s_waitcnt lgkmcnt(3)
    v_mfma_f32_32x32x8_bf16 v[16:31], v[60:61], v[62:63], v[16:31]
    ds_read_b64 v[60:61], v77 offset:43008
    v_exp_f32 v4, v4
    v_exp_f32 v5, v5
    v_exp_f32 v6, v6
    v_exp_f32 v7, v7
    v_cvt_pk_bf16_f32 v50, v4, v5
    v_cvt_pk_bf16_f32 v51, v6, v7
    s_waitcnt lgkmcnt(3)
    v_mfma_f32_32x32x16_bf16 v[32:47], v[72:75], v[52:55], v[32:47]
    ds_read_b128 v[72:75], v79 offset:36864
    v_exp_f32 v8, v8
    v_exp_f32 v9, v9
    v_exp_f32 v10, v10
    v_exp_f32 v11, v11
    v_cvt_pk_bf16_f32 v52, v8, v9
    v_cvt_pk_bf16_f32 v53, v10, v11
    s_waitcnt lgkmcnt(3)
    v_mfma_f32_32x32x16_bf16 v[32:47], v[68:71], v[48:51], v[32:47]
    ds_read_b128 v[68:71], v78 offset:39936
    v_exp_f32 v12, v12
    v_exp_f32 v13, v13
    v_exp_f32 v14, v14
    v_exp_f32 v15, v15
    v_cvt_pk_bf16_f32 v54, v12, v13
    v_cvt_pk_bf16_f32 v55, v14, v15
    s_setprio 0
    s_waitcnt lgkmcnt(3)
    v_mfma_f32_32x32x16_bf16 v[0:15], v[56:59], v[64:67], 0
    ds_read_b128 v[56:59], v76 offset:46080
    v_exp_f32 v16, v16
    v_exp_f32 v17, v17
    v_exp_f32 v18, v18
    v_exp_f32 v19, v19
    v_cvt_pk_bf16_f32 v48, v16, v17
    v_cvt_pk_bf16_f32 v49, v18, v19
    s_waitcnt lgkmcnt(3)
    v_mfma_f32_32x32x8_bf16 v[0:15], v[60:61], v[62:63], v[0:15]
    ds_read_b64 v[60:61], v77 offset:46080
    v_exp_f32 v20, v20
    v_exp_f32 v21, v21
    v_exp_f32 v22, v22
    v_exp_f32 v23, v23
    v_cvt_pk_bf16_f32 v50, v20, v21
    v_cvt_pk_bf16_f32 v51, v22, v23
    s_waitcnt lgkmcnt(3)
    v_mfma_f32_32x32x16_bf16 v[32:47], v[72:75], v[52:55], v[32:47]
    ds_read_b128 v[72:75], v79 offset:39936
    v_exp_f32 v24, v24
    v_exp_f32 v25, v25
    v_exp_f32 v26, v26
    v_exp_f32 v27, v27
    v_cvt_pk_bf16_f32 v52, v24, v25
    v_cvt_pk_bf16_f32 v53, v26, v27
    s_waitcnt lgkmcnt(3)
    v_mfma_f32_32x32x16_bf16 v[32:47], v[68:71], v[48:51], v[32:47]
    ds_read_b128 v[68:71], v78 offset:43008
    v_exp_f32 v28, v28
    v_exp_f32 v29, v29
    v_exp_f32 v30, v30
    v_exp_f32 v31, v31
    v_cvt_pk_bf16_f32 v54, v28, v29
    v_cvt_pk_bf16_f32 v55, v30, v31
    s_waitcnt vmcnt(5)
    s_waitcnt vmcnt(0)
    s_barrier
    s_setprio 3
    v_cmp_gt_u32 vcc, s57, v136
    s_mov_b32 s43, vcc_lo
    s_andn2_b32 s55, s44, s43
    s_cbranch_scc1 L_af_ok_96
    s_mov_b32 s37, 400000
L_af_sp_97:
    buffer_load_dword v136, v88, s[8:11], s42 offen sc1
    s_waitcnt vmcnt(0)
    v_cmp_gt_u32 vcc, s57, v136
    s_mov_b32 s43, vcc_lo
    s_andn2_b32 s55, s44, s43
    s_cbranch_scc1 L_af_ok_96
    s_sub_u32 s37, s37, 1
    s_cmp_lg_u32 s37, 0
    s_cbranch_scc1 L_af_sp_97
    s_mov_b32 s55, s44
L_af_ok_96:
    s_flbit_i32_b32 s55, s55
    s_sub_u32 s55, 31, s55
    s_bitset0_b32 s44, s55
    s_and_b32 s55, s55, 7
    s_mul_i32 s47, s55, 656384
    s_add_u32 s47, s47, s46
    s_waitcnt lgkmcnt(3)
    v_mfma_f32_32x32x16_bf16 v[16:31], v[56:59], v[64:67], 0
    ds_read_b128 v[56:59], v132 offset:16384
    v_exp_f32 v0, v0
    v_exp_f32 v1, v1
    v_exp_f32 v2, v2
    v_exp_f32 v3, v3
    v_cvt_pk_bf16_f32 v48, v0, v1
    v_cvt_pk_bf16_f32 v49, v2, v3
    s_waitcnt lgkmcnt(3)
    v_mfma_f32_32x32x8_bf16 v[16:31], v[60:61], v[62:63], v[16:31]
    ds_read_b64 v[60:61], v133 offset:16384
    v_exp_f32 v4, v4
    v_exp_f32 v5, v5
    v_exp_f32 v6, v6
    v_exp_f32 v7, v7
    v_cvt_pk_bf16_f32 v50, v4, v5
    v_cvt_pk_bf16_f32 v51, v6, v7
    s_waitcnt lgkmcnt(3)
    v_mfma_f32_32x32x16_bf16 v[32:47], v[72:75], v[52:55], v[32:47]
    ds_read_b128 v[72:75], v79 offset:43008
    s_add_u32 m0, s41, 0
    s_nop 0
    buffer_load_dwordx4 v249, s[32:35], s47 offen offset:0 sc1 lds
    v_exp_f32 v8, v8
    v_exp_f32 v9, v9
    v_exp_f32 v10, v10
    v_exp_f32 v11, v11
    v_cvt_pk_bf16_f32 v52, v8, v9
    v_cvt_pk_bf16_f32 v53, v10, v11
    s_waitcnt lgkmcnt(3)
    v_mfma_f32_32x32x16_bf16 v[32:47], v[68:71], v[48:51], v[32:47]
    ds_read_b128 v[68:71], v78 offset:46080
    v_exp_f32 v12, v12
    v_exp_f32 v13, v13
    v_exp_f32 v14, v14
    v_exp_f32 v15, v15
    v_cvt_pk_bf16_f32 v54, v12, v13
    v_cvt_pk_bf16_f32 v55, v14, v15
    s_add_u32 m0, s41, 0
    s_nop 0
    buffer_load_dwordx4 v250, s[32:35], s47 offen offset:1024 sc1 lds
    s_waitcnt lgkmcnt(3)
    v_mfma_f32_32x32x16_bf16 v[0:15], v[56:59], v[64:67], 0
    ds_read_b128 v[56:59], v132 offset:19456
    v_exp_f32 v16, v16
    v_exp_f32 v17, v17
    v_exp_f32 v18, v18
    v_exp_f32 v19, v19
    v_cvt_pk_bf16_f32 v48, v16, v17
    v_cvt_pk_bf16_f32 v49, v18, v19
    s_waitcnt lgkmcnt(3)
    v_mfma_f32_32x32x8_bf16 v[0:15], v[60:61], v[62:63], v[0:15]
    ds_read_b64 v[60:61], v133 offset:19456
    v_exp_f32 v20, v20
    v_exp_f32 v21, v21
    v_exp_f32 v22, v22
    v_exp_f32 v23, v23
    v_cvt_pk_bf16_f32 v50, v20, v21
    v_cvt_pk_bf16_f32 v51, v22, v23
    s_waitcnt lgkmcnt(3)
    v_mfma_f32_32x32x16_bf16 v[32:47], v[72:75], v[52:55], v[32:47]
    ds_read_b128 v[72:75], v79 offset:46080
    s_add_u32 m0, s41, 0
    s_nop 0
    buffer_load_dwordx4 v251, s[32:35], s47 offen offset:2048 sc1 lds
    v_exp_f32 v24, v24
    v_exp_f32 v25, v25
    v_exp_f32 v26, v26
    v_exp_f32 v27, v27
    v_cvt_pk_bf16_f32 v52, v24, v25
    v_cvt_pk_bf16_f32 v53, v26, v27
    s_waitcnt lgkmcnt(3)
    v_mfma_f32_32x32x16_bf16 v[32:47], v[68:71], v[48:51], v[32:47]
    ds_read_b128 v[68:71], v134 offset:16384
    v_exp_f32 v28, v28
    v_exp_f32 v29, v29
    v_exp_f32 v30, v30
    v_exp_f32 v31, v31
    v_cvt_pk_bf16_f32 v54, v28, v29
    v_cvt_pk_bf16_f32 v55, v30, v31
    s_waitcnt lgkmcnt(3)
    v_mfma_f32_32x32x16_bf16 v[16:31], v[56:59], v[64:67], 0
    ds_read_b128 v[56:59], v132 offset:22528
    v_exp_f32 v0, v0
    v_exp_f32 v1, v1
    v_exp_f32 v2, v2
    v_exp_f32 v3, v3
    v_cvt_pk_bf16_f32 v48, v0, v1
    v_cvt_pk_bf16_f32 v49, v2, v3
    s_waitcnt lgkmcnt(3)
    v_mfma_f32_32x32x8_bf16 v[16:31], v[60:61], v[62:63], v[16:31]
    ds_read_b64 v[60:61], v133 offset:22528
    v_exp_f32 v4, v4
    v_exp_f32 v5, v5
    v_exp_f32 v6, v6
    v_exp_f32 v7, v7
    v_cvt_pk_bf16_f32 v50, v4, v5
    v_cvt_pk_bf16_f32 v51, v6, v7
    s_waitcnt lgkmcnt(3)
    v_mfma_f32_32x32x16_bf16 v[32:47], v[72:75], v[52:55], v[32:47]
    ds_read_b128 v[72:75], v135 offset:16384
    s_cmp_ge_u32 s12, 4
    s_cbranch_scc1 L_b2h_98
    s_add_u32 s36, s52, 2048
    buffer_load_dwordx2 v[142:143], v137, s[8:11], s36 offen sc1
    s_branch L_b2e_99
L_b2h_98:
    s_add_u32 s36, s61, 1966080
    buffer_load_dwordx4 v[206:209], v244, s[20:23], s36 offen
L_b2e_99:
    v_exp_f32 v8, v8
    v_exp_f32 v9, v9
    v_exp_f32 v10, v10
    v_exp_f32 v11, v11
    v_cvt_pk_bf16_f32 v52, v8, v9
    v_cvt_pk_bf16_f32 v53, v10, v11
    s_waitcnt lgkmcnt(3)
    v_mfma_f32_32x32x16_bf16 v[32:47], v[68:71], v[48:51], v[32:47]
    ds_read_b128 v[68:71], v134 offset:19456
    v_exp_f32 v12, v12
    v_exp_f32 v13, v13
    v_exp_f32 v14, v14
    v_exp_f32 v15, v15
    v_cvt_pk_bf16_f32 v54, v12, v13
    v_cvt_pk_bf16_f32 v55, v14, v15
    s_waitcnt lgkmcnt(3)
    v_mfma_f32_32x32x16_bf16 v[0:15], v[56:59], v[64:67], 0
    ds_read_b128 v[56:59], v132 offset:25600
    v_exp_f32 v16, v16
    v_exp_f32 v17, v17
    v_exp_f32 v18, v18
    v_exp_f32 v19, v19
    v_cvt_pk_bf16_f32 v48, v16, v17
    v_cvt_pk_bf16_f32 v49, v18, v19
    s_waitcnt lgkmcnt(3)
    v_mfma_f32_32x32x8_bf16 v[0:15], v[60:61], v[62:63], v[0:15]
    ds_read_b64 v[60:61], v133 offset:25600
    v_exp_f32 v20, v20
    v_exp_f32 v21, v21
    v_exp_f32 v22, v22
    v_exp_f32 v23, v23
    v_cvt_pk_bf16_f32 v50, v20, v21
    v_cvt_pk_bf16_f32 v51, v22, v23
    s_waitcnt lgkmcnt(3)
    v_mfma_f32_32x32x16_bf16 v[32:47], v[72:75], v[52:55], v[32:47]
    ds_read_b128 v[72:75], v135 offset:19456
    s_add_u32 m0, s58, 16384
    s_add_u32 s36, s59, 16384
    buffer_load_dwordx4 v255, s[8:11], s36 offen lds
    v_exp_f32 v24, v24
    v_exp_f32 v25, v25
    v_exp_f32 v26, v26
    v_exp_f32 v27, v27
    v_cvt_pk_bf16_f32 v52, v24, v25
    v_cvt_pk_bf16_f32 v53, v26, v27
    s_waitcnt lgkmcnt(3)
    v_mfma_f32_32x32x16_bf16 v[32:47], v[68:71], v[48:51], v[32:47]
    ds_read_b128 v[68:71], v134 offset:22528
    v_exp_f32 v28, v28
    v_exp_f32 v29, v29
    v_exp_f32 v30, v30
    v_exp_f32 v31, v31
    v_cvt_pk_bf16_f32 v54, v28, v29
    v_cvt_pk_bf16_f32 v55, v30, v31
    s_setprio 2
    s_waitcnt lgkmcnt(3)
    v_mfma_f32_32x32x16_bf16 v[16:31], v[56:59], v[64:67], 0
    ds_read_b128 v[56:59], v132 offset:28672
    v_exp_f32 v0, v0
    v_exp_f32 v1, v1
    v_exp_f32 v2, v2
    v_exp_f32 v3, v3
    v_cvt_pk_bf16_f32 v48, v0, v1
    v_cvt_pk_bf16_f32 v49, v2, v3
    s_waitcnt lgkmcnt(3)
    v_mfma_f32_32x32x8_bf16 v[16:31], v[60:61], v[62:63], v[16:31]
    ds_read_b64 v[60:61], v133 offset:28672
    v_exp_f32 v4, v4
    v_exp_f32 v5, v5
    v_exp_f32 v6, v6
    v_exp_f32 v7, v7
    v_cvt_pk_bf16_f32 v50, v4, v5
    v_cvt_pk_bf16_f32 v51, v6, v7
    s_waitcnt lgkmcnt(3)
    v_mfma_f32_32x32x16_bf16 v[32:47], v[72:75], v[52:55], v[32:47]
    ds_read_b128 v[72:75], v135 offset:22528
    s_cmp_ge_u32 s12, 4
    s_cbranch_scc1 L_b2h_100
    s_add_u32 s36, s52, 3072
    buffer_load_dwordx2 v[144:145], v137, s[8:11], s36 offen sc1
    s_branch L_b2e_101
L_b2h_100:
    s_add_u32 s36, s61, 2027520
    buffer_load_dwordx4 v[210:213], v244, s[20:23], s36 offen
L_b2e_101:
    v_exp_f32 v8, v8
    v_exp_f32 v9, v9
    v_exp_f32 v10, v10
    v_exp_f32 v11, v11
    v_cvt_pk_bf16_f32 v52, v8, v9
    v_cvt_pk_bf16_f32 v53, v10, v11
    s_waitcnt lgkmcnt(3)
    v_mfma_f32_32x32x16_bf16 v[32:47], v[68:71], v[48:51], v[32:47]
    ds_read_b128 v[68:71], v134 offset:25600
    v_exp_f32 v12, v12
    v_exp_f32 v13, v13
    v_exp_f32 v14, v14
    v_exp_f32 v15, v15
    v_cvt_pk_bf16_f32 v54, v12, v13
    v_cvt_pk_bf16_f32 v55, v14, v15
    s_waitcnt lgkmcnt(3)
    v_mfma_f32_32x32x16_bf16 v[0:15], v[56:59], v[64:67], 0
    ds_read_b128 v[56:59], v132 offset:31744
    v_exp_f32 v16, v16
    v_exp_f32 v17, v17
    v_exp_f32 v18, v18
    v_exp_f32 v19, v19
    v_cvt_pk_bf16_f32 v48, v16, v17
    v_cvt_pk_bf16_f32 v49, v18, v19
    s_waitcnt lgkmcnt(3)
    v_mfma_f32_32x32x8_bf16 v[0:15], v[60:61], v[62:63], v[0:15]
    ds_read_b64 v[60:61], v133 offset:31744
    v_exp_f32 v20, v20
    v_exp_f32 v21, v21
    v_exp_f32 v22, v22
    v_exp_f32 v23, v23
    v_cvt_pk_bf16_f32 v50, v20, v21
    v_cvt_pk_bf16_f32 v51, v22, v23
    s_waitcnt lgkmcnt(3)
    v_mfma_f32_32x32x16_bf16 v[32:47], v[72:75], v[52:55], v[32:47]
    ds_read_b128 v[72:75], v135 offset:25600
    s_add_u32 m0, s58, 24576
    s_add_u32 s36, s59, 24576
    buffer_load_dwordx4 v255, s[8:11], s36 offen lds
    v_exp_f32 v24, v24
    v_exp_f32 v25, v25
    v_exp_f32 v26, v26
    v_exp_f32 v27, v27
    v_cvt_pk_bf16_f32 v52, v24, v25
    v_cvt_pk_bf16_f32 v53, v26, v27
    buffer_load_dword v136, v88, s[8:11], s42 offen sc1
    s_waitcnt lgkmcnt(3)
    v_mfma_f32_32x32x16_bf16 v[32:47], v[68:71], v[48:51], v[32:47]
    ds_read_b128 v[68:71], v134 offset:28672
    v_exp_f32 v28, v28
    v_exp_f32 v29, v29
    v_exp_f32 v30, v30
    v_exp_f32 v31, v31
    v_cvt_pk_bf16_f32 v54, v28, v29
    v_cvt_pk_bf16_f32 v55, v30, v31
    s_setprio 1
    s_waitcnt lgkmcnt(3)
    v_mfma_f32_32x32x16_bf16 v[16:31], v[56:59], v[64:67], 0
    ds_read_b128 v[56:59], v132 offset:34816
    v_exp_f32 v0, v0
    v_exp_f32 v1, v1
    v_exp_f32 v2, v2
    v_exp_f32 v3, v3
    v_cvt_pk_bf16_f32 v48, v0, v1
    v_cvt_pk_bf16_f32 v49, v2, v3
    s_waitcnt lgkmcnt(3)
    v_mfma_f32_32x32x8_bf16 v[16:31], v[60:61], v[62:63], v[16:31]
    ds_read_b64 v[60:61], v133 offset:34816
    v_exp_f32 v4, v4
    v_exp_f32 v5, v5
    v_exp_f32 v6, v6
    v_exp_f32 v7, v7
    v_cvt_pk_bf16_f32 v50, v4, v5
    v_cvt_pk_bf16_f32 v51, v6, v7
    s_waitcnt lgkmcnt(3)
    v_mfma_f32_32x32x16_bf16 v[32:47], v[72:75], v[52:55], v[32:47]
    ds_read_b128 v[72:75], v135 offset:28672
    v_exp_f32 v8, v8
    v_exp_f32 v9, v9
    v_exp_f32 v10, v10
    v_exp_f32 v11, v11
    v_cvt_pk_bf16_f32 v52, v8, v9
    v_cvt_pk_bf16_f32 v53, v10, v11
    s_waitcnt lgkmcnt(3)
    v_mfma_f32_32x32x16_bf16 v[32:47], v[68:71], v[48:51], v[32:47]
    ds_read_b128 v[68:71], v134 offset:31744
    v_exp_f32 v12, v12
    v_exp_f32 v13, v13
    v_exp_f32 v14, v14
    v_exp_f32 v15, v15
    v_cvt_pk_bf16_f32 v54, v12, v13
    v_cvt_pk_bf16_f32 v55, v14, v15
    s_setprio 0
    s_waitcnt lgkmcnt(3)
    v_mfma_f32_32x32x16_bf16 v[0:15], v[56:59], v[64:67], 0
    ds_read_b128 v[56:59], v132 offset:37888
    v_exp_f32 v16, v16
    v_exp_f32 v17, v17
    v_exp_f32 v18, v18
    v_exp_f32 v19, v19
    v_cvt_pk_bf16_f32 v48, v16, v17
    v_cvt_pk_bf16_f32 v49, v18, v19
    s_waitcnt lgkmcnt(3)
    v_mfma_f32_32x32x8_bf16 v[0:15], v[60:61], v[62:63], v[0:15]
    ds_read_b64 v[60:61], v133 offset:37888
    v_exp_f32 v20, v20
    v_exp_f32 v21, v21
    v_exp_f32 v22, v22
    v_exp_f32 v23, v23
    v_cvt_pk_bf16_f32 v50, v20, v21
    v_cvt_pk_bf16_f32 v51, v22, v23
    s_waitcnt lgkmcnt(3)
    v_mfma_f32_32x32x16_bf16 v[32:47], v[72:75], v[52:55], v[32:47]
    ds_read_b128 v[72:75], v135 offset:31744
    v_exp_f32 v24, v24
    v_exp_f32 v25, v25
    v_exp_f32 v26, v26
    v_exp_f32 v27, v27
    v_cvt_pk_bf16_f32 v52, v24, v25
    v_cvt_pk_bf16_f32 v53, v26, v27
    s_waitcnt lgkmcnt(3)
    v_mfma_f32_32x32x16_bf16 v[32:47], v[68:71], v[48:51], v[32:47]
    ds_read_b128 v[68:71], v134 offset:34816
    v_exp_f32 v28, v28
    v_exp_f32 v29, v29
    v_exp_f32 v30, v30
    v_exp_f32 v31, v31
    v_cvt_pk_bf16_f32 v54, v28, v29
    v_cvt_pk_bf16_f32 v55, v30, v31
    s_waitcnt vmcnt(5)
    s_waitcnt vmcnt(0)
    s_barrier
    s_setprio 3
    v_cmp_gt_u32 vcc, s57, v136
    s_mov_b32 s43, vcc_lo
    s_andn2_b32 s55, s44, s43
    s_cbranch_scc1 L_af_ok_102
    s_mov_b32 s37, 400000
L_af_sp_103:
    buffer_load_dword v136, v88, s[8:11], s42 offen sc1
    s_waitcnt vmcnt(0)
    v_cmp_gt_u32 vcc, s57, v136
    s_mov_b32 s43, vcc_lo
    s_andn2_b32 s55, s44, s43
    s_cbranch_scc1 L_af_ok_102
    s_sub_u32 s37, s37, 1
    s_cmp_lg_u32 s37, 0
    s_cbranch_scc1 L_af_sp_103
    s_mov_b32 s55, s44
L_af_ok_102:
    s_flbit_i32_b32 s55, s55
    s_sub_u32 s55, 31, s55
    s_bitset0_b32 s44, s55
    s_and_b32 s55, s55, 7
    s_mul_i32 s47, s55, 656384
    s_add_u32 s47, s47, s46
    s_waitcnt lgkmcnt(3)
    v_mfma_f32_32x32x16_bf16 v[16:31], v[56:59], v[64:67], 0
    ds_read_b128 v[56:59], v76 offset:0
    v_exp_f32 v0, v0
    v_exp_f32 v1, v1
    v_exp_f32 v2, v2
    v_exp_f32 v3, v3
    v_cvt_pk_bf16_f32 v48, v0, v1
    v_cvt_pk_bf16_f32 v49, v2, v3
    s_waitcnt lgkmcnt(3)
    v_mfma_f32_32x32x8_bf16 v[16:31], v[60:61], v[62:63], v[16:31]
    ds_read_b64 v[60:61], v77 offset:0
    v_exp_f32 v4, v4
    v_exp_f32 v5, v5
    v_exp_f32 v6, v6
    v_exp_f32 v7, v7
    v_cvt_pk_bf16_f32 v50, v4, v5
    v_cvt_pk_bf16_f32 v51, v6, v7
    s_waitcnt lgkmcnt(3)
    v_mfma_f32_32x32x16_bf16 v[32:47], v[72:75], v[52:55], v[32:47]
    ds_read_b128 v[72:75], v135 offset:34816
    s_add_u32 m0, s41, 24576
    s_nop 0
    buffer_load_dwordx4 v249, s[32:35], s47 offen offset:0 sc1 lds
    v_exp_f32 v8, v8
    v_exp_f32 v9, v9
    v_exp_f32 v10, v10
    v_exp_f32 v11, v11
    v_cvt_pk_bf16_f32 v52, v8, v9
    v_cvt_pk_bf16_f32 v53, v10, v11
    s_waitcnt lgkmcnt(3)
    v_mfma_f32_32x32x16_bf16 v[32:47], v[68:71], v[48:51], v[32:47]
    ds_read_b128 v[68:71], v134 offset:37888
    v_exp_f32 v12, v12
    v_exp_f32 v13, v13
    v_exp_f32 v14, v14
    v_exp_f32 v15, v15
    v_cvt_pk_bf16_f32 v54, v12, v13
    v_cvt_pk_bf16_f32 v55, v14, v15
    s_add_u32 m0, s41, 24576
    s_nop 0
    buffer_load_dwordx4 v250, s[32:35], s47 offen offset:1024 sc1 lds
    s_waitcnt lgkmcnt(3)
    v_mfma_f32_32x32x16_bf16 v[0:15], v[56:59], v[64:67], 0
    ds_read_b128 v[56:59], v76 offset:3072
    v_exp_f32 v16, v16
    v_exp_f32 v17, v17
    v_exp_f32 v18, v18
    v_exp_f32 v19, v19
    v_cvt_pk_bf16_f32 v48, v16, v17
    v_cvt_pk_bf16_f32 v49, v18, v19
    s_waitcnt lgkmcnt(3)
    v_mfma_f32_32x32x8_bf16 v[0:15], v[60:61], v[62:63], v[0:15]
    ds_read_b64 v[60:61], v77 offset:3072
    v_exp_f32 v20, v20
    v_exp_f32 v21, v21
    v_exp_f32 v22, v22
    v_exp_f32 v23, v23
    v_cvt_pk_bf16_f32 v50, v20, v21
    v_cvt_pk_bf16_f32 v51, v22, v23
    s_waitcnt lgkmcnt(3)
    v_mfma_f32_32x32x16_bf16 v[32:47], v[72:75], v[52:55], v[32:47]
    ds_read_b128 v[72:75], v135 offset:37888
    s_add_u32 m0, s41, 24576
    s_nop 0
    buffer_load_dwordx4 v251, s[32:35], s47 offen offset:2048 sc1 lds
    v_exp_f32 v24, v24
    v_exp_f32 v25, v25
    v_exp_f32 v26, v26
    v_exp_f32 v27, v27
    v_cvt_pk_bf16_f32 v52, v24, v25
    v_cvt_pk_bf16_f32 v53, v26, v27
    s_waitcnt lgkmcnt(3)
    v_mfma_f32_32x32x16_bf16 v[32:47], v[68:71], v[48:51], v[32:47]
    ds_read_b128 v[68:71], v78 offset:0
    v_exp_f32 v28, v28
    v_exp_f32 v29, v29
    v_exp_f32 v30, v30
    v_exp_f32 v31, v31
    v_cvt_pk_bf16_f32 v54, v28, v29
    v_cvt_pk_bf16_f32 v55, v30, v31
    s_waitcnt lgkmcnt(3)
    v_mfma_f32_32x32x16_bf16 v[16:31], v[56:59], v[64:67], 0
    ds_read_b128 v[56:59], v76 offset:6144
    v_exp_f32 v0, v0
    v_exp_f32 v1, v1
    v_exp_f32 v2, v2
    v_exp_f32 v3, v3
    v_cvt_pk_bf16_f32 v48, v0, v1
    v_cvt_pk_bf16_f32 v49, v2, v3
    s_waitcnt lgkmcnt(3)
    v_mfma_f32_32x32x8_bf16 v[16:31], v[60:61], v[62:63], v[16:31]
    ds_read_b64 v[60:61], v77 offset:6144
    v_exp_f32 v4, v4
    v_exp_f32 v5, v5
    v_exp_f32 v6, v6
    v_exp_f32 v7, v7
    v_cvt_pk_bf16_f32 v50, v4, v5
    v_cvt_pk_bf16_f32 v51, v6, v7
    s_waitcnt lgkmcnt(3)
    v_mfma_f32_32x32x16_bf16 v[32:47], v[72:75], v[52:55], v[32:47]
    ds_read_b128 v[72:75], v79 offset:0
    s_cmp_ge_u32 s12, 4
    s_cbranch_scc1 L_b2h_104
    s_add_u32 s36, s52, 4096
    buffer_load_dwordx2 v[146:147], v137, s[8:11], s36 offen sc1
    s_branch L_b2e_105
L_b2h_104:
    s_add_u32 s36, s61, 2088960
    buffer_load_dwordx4 v[214:217], v244, s[20:23], s36 offen
L_b2e_105:
    v_exp_f32 v8, v8
    v_exp_f32 v9, v9
    v_exp_f32 v10, v10
    v_exp_f32 v11, v11
    v_cvt_pk_bf16_f32 v52, v8, v9
    v_cvt_pk_bf16_f32 v53, v10, v11
    s_waitcnt lgkmcnt(3)
    v_mfma_f32_32x32x16_bf16 v[32:47], v[68:71], v[48:51], v[32:47]
    ds_read_b128 v[68:71], v78 offset:3072
    v_exp_f32 v12, v12
    v_exp_f32 v13, v13
    v_exp_f32 v14, v14
    v_exp_f32 v15, v15
    v_cvt_pk_bf16_f32 v54, v12, v13
    v_cvt_pk_bf16_f32 v55, v14, v15
    s_waitcnt lgkmcnt(3)
    v_mfma_f32_32x32x16_bf16 v[0:15], v[56:59], v[64:67], 0
    ds_read_b128 v[56:59], v76 offset:9216
    v_exp_f32 v16, v16
    v_exp_f32 v17, v17
    v_exp_f32 v18, v18
    v_exp_f32 v19, v19
    v_cvt_pk_bf16_f32 v48, v16, v17
    v_cvt_pk_bf16_f32 v49, v18, v19
    s_waitcnt lgkmcnt(3)
    v_mfma_f32_32x32x8_bf16 v[0:15], v[60:61], v[62:63], v[0:15]
    ds_read_b64 v[60:61], v77 offset:9216
    v_exp_f32 v20, v20
    v_exp_f32 v21, v21
    v_exp_f32 v22, v22
    v_exp_f32 v23, v23
    v_cvt_pk_bf16_f32 v50, v20, v21
    v_cvt_pk_bf16_f32 v51, v22, v23
    s_waitcnt lgkmcnt(3)
    v_mfma_f32_32x32x16_bf16 v[32:47], v[72:75], v[52:55], v[32:47]
    ds_read_b128 v[72:75], v79 offset:3072
    s_add_u32 m0, s58, 32768
    s_add_u32 s36, s59, 32768
    buffer_load_dwordx4 v255, s[8:11], s36 offen lds
    v_exp_f32 v24, v24
    v_exp_f32 v25, v25
    v_exp_f32 v26, v26
    v_exp_f32 v27, v27
    v_cvt_pk_bf16_f32 v52, v24, v25
    v_cvt_pk_bf16_f32 v53, v26, v27
    s_waitcnt lgkmcnt(3)
    v_mfma_f32_32x32x16_bf16 v[32:47], v[68:71], v[48:51], v[32:47]
    ds_read_b128 v[68:71], v78 offset:6144
    v_exp_f32 v28, v28
    v_exp_f32 v29, v29
    v_exp_f32 v30, v30
    v_exp_f32 v31, v31
    v_cvt_pk_bf16_f32 v54, v28, v29
    v_cvt_pk_bf16_f32 v55, v30, v31
    s_setprio 2
    s_waitcnt lgkmcnt(3)
    v_mfma_f32_32x32x16_bf16 v[16:31], v[56:59], v[64:67], 0
    ds_read_b128 v[56:59], v76 offset:12288
    v_exp_f32 v0, v0
    v_exp_f32 v1, v1
    v_exp_f32 v2, v2
    v_exp_f32 v3, v3
    v_cvt_pk_bf16_f32 v48, v0, v1
    v_cvt_pk_bf16_f32 v49, v2, v3
    s_waitcnt lgkmcnt(3)
    v_mfma_f32_32x32x8_bf16 v[16:31], v[60:61], v[62:63], v[16:31]
    ds_read_b64 v[60:61], v77 offset:12288
    v_exp_f32 v4, v4
    v_exp_f32 v5, v5
    v_exp_f32 v6, v6
    v_exp_f32 v7, v7
    v_cvt_pk_bf16_f32 v50, v4, v5
    v_cvt_pk_bf16_f32 v51, v6, v7
    s_waitcnt lgkmcnt(3)
    v_mfma_f32_32x32x16_bf16 v[32:47], v[72:75], v[52:55], v[32:47]
    ds_read_b128 v[72:75], v79 offset:6144
    s_cmp_ge_u32 s12, 4
    s_cbranch_scc1 L_b2h_106
    buffer_load_dword v238, v252, s[8:11], s18 offen sc1
    s_branch L_b2e_107
L_b2h_106:
    s_add_u32 s36, s61, 2150400
    buffer_load_dwordx4 v[218:221], v244, s[20:23], s36 offen
L_b2e_107:
    v_exp_f32 v8, v8
    v_exp_f32 v9, v9
    v_exp_f32 v10, v10
    v_exp_f32 v11, v11
    v_cvt_pk_bf16_f32 v52, v8, v9
    v_cvt_pk_bf16_f32 v53, v10, v11
    s_waitcnt lgkmcnt(3)
    v_mfma_f32_32x32x16_bf16 v[32:47], v[68:71], v[48:51], v[32:47]
    ds_read_b128 v[68:71], v78 offset:9216
    v_exp_f32 v12, v12
    v_exp_f32 v13, v13
    v_exp_f32 v14, v14
    v_exp_f32 v15, v15
    v_cvt_pk_bf16_f32 v54, v12, v13
    v_cvt_pk_bf16_f32 v55, v14, v15
    s_waitcnt lgkmcnt(3)
    v_mfma_f32_32x32x16_bf16 v[0:15], v[56:59], v[64:67], 0
    ds_read_b128 v[56:59], v76 offset:15360
    v_exp_f32 v16, v16
    v_exp_f32 v17, v17
    v_exp_f32 v18, v18
    v_exp_f32 v19, v19
    v_cvt_pk_bf16_f32 v48, v16, v17
    v_cvt_pk_bf16_f32 v49, v18, v19
    s_waitcnt lgkmcnt(3)
    v_mfma_f32_32x32x8_bf16 v[0:15], v[60:61], v[62:63], v[0:15]
    ds_read_b64 v[60:61], v77 offset:15360
    v_exp_f32 v20, v20
    v_exp_f32 v21, v21
    v_exp_f32 v22, v22
    v_exp_f32 v23, v23
    v_cvt_pk_bf16_f32 v50, v20, v21
    v_cvt_pk_bf16_f32 v51, v22, v23
    s_waitcnt lgkmcnt(3)
    v_mfma_f32_32x32x16_bf16 v[32:47], v[72:75], v[52:55], v[32:47]
    ds_read_b128 v[72:75], v79 offset:9216
    s_add_u32 m0, s58, 40960
    s_add_u32 s36, s59, 40960
    buffer_load_dwordx4 v255, s[8:11], s36 offen lds
    v_exp_f32 v24, v24
    v_exp_f32 v25, v25
    v_exp_f32 v26, v26
    v_exp_f32 v27, v27
    v_cvt_pk_bf16_f32 v52, v24, v25
    v_cvt_pk_bf16_f32 v53, v26, v27
    s_waitcnt lgkmcnt(3)
    v_mfma_f32_32x32x16_bf16 v[32:47], v[68:71], v[48:51], v[32:47]
    ds_read_b128 v[68:71], v78 offset:12288
    v_exp_f32 v28, v28
    v_exp_f32 v29, v29
    v_exp_f32 v30, v30
    v_exp_f32 v31, v31
    v_cvt_pk_bf16_f32 v54, v28, v29
    v_cvt_pk_bf16_f32 v55, v30, v31
    s_setprio 1
    s_waitcnt lgkmcnt(3)
    v_mfma_f32_32x32x16_bf16 v[16:31], v[56:59], v[64:67], 0
    ds_read_b128 v[56:59], v76 offset:18432
    v_exp_f32 v0, v0
    v_exp_f32 v1, v1
    v_exp_f32 v2, v2
    v_exp_f32 v3, v3
    v_cvt_pk_bf16_f32 v48, v0, v1
    v_cvt_pk_bf16_f32 v49, v2, v3
    s_waitcnt lgkmcnt(3)
    v_mfma_f32_32x32x8_bf16 v[16:31], v[60:61], v[62:63], v[16:31]
    ds_read_b64 v[60:61], v77 offset:18432
    v_exp_f32 v4, v4
    v_exp_f32 v5, v5
    v_exp_f32 v6, v6
    v_exp_f32 v7, v7
    v_cvt_pk_bf16_f32 v50, v4, v5
    v_cvt_pk_bf16_f32 v51, v6, v7
    s_waitcnt lgkmcnt(3)
    v_mfma_f32_32x32x16_bf16 v[32:47], v[72:75], v[52:55], v[32:47]
    ds_read_b128 v[72:75], v79 offset:12288
    v_exp_f32 v8, v8
    v_exp_f32 v9, v9
    v_exp_f32 v10, v10
    v_exp_f32 v11, v11
    v_cvt_pk_bf16_f32 v52, v8, v9
    v_cvt_pk_bf16_f32 v53, v10, v11
    s_waitcnt lgkmcnt(3)
    v_mfma_f32_32x32x16_bf16 v[32:47], v[68:71], v[48:51], v[32:47]
    ds_read_b128 v[68:71], v78 offset:15360
    v_exp_f32 v12, v12
    v_exp_f32 v13, v13
    v_exp_f32 v14, v14
    v_exp_f32 v15, v15
    v_cvt_pk_bf16_f32 v54, v12, v13
    v_cvt_pk_bf16_f32 v55, v14, v15
    s_setprio 0
    s_waitcnt lgkmcnt(3)
    v_mfma_f32_32x32x16_bf16 v[0:15], v[56:59], v[64:67], 0
    ds_read_b128 v[56:59], v76 offset:21504
    v_exp_f32 v16, v16
    v_exp_f32 v17, v17
    v_exp_f32 v18, v18
    v_exp_f32 v19, v19
    v_cvt_pk_bf16_f32 v48, v16, v17
    v_cvt_pk_bf16_f32 v49, v18, v19
    s_waitcnt lgkmcnt(3)
    v_mfma_f32_32x32x8_bf16 v[0:15], v[60:61], v[62:63], v[0:15]
    ds_read_b64 v[60:61], v77 offset:21504
    v_exp_f32 v20, v20
    v_exp_f32 v21, v21
    v_exp_f32 v22, v22
    v_exp_f32 v23, v23
    v_cvt_pk_bf16_f32 v50, v20, v21
    v_cvt_pk_bf16_f32 v51, v22, v23
    s_waitcnt lgkmcnt(3)
    v_mfma_f32_32x32x16_bf16 v[32:47], v[72:75], v[52:55], v[32:47]
    ds_read_b128 v[72:75], v79 offset:15360
    v_exp_f32 v24, v24
    v_exp_f32 v25, v25
    v_exp_f32 v26, v26
    v_exp_f32 v27, v27
    v_cvt_pk_bf16_f32 v52, v24, v25
    v_cvt_pk_bf16_f32 v53, v26, v27
    s_waitcnt lgkmcnt(3)
    v_mfma_f32_32x32x16_bf16 v[32:47], v[68:71], v[48:51], v[32:47]
    ds_read_b128 v[68:71], v78 offset:18432
    v_exp_f32 v28, v28
    v_exp_f32 v29, v29
    v_exp_f32 v30, v30
    v_exp_f32 v31, v31
    v_cvt_pk_bf16_f32 v54, v28, v29
    v_cvt_pk_bf16_f32 v55, v30, v31
    s_waitcnt vmcnt(4)
    s_barrier
    s_setprio 3
    s_andn2_b32 s55, s44, s43
    s_cbranch_scc1 L_af_ok_108
    s_mov_b32 s37, 400000
L_af_sp_109:
    buffer_load_dword v136, v88, s[8:11], s42 offen sc1
    s_waitcnt vmcnt(0)
    v_cmp_gt_u32 vcc, s57, v136
    s_mov_b32 s43, vcc_lo
    s_andn2_b32 s55, s44, s43
    s_cbranch_scc1 L_af_ok_108
    s_sub_u32 s37, s37, 1
    s_cmp_lg_u32 s37, 0
    s_cbranch_scc1 L_af_sp_109
    s_mov_b32 s55, s44
L_af_ok_108:
    s_flbit_i32_b32 s55, s55
    s_sub_u32 s55, 31, s55
    s_bitset0_b32 s44, s55
    s_and_b32 s55, s55, 7
    s_mul_i32 s47, s55, 656384
    s_add_u32 s47, s47, s46
    s_waitcnt lgkmcnt(3)
    v_mfma_f32_32x32x16_bf16 v[16:31], v[56:59], v[64:67], 0
    ds_read_b128 v[56:59], v76 offset:24576
    v_exp_f32 v0, v0
    v_exp_f32 v1, v1
    v_exp_f32 v2, v2
    v_exp_f32 v3, v3
    v_cvt_pk_bf16_f32 v48, v0, v1
    v_cvt_pk_bf16_f32 v49, v2, v3
    s_waitcnt lgkmcnt(3)
    v_mfma_f32_32x32x8_bf16 v[16:31], v[60:61], v[62:63], v[16:31]
    ds_read_b64 v[60:61], v77 offset:24576
    v_exp_f32 v4, v4
    v_exp_f32 v5, v5
    v_exp_f32 v6, v6
    v_exp_f32 v7, v7
    v_cvt_pk_bf16_f32 v50, v4, v5
    v_cvt_pk_bf16_f32 v51, v6, v7
    s_waitcnt lgkmcnt(3)
    v_mfma_f32_32x32x16_bf16 v[32:47], v[72:75], v[52:55], v[32:47]
    ds_read_b128 v[72:75], v79 offset:18432
    s_add_u32 m0, s41, 49152
    s_nop 0
    buffer_load_dwordx4 v249, s[32:35], s47 offen offset:0 sc1 lds
    v_exp_f32 v8, v8
    v_exp_f32 v9, v9
    v_exp_f32 v10, v10
    v_exp_f32 v11, v11
    v_cvt_pk_bf16_f32 v52, v8, v9
    v_cvt_pk_bf16_f32 v53, v10, v11
    s_waitcnt lgkmcnt(3)
    v_mfma_f32_32x32x16_bf16 v[32:47], v[68:71], v[48:51], v[32:47]
    ds_read_b128 v[68:71], v78 offset:21504
    v_exp_f32 v12, v12
    v_exp_f32 v13, v13
    v_exp_f32 v14, v14
    v_exp_f32 v15, v15
    v_cvt_pk_bf16_f32 v54, v12, v13
    v_cvt_pk_bf16_f32 v55, v14, v15
    s_add_u32 m0, s41, 49152
    s_nop 0
    buffer_load_dwordx4 v250, s[32:35], s47 offen offset:1024 sc1 lds
    s_waitcnt lgkmcnt(3)
    v_mfma_f32_32x32x16_bf16 v[0:15], v[56:59], v[64:67], 0
    ds_read_b128 v[56:59], v76 offset:27648
    v_exp_f32 v16, v16
    v_exp_f32 v17, v17
    v_exp_f32 v18, v18
    v_exp_f32 v19, v19
    v_cvt_pk_bf16_f32 v48, v16, v17
    v_cvt_pk_bf16_f32 v49, v18, v19
    s_waitcnt lgkmcnt(3)
    v_mfma_f32_32x32x8_bf16 v[0:15], v[60:61], v[62:63], v[0:15]
    ds_read_b64 v[60:61], v77 offset:27648
    v_exp_f32 v20, v20
    v_exp_f32 v21, v21
    v_exp_f32 v22, v22
    v_exp_f32 v23, v23
    v_cvt_pk_bf16_f32 v50, v20, v21
    v_cvt_pk_bf16_f32 v51, v22, v23
    s_waitcnt lgkmcnt(3)
    v_mfma_f32_32x32x16_bf16 v[32:47], v[72:75], v[52:55], v[32:47]
    ds_read_b128 v[72:75], v79 offset:21504
    s_add_u32 m0, s41, 49152
    s_nop 0
    buffer_load_dwordx4 v251, s[32:35], s47 offen offset:2048 sc1 lds
    v_exp_f32 v24, v24
    v_exp_f32 v25, v25
    v_exp_f32 v26, v26
    v_exp_f32 v27, v27
    v_cvt_pk_bf16_f32 v52, v24, v25
    v_cvt_pk_bf16_f32 v53, v26, v27
    s_waitcnt lgkmcnt(3)
    v_mfma_f32_32x32x16_bf16 v[32:47], v[68:71], v[48:51], v[32:47]
    ds_read_b128 v[68:71], v78 offset:24576
    v_exp_f32 v28, v28
    v_exp_f32 v29, v29
    v_exp_f32 v30, v30
    v_exp_f32 v31, v31
    v_cvt_pk_bf16_f32 v54, v28, v29
    v_cvt_pk_bf16_f32 v55, v30, v31
    s_waitcnt lgkmcnt(3)
    v_mfma_f32_32x32x16_bf16 v[16:31], v[56:59], v[64:67], 0
    ds_read_b128 v[56:59], v76 offset:30720
    v_exp_f32 v0, v0
    v_exp_f32 v1, v1
    v_exp_f32 v2, v2
    v_exp_f32 v3, v3
    v_cvt_pk_bf16_f32 v48, v0, v1
    v_cvt_pk_bf16_f32 v49, v2, v3
    s_waitcnt lgkmcnt(3)
    v_mfma_f32_32x32x8_bf16 v[16:31], v[60:61], v[62:63], v[16:31]
    ds_read_b64 v[60:61], v77 offset:30720
    v_exp_f32 v4, v4
    v_exp_f32 v5, v5
    v_exp_f32 v6, v6
    v_exp_f32 v7, v7
    v_cvt_pk_bf16_f32 v50, v4, v5
    v_cvt_pk_bf16_f32 v51, v6, v7
    s_waitcnt lgkmcnt(3)
    v_mfma_f32_32x32x16_bf16 v[32:47], v[72:75], v[52:55], v[32:47]
    ds_read_b128 v[72:75], v79 offset:24576
    s_cmp_ge_u32 s12, 4
    s_cbranch_scc1 L_b2h_110
    buffer_load_dword v238, v252, s[8:11], s18 offen sc1
    s_branch L_b2e_111
L_b2h_110:
    s_add_u32 s36, s61, 2211840
    buffer_load_dwordx4 v[222:225], v244, s[20:23], s36 offen
L_b2e_111:
    v_exp_f32 v8, v8
    v_exp_f32 v9, v9
    v_exp_f32 v10, v10
    v_exp_f32 v11, v11
    v_cvt_pk_bf16_f32 v52, v8, v9
    v_cvt_pk_bf16_f32 v53, v10, v11
    s_waitcnt lgkmcnt(3)
    v_mfma_f32_32x32x16_bf16 v[32:47], v[68:71], v[48:51], v[32:47]
    ds_read_b128 v[68:71], v78 offset:27648
    v_exp_f32 v12, v12
    v_exp_f32 v13, v13
    v_exp_f32 v14, v14
    v_exp_f32 v15, v15
    v_cvt_pk_bf16_f32 v54, v12, v13
    v_cvt_pk_bf16_f32 v55, v14, v15
    s_waitcnt lgkmcnt(3)
    v_mfma_f32_32x32x16_bf16 v[0:15], v[56:59], v[64:67], 0
    ds_read_b128 v[56:59], v76 offset:33792
    v_exp_f32 v16, v16
    v_exp_f32 v17, v17
    v_exp_f32 v18, v18
    v_exp_f32 v19, v19
    v_cvt_pk_bf16_f32 v48, v16, v17
    v_cvt_pk_bf16_f32 v49, v18, v19
    s_waitcnt lgkmcnt(3)
    v_mfma_f32_32x32x8_bf16 v[0:15], v[60:61], v[62:63], v[0:15]
    ds_read_b64 v[60:61], v77 offset:33792
    v_exp_f32 v20, v20
    v_exp_f32 v21, v21
    v_exp_f32 v22, v22
    v_exp_f32 v23, v23
    v_cvt_pk_bf16_f32 v50, v20, v21
    v_cvt_pk_bf16_f32 v51, v22, v23
    s_waitcnt lgkmcnt(3)
    v_mfma_f32_32x32x16_bf16 v[32:47], v[72:75], v[52:55], v[32:47]
    ds_read_b128 v[72:75], v79 offset:27648
    s_add_u32 m0, s58, 49152
    s_add_u32 s36, s59, 49152
    buffer_load_dwordx4 v255, s[8:11], s36 offen lds
    v_exp_f32 v24, v24
    v_exp_f32 v25, v25
    v_exp_f32 v26, v26
    v_exp_f32 v27, v27
    v_cvt_pk_bf16_f32 v52, v24, v25
    v_cvt_pk_bf16_f32 v53, v26, v27
    s_waitcnt lgkmcnt(3)
    v_mfma_f32_32x32x16_bf16 v[32:47], v[68:71], v[48:51], v[32:47]
    ds_read_b128 v[68:71], v78 offset:30720
    v_exp_f32 v28, v28
    v_exp_f32 v29, v29
    v_exp_f32 v30, v30
    v_exp_f32 v31, v31
    v_cvt_pk_bf16_f32 v54, v28, v29
    v_cvt_pk_bf16_f32 v55, v30, v31
    s_setprio 2
    s_waitcnt lgkmcnt(3)
    v_mfma_f32_32x32x16_bf16 v[16:31], v[56:59], v[64:67], 0
    ds_read_b128 v[56:59], v76 offset:36864
    v_exp_f32 v0, v0
    v_exp_f32 v1, v1
    v_exp_f32 v2, v2
    v_exp_f32 v3, v3
    v_cvt_pk_bf16_f32 v48, v0, v1
    v_cvt_pk_bf16_f32 v49, v2, v3
    s_waitcnt lgkmcnt(3)
    v_mfma_f32_32x32x8_bf16 v[16:31], v[60:61], v[62:63], v[16:31]
    ds_read_b64 v[60:61], v77 offset:36864
    v_exp_f32 v4, v4
    v_exp_f32 v5, v5
    v_exp_f32 v6, v6
    v_exp_f32 v7, v7
    v_cvt_pk_bf16_f32 v50, v4, v5
    v_cvt_pk_bf16_f32 v51, v6, v7
    s_waitcnt lgkmcnt(3)
    v_mfma_f32_32x32x16_bf16 v[32:47], v[72:75], v[52:55], v[32:47]
    ds_read_b128 v[72:75], v79 offset:30720
    s_cmp_ge_u32 s12, 4
    s_cbranch_scc1 L_b2h_112
    buffer_load_dword v238, v252, s[8:11], s18 offen sc1
    s_branch L_b2e_113
L_b2h_112:
    s_add_u32 s36, s61, 2273280
    buffer_load_dwordx4 v[226:229], v244, s[20:23], s36 offen
L_b2e_113:
    v_exp_f32 v8, v8
    v_exp_f32 v9, v9
    v_exp_f32 v10, v10
    v_exp_f32 v11, v11
    v_cvt_pk_bf16_f32 v52, v8, v9
    v_cvt_pk_bf16_f32 v53, v10, v11
    s_waitcnt lgkmcnt(3)
    v_mfma_f32_32x32x16_bf16 v[32:47], v[68:71], v[48:51], v[32:47]
    ds_read_b128 v[68:71], v78 offset:33792
    v_exp_f32 v12, v12
    v_exp_f32 v13, v13
    v_exp_f32 v14, v14
    v_exp_f32 v15, v15
    v_cvt_pk_bf16_f32 v54, v12, v13
    v_cvt_pk_bf16_f32 v55, v14, v15
    s_waitcnt lgkmcnt(3)
    v_mfma_f32_32x32x16_bf16 v[0:15], v[56:59], v[64:67], 0
    ds_read_b128 v[56:59], v76 offset:39936
    v_exp_f32 v16, v16
    v_exp_f32 v17, v17
    v_exp_f32 v18, v18
    v_exp_f32 v19, v19
    v_cvt_pk_bf16_f32 v48, v16, v17
    v_cvt_pk_bf16_f32 v49, v18, v19
    s_waitcnt lgkmcnt(3)
    v_mfma_f32_32x32x8_bf16 v[0:15], v[60:61], v[62:63], v[0:15]
    ds_read_b64 v[60:61], v77 offset:39936
    v_exp_f32 v20, v20
    v_exp_f32 v21, v21
    v_exp_f32 v22, v22
    v_exp_f32 v23, v23
    v_cvt_pk_bf16_f32 v50, v20, v21
    v_cvt_pk_bf16_f32 v51, v22, v23
    s_waitcnt lgkmcnt(3)
    v_mfma_f32_32x32x16_bf16 v[32:47], v[72:75], v[52:55], v[32:47]
    ds_read_b128 v[72:75], v79 offset:33792
    s_add_u32 m0, s58, 57344
    s_add_u32 s36, s59, 57344
    buffer_load_dwordx4 v255, s[8:11], s36 offen lds
    v_exp_f32 v24, v24
    v_exp_f32 v25, v25
    v_exp_f32 v26, v26
    v_exp_f32 v27, v27
    v_cvt_pk_bf16_f32 v52, v24, v25
    v_cvt_pk_bf16_f32 v53, v26, v27
    s_waitcnt lgkmcnt(3)
    v_mfma_f32_32x32x16_bf16 v[32:47], v[68:71], v[48:51], v[32:47]
    ds_read_b128 v[68:71], v78 offset:36864
    v_exp_f32 v28, v28
    v_exp_f32 v29, v29
    v_exp_f32 v30, v30
    v_exp_f32 v31, v31
    v_cvt_pk_bf16_f32 v54, v28, v29
    v_cvt_pk_bf16_f32 v55, v30, v31
    s_setprio 1
    s_waitcnt lgkmcnt(3)
    v_mfma_f32_32x32x16_bf16 v[16:31], v[56:59], v[64:67], 0
    ds_read_b128 v[56:59], v76 offset:43008
    v_exp_f32 v0, v0
    v_exp_f32 v1, v1
    v_exp_f32 v2, v2
    v_exp_f32 v3, v3
    v_cvt_pk_bf16_f32 v48, v0, v1
    v_cvt_pk_bf16_f32 v49, v2, v3
    s_waitcnt lgkmcnt(3)
    v_mfma_f32_32x32x8_bf16 v[16:31], v[60:61], v[62:63], v[16:31]
    ds_read_b64 v[60:61], v77 offset:43008
    v_exp_f32 v4, v4
    v_exp_f32 v5, v5
    v_exp_f32 v6, v6
    v_exp_f32 v7, v7
    v_cvt_pk_bf16_f32 v50, v4, v5
    v_cvt_pk_bf16_f32 v51, v6, v7
    s_waitcnt lgkmcnt(3)
    v_mfma_f32_32x32x16_bf16 v[32:47], v[72:75], v[52:55], v[32:47]
    ds_read_b128 v[72:75], v79 offset:36864
    v_exp_f32 v8, v8
    v_exp_f32 v9, v9
    v_exp_f32 v10, v10
    v_exp_f32 v11, v11
    v_cvt_pk_bf16_f32 v52, v8, v9
    v_cvt_pk_bf16_f32 v53, v10, v11
    s_waitcnt lgkmcnt(3)
    v_mfma_f32_32x32x16_bf16 v[32:47], v[68:71], v[48:51], v[32:47]
    ds_read_b128 v[68:71], v78 offset:39936
    v_exp_f32 v12, v12
    v_exp_f32 v13, v13
    v_exp_f32 v14, v14
    v_exp_f32 v15, v15
    v_cvt_pk_bf16_f32 v54, v12, v13
    v_cvt_pk_bf16_f32 v55, v14, v15
    s_setprio 0
    s_waitcnt lgkmcnt(3)
    v_mfma_f32_32x32x16_bf16 v[0:15], v[56:59], v[64:67], 0
    ds_read_b128 v[56:59], v76 offset:46080
    v_exp_f32 v16, v16
    v_exp_f32 v17, v17
    v_exp_f32 v18, v18
    v_exp_f32 v19, v19
    v_cvt_pk_bf16_f32 v48, v16, v17
    v_cvt_pk_bf16_f32 v49, v18, v19
    s_waitcnt lgkmcnt(3)
    v_mfma_f32_32x32x8_bf16 v[0:15], v[60:61], v[62:63], v[0:15]
    ds_read_b64 v[60:61], v77 offset:46080
    v_exp_f32 v20, v20
    v_exp_f32 v21, v21
    v_exp_f32 v22, v22
    v_exp_f32 v23, v23
    v_cvt_pk_bf16_f32 v50, v20, v21
    v_cvt_pk_bf16_f32 v51, v22, v23
    s_waitcnt lgkmcnt(3)
    v_mfma_f32_32x32x16_bf16 v[32:47], v[72:75], v[52:55], v[32:47]
    ds_read_b128 v[72:75], v79 offset:39936
    v_exp_f32 v24, v24
    v_exp_f32 v25, v25
    v_exp_f32 v26, v26
    v_exp_f32 v27, v27
    v_cvt_pk_bf16_f32 v52, v24, v25
    v_cvt_pk_bf16_f32 v53, v26, v27
    s_waitcnt lgkmcnt(3)
    v_mfma_f32_32x32x16_bf16 v[32:47], v[68:71], v[48:51], v[32:47]
    ds_read_b128 v[68:71], v78 offset:43008
    v_exp_f32 v28, v28
    v_exp_f32 v29, v29
    v_exp_f32 v30, v30
    v_exp_f32 v31, v31
    v_cvt_pk_bf16_f32 v54, v28, v29
    v_cvt_pk_bf16_f32 v55, v30, v31
    s_waitcnt vmcnt(4)
    s_barrier
    s_setprio 3
    s_andn2_b32 s55, s44, s43
    s_cbranch_scc1 L_af_ok_114
    s_mov_b32 s37, 400000
L_af_sp_115:
    buffer_load_dword v136, v88, s[8:11], s42 offen sc1
    s_waitcnt vmcnt(0)
    v_cmp_gt_u32 vcc, s57, v136
    s_mov_b32 s43, vcc_lo
    s_andn2_b32 s55, s44, s43
    s_cbranch_scc1 L_af_ok_114
    s_sub_u32 s37, s37, 1
    s_cmp_lg_u32 s37, 0
    s_cbranch_scc1 L_af_sp_115
    s_mov_b32 s55, s44
L_af_ok_114:
    s_flbit_i32_b32 s55, s55
    s_sub_u32 s55, 31, s55
    s_bitset0_b32 s44, s55
    s_and_b32 s55, s55, 7
    s_mul_i32 s47, s55, 656384
    s_add_u32 s47, s47, s46
    s_waitcnt lgkmcnt(3)
    v_mfma_f32_32x32x16_bf16 v[16:31], v[56:59], v[64:67], 0
    ds_read_b128 v[56:59], v132 offset:16384
    v_exp_f32 v0, v0
    v_exp_f32 v1, v1
    v_exp_f32 v2, v2
    v_exp_f32 v3, v3
    v_cvt_pk_bf16_f32 v48, v0, v1
    v_cvt_pk_bf16_f32 v49, v2, v3
    s_waitcnt lgkmcnt(3)
    v_mfma_f32_32x32x8_bf16 v[16:31], v[60:61], v[62:63], v[16:31]
    ds_read_b64 v[60:61], v133 offset:16384
    v_exp_f32 v4, v4
    v_exp_f32 v5, v5
    v_exp_f32 v6, v6
    v_exp_f32 v7, v7
    v_cvt_pk_bf16_f32 v50, v4, v5
    v_cvt_pk_bf16_f32 v51, v6, v7
    s_waitcnt lgkmcnt(3)
    v_mfma_f32_32x32x16_bf16 v[32:47], v[72:75], v[52:55], v[32:47]
    ds_read_b128 v[72:75], v79 offset:43008
    s_add_u32 m0, s41, 0
    s_nop 0
    buffer_load_dwordx4 v249, s[32:35], s47 offen offset:0 sc1 lds
    v_exp_f32 v8, v8
    v_exp_f32 v9, v9
    v_exp_f32 v10, v10
    v_exp_f32 v11, v11
    v_cvt_pk_bf16_f32 v52, v8, v9
    v_cvt_pk_bf16_f32 v53, v10, v11
    s_waitcnt lgkmcnt(3)
    v_mfma_f32_32x32x16_bf16 v[32:47], v[68:71], v[48:51], v[32:47]
    ds_read_b128 v[68:71], v78 offset:46080
    v_exp_f32 v12, v12
    v_exp_f32 v13, v13
    v_exp_f32 v14, v14
    v_exp_f32 v15, v15
    v_cvt_pk_bf16_f32 v54, v12, v13
    v_cvt_pk_bf16_f32 v55, v14, v15
    s_add_u32 m0, s41, 0
    s_nop 0
    buffer_load_dwordx4 v250, s[32:35], s47 offen offset:1024 sc1 lds
    s_waitcnt lgkmcnt(3)
    v_mfma_f32_32x32x16_bf16 v[0:15], v[56:59], v[64:67], 0
    ds_read_b128 v[56:59], v132 offset:19456
    v_exp_f32 v16, v16
    v_exp_f32 v17, v17
    v_exp_f32 v18, v18
    v_exp_f32 v19, v19
    v_cvt_pk_bf16_f32 v48, v16, v17
    v_cvt_pk_bf16_f32 v49, v18, v19
    s_waitcnt lgkmcnt(3)
    v_mfma_f32_32x32x8_bf16 v[0:15], v[60:61], v[62:63], v[0:15]
    ds_read_b64 v[60:61], v133 offset:19456
    v_exp_f32 v20, v20
    v_exp_f32 v21, v21
    v_exp_f32 v22, v22
    v_exp_f32 v23, v23
    v_cvt_pk_bf16_f32 v50, v20, v21
    v_cvt_pk_bf16_f32 v51, v22, v23
    s_waitcnt lgkmcnt(3)
    v_mfma_f32_32x32x16_bf16 v[32:47], v[72:75], v[52:55], v[32:47]
    ds_read_b128 v[72:75], v79 offset:46080
    s_add_u32 m0, s41, 0
    s_nop 0
    buffer_load_dwordx4 v251, s[32:35], s47 offen offset:2048 sc1 lds
    v_exp_f32 v24, v24
    v_exp_f32 v25, v25
    v_exp_f32 v26, v26
    v_exp_f32 v27, v27
    v_cvt_pk_bf16_f32 v52, v24, v25
    v_cvt_pk_bf16_f32 v53, v26, v27
    s_waitcnt lgkmcnt(3)
    v_mfma_f32_32x32x16_bf16 v[32:47], v[68:71], v[48:51], v[32:47]
    ds_read_b128 v[68:71], v134 offset:16384
    v_exp_f32 v28, v28
    v_exp_f32 v29, v29
    v_exp_f32 v30, v30
    v_exp_f32 v31, v31
    v_cvt_pk_bf16_f32 v54, v28, v29
    v_cvt_pk_bf16_f32 v55, v30, v31
    s_waitcnt lgkmcnt(3)
    v_mfma_f32_32x32x16_bf16 v[16:31], v[56:59], v[64:67], 0
    ds_read_b128 v[56:59], v132 offset:22528
    v_exp_f32 v0, v0
    v_exp_f32 v1, v1
    v_exp_f32 v2, v2
    v_exp_f32 v3, v3
    v_cvt_pk_bf16_f32 v48, v0, v1
    v_cvt_pk_bf16_f32 v49, v2, v3
    s_waitcnt lgkmcnt(3)
    v_mfma_f32_32x32x8_bf16 v[16:31], v[60:61], v[62:63], v[16:31]
    ds_read_b64 v[60:61], v133 offset:22528
    v_exp_f32 v4, v4
    v_exp_f32 v5, v5
    v_exp_f32 v6, v6
    v_exp_f32 v7, v7
    v_cvt_pk_bf16_f32 v50, v4, v5
    v_cvt_pk_bf16_f32 v51, v6, v7
    s_waitcnt lgkmcnt(3)
    v_mfma_f32_32x32x16_bf16 v[32:47], v[72:75], v[52:55], v[32:47]
    ds_read_b128 v[72:75], v135 offset:16384
    s_cmp_ge_u32 s12, 4
    s_cbranch_scc1 L_b2h_116
    buffer_load_dword v238, v252, s[8:11], s18 offen sc1
    s_branch L_b2e_117
L_b2h_116:
    s_add_u32 s36, s61, 2334720
    buffer_load_dwordx4 v[230:233], v244, s[20:23], s36 offen
L_b2e_117:
    v_exp_f32 v8, v8
    v_exp_f32 v9, v9
    v_exp_f32 v10, v10
    v_exp_f32 v11, v11
    v_cvt_pk_bf16_f32 v52, v8, v9
    v_cvt_pk_bf16_f32 v53, v10, v11
    s_waitcnt lgkmcnt(3)
    v_mfma_f32_32x32x16_bf16 v[32:47], v[68:71], v[48:51], v[32:47]
    ds_read_b128 v[68:71], v134 offset:19456
    v_exp_f32 v12, v12
    v_exp_f32 v13, v13
    v_exp_f32 v14, v14
    v_exp_f32 v15, v15
    v_cvt_pk_bf16_f32 v54, v12, v13
    v_cvt_pk_bf16_f32 v55, v14, v15
    s_waitcnt lgkmcnt(3)
    v_mfma_f32_32x32x16_bf16 v[0:15], v[56:59], v[64:67], 0
    ds_read_b128 v[56:59], v132 offset:25600
    v_exp_f32 v16, v16
    v_exp_f32 v17, v17
    v_exp_f32 v18, v18
    v_exp_f32 v19, v19
    v_cvt_pk_bf16_f32 v48, v16, v17
    v_cvt_pk_bf16_f32 v49, v18, v19
    s_waitcnt lgkmcnt(3)
    v_mfma_f32_32x32x8_bf16 v[0:15], v[60:61], v[62:63], v[0:15]
    ds_read_b64 v[60:61], v133 offset:25600
    v_exp_f32 v20, v20
    v_exp_f32 v21, v21
    v_exp_f32 v22, v22
    v_exp_f32 v23, v23
    v_cvt_pk_bf16_f32 v50, v20, v21
    v_cvt_pk_bf16_f32 v51, v22, v23
    s_waitcnt lgkmcnt(3)
    v_mfma_f32_32x32x16_bf16 v[32:47], v[72:75], v[52:55], v[32:47]
    ds_read_b128 v[72:75], v135 offset:19456
    s_add_u32 m0, s58, 65536
    s_add_u32 s36, s59, 65536
    buffer_load_dwordx4 v255, s[8:11], s36 offen lds
    v_exp_f32 v24, v24
    v_exp_f32 v25, v25
    v_exp_f32 v26, v26
    v_exp_f32 v27, v27
    v_cvt_pk_bf16_f32 v52, v24, v25
    v_cvt_pk_bf16_f32 v53, v26, v27
    s_waitcnt lgkmcnt(3)
    v_mfma_f32_32x32x16_bf16 v[32:47], v[68:71], v[48:51], v[32:47]
    ds_read_b128 v[68:71], v134 offset:22528
    v_exp_f32 v28, v28
    v_exp_f32 v29, v29
    v_exp_f32 v30, v30
    v_exp_f32 v31, v31
    v_cvt_pk_bf16_f32 v54, v28, v29
    v_cvt_pk_bf16_f32 v55, v30, v31
    s_setprio 2
    s_waitcnt lgkmcnt(3)
    v_mfma_f32_32x32x16_bf16 v[16:31], v[56:59], v[64:67], 0
    ds_read_b128 v[56:59], v132 offset:28672
    v_exp_f32 v0, v0
    v_exp_f32 v1, v1
    v_exp_f32 v2, v2
    v_exp_f32 v3, v3
    v_cvt_pk_bf16_f32 v48, v0, v1
    v_cvt_pk_bf16_f32 v49, v2, v3
    s_waitcnt lgkmcnt(3)
    v_mfma_f32_32x32x8_bf16 v[16:31], v[60:61], v[62:63], v[16:31]
    ds_read_b64 v[60:61], v133 offset:28672
    v_exp_f32 v4, v4
    v_exp_f32 v5, v5
    v_exp_f32 v6, v6
    v_exp_f32 v7, v7
    v_cvt_pk_bf16_f32 v50, v4, v5
    v_cvt_pk_bf16_f32 v51, v6, v7
    s_waitcnt lgkmcnt(3)
    v_mfma_f32_32x32x16_bf16 v[32:47], v[72:75], v[52:55], v[32:47]
    ds_read_b128 v[72:75], v135 offset:22528
    s_cmp_ge_u32 s12, 4
    s_cbranch_scc1 L_b2h_118
    s_lshl_b32 s36, s12, 12
    s_add_u32 s36, s36, s62
    s_add_u32 s36, s36, 87040
    v_lshlrev_b32 v242, 7, v254
    buffer_load_dword v238, v242, s[8:11], s36 offen
    s_branch L_b2e_119
L_b2h_118:
    s_add_u32 s36, s61, 2396160
    buffer_load_dwordx4 v[234:237], v244, s[20:23], s36 offen
L_b2e_119:
    v_exp_f32 v8, v8
    v_exp_f32 v9, v9
    v_exp_f32 v10, v10
    v_exp_f32 v11, v11
    v_cvt_pk_bf16_f32 v52, v8, v9
    v_cvt_pk_bf16_f32 v53, v10, v11
    s_waitcnt lgkmcnt(3)
    v_mfma_f32_32x32x16_bf16 v[32:47], v[68:71], v[48:51], v[32:47]
    ds_read_b128 v[68:71], v134 offset:25600
    v_exp_f32 v12, v12
    v_exp_f32 v13, v13
    v_exp_f32 v14, v14
    v_exp_f32 v15, v15
    v_cvt_pk_bf16_f32 v54, v12, v13
    v_cvt_pk_bf16_f32 v55, v14, v15
    s_waitcnt lgkmcnt(3)
    v_mfma_f32_32x32x16_bf16 v[0:15], v[56:59], v[64:67], 0
    ds_read_b128 v[56:59], v132 offset:31744
    v_exp_f32 v16, v16
    v_exp_f32 v17, v17
    v_exp_f32 v18, v18
    v_exp_f32 v19, v19
    v_cvt_pk_bf16_f32 v48, v16, v17
    v_cvt_pk_bf16_f32 v49, v18, v19
    s_waitcnt lgkmcnt(3)
    v_mfma_f32_32x32x8_bf16 v[0:15], v[60:61], v[62:63], v[0:15]
    ds_read_b64 v[60:61], v133 offset:31744
    v_exp_f32 v20, v20
    v_exp_f32 v21, v21
    v_exp_f32 v22, v22
    v_exp_f32 v23, v23
    v_cvt_pk_bf16_f32 v50, v20, v21
    v_cvt_pk_bf16_f32 v51, v22, v23
    s_waitcnt lgkmcnt(3)
    v_mfma_f32_32x32x16_bf16 v[32:47], v[72:75], v[52:55], v[32:47]
    ds_read_b128 v[72:75], v135 offset:25600
    s_add_u32 m0, s58, 73728
    s_add_u32 s36, s59, 73728
    buffer_load_dwordx4 v255, s[8:11], s36 offen lds
    v_exp_f32 v24, v24
    v_exp_f32 v25, v25
    v_exp_f32 v26, v26
    v_exp_f32 v27, v27
    v_cvt_pk_bf16_f32 v52, v24, v25
    v_cvt_pk_bf16_f32 v53, v26, v27
    s_waitcnt lgkmcnt(3)
    v_mfma_f32_32x32x16_bf16 v[32:47], v[68:71], v[48:51], v[32:47]
    ds_read_b128 v[68:71], v134 offset:28672
    v_exp_f32 v28, v28
    v_exp_f32 v29, v29
    v_exp_f32 v30, v30
    v_exp_f32 v31, v31
    v_cvt_pk_bf16_f32 v54, v28, v29
    v_cvt_pk_bf16_f32 v55, v30, v31
    s_setprio 1
    s_waitcnt lgkmcnt(3)
    v_mfma_f32_32x32x16_bf16 v[16:31], v[56:59], v[64:67], 0
    ds_read_b128 v[56:59], v132 offset:34816
    v_exp_f32 v0, v0
    v_exp_f32 v1, v1
    v_exp_f32 v2, v2
    v_exp_f32 v3, v3
    v_cvt_pk_bf16_f32 v48, v0, v1
    v_cvt_pk_bf16_f32 v49, v2, v3
    s_waitcnt lgkmcnt(3)
    v_mfma_f32_32x32x8_bf16 v[16:31], v[60:61], v[62:63], v[16:31]
    ds_read_b64 v[60:61], v133 offset:34816
    v_exp_f32 v4, v4
    v_exp_f32 v5, v5
    v_exp_f32 v6, v6
    v_exp_f32 v7, v7
    v_cvt_pk_bf16_f32 v50, v4, v5
    v_cvt_pk_bf16_f32 v51, v6, v7
    s_waitcnt lgkmcnt(3)
    v_mfma_f32_32x32x16_bf16 v[32:47], v[72:75], v[52:55], v[32:47]
    ds_read_b128 v[72:75], v135 offset:28672
    v_exp_f32 v8, v8
    v_exp_f32 v9, v9
    v_exp_f32 v10, v10
    v_exp_f32 v11, v11
    v_cvt_pk_bf16_f32 v52, v8, v9
    v_cvt_pk_bf16_f32 v53, v10, v11
    s_waitcnt lgkmcnt(3)
    v_mfma_f32_32x32x16_bf16 v[32:47], v[68:71], v[48:51], v[32:47]
    ds_read_b128 v[68:71], v134 offset:31744
    v_exp_f32 v12, v12
    v_exp_f32 v13, v13
    v_exp_f32 v14, v14
    v_exp_f32 v15, v15
    v_cvt_pk_bf16_f32 v54, v12, v13
    v_cvt_pk_bf16_f32 v55, v14, v15
    s_setprio 0
    s_waitcnt lgkmcnt(3)
    v_mfma_f32_32x32x16_bf16 v[0:15], v[56:59], v[64:67], 0
    ds_read_b128 v[56:59], v132 offset:37888
    v_exp_f32 v16, v16
    v_exp_f32 v17, v17
    v_exp_f32 v18, v18
    v_exp_f32 v19, v19
    v_cvt_pk_bf16_f32 v48, v16, v17
    v_cvt_pk_bf16_f32 v49, v18, v19
    s_waitcnt lgkmcnt(3)
    v_mfma_f32_32x32x8_bf16 v[0:15], v[60:61], v[62:63], v[0:15]
    ds_read_b64 v[60:61], v133 offset:37888
    v_exp_f32 v20, v20
    v_exp_f32 v21, v21
    v_exp_f32 v22, v22
    v_exp_f32 v23, v23
    v_cvt_pk_bf16_f32 v50, v20, v21
    v_cvt_pk_bf16_f32 v51, v22, v23
    s_waitcnt lgkmcnt(3)
    v_mfma_f32_32x32x16_bf16 v[32:47], v[72:75], v[52:55], v[32:47]
    ds_read_b128 v[72:75], v135 offset:31744
    v_exp_f32 v24, v24
    v_exp_f32 v25, v25
    v_exp_f32 v26, v26
    v_exp_f32 v27, v27
    v_cvt_pk_bf16_f32 v52, v24, v25
    v_cvt_pk_bf16_f32 v53, v26, v27
    s_waitcnt lgkmcnt(3)
    v_mfma_f32_32x32x16_bf16 v[32:47], v[68:71], v[48:51], v[32:47]
    ds_read_b128 v[68:71], v134 offset:34816
    v_exp_f32 v28, v28
    v_exp_f32 v29, v29
    v_exp_f32 v30, v30
    v_exp_f32 v31, v31
    v_cvt_pk_bf16_f32 v54, v28, v29
    v_cvt_pk_bf16_f32 v55, v30, v31
    s_waitcnt vmcnt(4)
    s_barrier
    s_setprio 3
    s_andn2_b32 s55, s44, s43
    s_cbranch_scc1 L_af_ok_120
    s_mov_b32 s37, 400000
L_af_sp_121:
    buffer_load_dword v136, v88, s[8:11], s42 offen sc1
    s_waitcnt vmcnt(0)
    v_cmp_gt_u32 vcc, s57, v136
    s_mov_b32 s43, vcc_lo
    s_andn2_b32 s55, s44, s43
    s_cbranch_scc1 L_af_ok_120
    s_sub_u32 s37, s37, 1
    s_cmp_lg_u32 s37, 0
    s_cbranch_scc1 L_af_sp_121
    s_mov_b32 s55, s44
L_af_ok_120:
    s_flbit_i32_b32 s55, s55
    s_sub_u32 s55, 31, s55
    s_bitset0_b32 s44, s55
    s_and_b32 s55, s55, 7
    s_mul_i32 s47, s55, 656384
    s_add_u32 s47, s47, s46
    s_waitcnt lgkmcnt(3)
    v_mfma_f32_32x32x16_bf16 v[16:31], v[56:59], v[64:67], 0
    ds_read_b128 v[56:59], v76 offset:0
    v_exp_f32 v0, v0
    v_exp_f32 v1, v1
    v_exp_f32 v2, v2
    v_exp_f32 v3, v3
    v_cvt_pk_bf16_f32 v48, v0, v1
    v_cvt_pk_bf16_f32 v49, v2, v3
    s_waitcnt lgkmcnt(3)
    v_mfma_f32_32x32x8_bf16 v[16:31], v[60:61], v[62:63], v[16:31]
    ds_read_b64 v[60:61], v77 offset:0
    v_exp_f32 v4, v4
    v_exp_f32 v5, v5
    v_exp_f32 v6, v6
    v_exp_f32 v7, v7
    v_cvt_pk_bf16_f32 v50, v4, v5
    v_cvt_pk_bf16_f32 v51, v6, v7
    s_waitcnt lgkmcnt(3)
    v_mfma_f32_32x32x16_bf16 v[32:47], v[72:75], v[52:55], v[32:47]
    ds_read_b128 v[72:75], v135 offset:34816
    s_add_u32 m0, s41, 24576
    s_nop 0
    buffer_load_dwordx4 v249, s[32:35], s47 offen offset:0 sc1 lds
    v_exp_f32 v8, v8
    v_exp_f32 v9, v9
    v_exp_f32 v10, v10
    v_exp_f32 v11, v11
    v_cvt_pk_bf16_f32 v52, v8, v9
    v_cvt_pk_bf16_f32 v53, v10, v11
    s_waitcnt lgkmcnt(3)
    v_mfma_f32_32x32x16_bf16 v[32:47], v[68:71], v[48:51], v[32:47]
    ds_read_b128 v[68:71], v134 offset:37888
    v_exp_f32 v12, v12
    v_exp_f32 v13, v13
    v_exp_f32 v14, v14
    v_exp_f32 v15, v15
    v_cvt_pk_bf16_f32 v54, v12, v13
    v_cvt_pk_bf16_f32 v55, v14, v15
    s_add_u32 m0, s41, 24576
    s_nop 0
    buffer_load_dwordx4 v250, s[32:35], s47 offen offset:1024 sc1 lds
    s_waitcnt lgkmcnt(3)
    v_mfma_f32_32x32x16_bf16 v[0:15], v[56:59], v[64:67], 0
    ds_read_b128 v[56:59], v76 offset:3072
    v_exp_f32 v16, v16
    v_exp_f32 v17, v17
    v_exp_f32 v18, v18
    v_exp_f32 v19, v19
    v_cvt_pk_bf16_f32 v48, v16, v17
    v_cvt_pk_bf16_f32 v49, v18, v19
    s_waitcnt lgkmcnt(3)
    v_mfma_f32_32x32x8_bf16 v[0:15], v[60:61], v[62:63], v[0:15]
    ds_read_b64 v[60:61], v77 offset:3072
    v_exp_f32 v20, v20
    v_exp_f32 v21, v21
    v_exp_f32 v22, v22
    v_exp_f32 v23, v23
    v_cvt_pk_bf16_f32 v50, v20, v21
    v_cvt_pk_bf16_f32 v51, v22, v23
    s_waitcnt lgkmcnt(3)
    v_mfma_f32_32x32x16_bf16 v[32:47], v[72:75], v[52:55], v[32:47]
    ds_read_b128 v[72:75], v135 offset:37888
    s_add_u32 m0, s41, 24576
    s_nop 0
    buffer_load_dwordx4 v251, s[32:35], s47 offen offset:2048 sc1 lds
    v_exp_f32 v24, v24
    v_exp_f32 v25, v25
    v_exp_f32 v26, v26
    v_exp_f32 v27, v27
    v_cvt_pk_bf16_f32 v52, v24, v25
    v_cvt_pk_bf16_f32 v53, v26, v27
    s_waitcnt lgkmcnt(3)
    v_mfma_f32_32x32x16_bf16 v[32:47], v[68:71], v[48:51], v[32:47]
    ds_read_b128 v[68:71], v78 offset:0
    v_exp_f32 v28, v28
    v_exp_f32 v29, v29
    v_exp_f32 v30, v30
    v_exp_f32 v31, v31
    v_cvt_pk_bf16_f32 v54, v28, v29
    v_cvt_pk_bf16_f32 v55, v30, v31
    s_waitcnt lgkmcnt(3)
    v_mfma_f32_32x32x16_bf16 v[16:31], v[56:59], v[64:67], 0
    ds_read_b128 v[56:59], v76 offset:6144
    v_exp_f32 v0, v0
    v_exp_f32 v1, v1
    v_exp_f32 v2, v2
    v_exp_f32 v3, v3
    v_cvt_pk_bf16_f32 v48, v0, v1
    v_cvt_pk_bf16_f32 v49, v2, v3
    s_waitcnt lgkmcnt(3)
    v_mfma_f32_32x32x8_bf16 v[16:31], v[60:61], v[62:63], v[16:31]
    ds_read_b64 v[60:61], v77 offset:6144
    v_exp_f32 v4, v4
    v_exp_f32 v5, v5
    v_exp_f32 v6, v6
    v_exp_f32 v7, v7
    v_cvt_pk_bf16_f32 v50, v4, v5
    v_cvt_pk_bf16_f32 v51, v6, v7
    s_waitcnt lgkmcnt(3)
    v_mfma_f32_32x32x16_bf16 v[32:47], v[72:75], v[52:55], v[32:47]
    ds_read_b128 v[72:75], v79 offset:0
    v_exp_f32 v8, v8
    v_exp_f32 v9, v9
    v_exp_f32 v10, v10
    v_exp_f32 v11, v11
    v_cvt_pk_bf16_f32 v52, v8, v9
    v_cvt_pk_bf16_f32 v53, v10, v11
    s_waitcnt lgkmcnt(3)
    v_mfma_f32_32x32x16_bf16 v[32:47], v[68:71], v[48:51], v[32:47]
    ds_read_b128 v[68:71], v78 offset:3072
    v_exp_f32 v12, v12
    v_exp_f32 v13, v13
    v_exp_f32 v14, v14
    v_exp_f32 v15, v15
    v_cvt_pk_bf16_f32 v54, v12, v13
    v_cvt_pk_bf16_f32 v55, v14, v15
    s_waitcnt lgkmcnt(3)
    v_mfma_f32_32x32x16_bf16 v[0:15], v[56:59], v[64:67], 0
    ds_read_b128 v[56:59], v76 offset:9216
    v_exp_f32 v16, v16
    v_exp_f32 v17, v17
    v_exp_f32 v18, v18
    v_exp_f32 v19, v19
    v_cvt_pk_bf16_f32 v48, v16, v17
    v_cvt_pk_bf16_f32 v49, v18, v19
    s_waitcnt lgkmcnt(3)
    v_mfma_f32_32x32x8_bf16 v[0:15], v[60:61], v[62:63], v[0:15]
    ds_read_b64 v[60:61], v77 offset:9216
    v_exp_f32 v20, v20
    v_exp_f32 v21, v21
    v_exp_f32 v22, v22
    v_exp_f32 v23, v23
    v_cvt_pk_bf16_f32 v50, v20, v21
    v_cvt_pk_bf16_f32 v51, v22, v23
    s_waitcnt lgkmcnt(3)
    v_mfma_f32_32x32x16_bf16 v[32:47], v[72:75], v[52:55], v[32:47]
    ds_read_b128 v[72:75], v79 offset:3072
    s_min_u32 s36, s12, 4
    s_lshl_b32 s36, s36, 10
    s_add_u32 m0, s36, 158720
    s_add_u32 s36, s36, s62
    s_add_u32 s36, s36, 81920
    buffer_load_dwordx4 v255, s[8:11], s36 offen lds
    v_exp_f32 v24, v24
    v_exp_f32 v25, v25
    v_exp_f32 v26, v26
    v_exp_f32 v27, v27
    v_cvt_pk_bf16_f32 v52, v24, v25
    v_cvt_pk_bf16_f32 v53, v26, v27
    s_waitcnt lgkmcnt(3)
    v_mfma_f32_32x32x16_bf16 v[32:47], v[68:71], v[48:51], v[32:47]
    ds_read_b128 v[68:71], v78 offset:6144
    v_exp_f32 v28, v28
    v_exp_f32 v29, v29
    v_exp_f32 v30, v30
    v_exp_f32 v31, v31
    v_cvt_pk_bf16_f32 v54, v28, v29
    v_cvt_pk_bf16_f32 v55, v30, v31
    s_setprio 2
    s_waitcnt lgkmcnt(3)
    v_mfma_f32_32x32x16_bf16 v[16:31], v[56:59], v[64:67], 0
    ds_read_b128 v[56:59], v76 offset:12288
    v_exp_f32 v0, v0
    v_exp_f32 v1, v1
    v_exp_f32 v2, v2
    v_exp_f32 v3, v3
    v_cvt_pk_bf16_f32 v48, v0, v1
    v_cvt_pk_bf16_f32 v49, v2, v3
    s_waitcnt lgkmcnt(3)
    v_mfma_f32_32x32x8_bf16 v[16:31], v[60:61], v[62:63], v[16:31]
    ds_read_b64 v[60:61], v77 offset:12288
    v_exp_f32 v4, v4
    v_exp_f32 v5, v5
    v_exp_f32 v6, v6
    v_exp_f32 v7, v7
    v_cvt_pk_bf16_f32 v50, v4, v5
    v_cvt_pk_bf16_f32 v51, v6, v7
    s_waitcnt lgkmcnt(3)
    v_mfma_f32_32x32x16_bf16 v[32:47], v[72:75], v[52:55], v[32:47]
    ds_read_b128 v[72:75], v79 offset:6144
    v_exp_f32 v8, v8
    v_exp_f32 v9, v9
    v_exp_f32 v10, v10
    v_exp_f32 v11, v11
    v_cvt_pk_bf16_f32 v52, v8, v9
    v_cvt_pk_bf16_f32 v53, v10, v11
    s_waitcnt lgkmcnt(3)
    v_mfma_f32_32x32x16_bf16 v[32:47], v[68:71], v[48:51], v[32:47]
    ds_read_b128 v[68:71], v78 offset:9216
    v_exp_f32 v12, v12
    v_exp_f32 v13, v13
    v_exp_f32 v14, v14
    v_exp_f32 v15, v15
    v_cvt_pk_bf16_f32 v54, v12, v13
    v_cvt_pk_bf16_f32 v55, v14, v15
    s_waitcnt lgkmcnt(3)
    v_mfma_f32_32x32x16_bf16 v[0:15], v[56:59], v[64:67], 0
    ds_read_b128 v[56:59], v76 offset:15360
    v_exp_f32 v16, v16
    v_exp_f32 v17, v17
    v_exp_f32 v18, v18
    v_exp_f32 v19, v19
    v_cvt_pk_bf16_f32 v48, v16, v17
    v_cvt_pk_bf16_f32 v49, v18, v19
    s_waitcnt lgkmcnt(3)
    v_mfma_f32_32x32x8_bf16 v[0:15], v[60:61], v[62:63], v[0:15]
    ds_read_b64 v[60:61], v77 offset:15360
    v_exp_f32 v20, v20
    v_exp_f32 v21, v21
    v_exp_f32 v22, v22
    v_exp_f32 v23, v23
    v_cvt_pk_bf16_f32 v50, v20, v21
    v_cvt_pk_bf16_f32 v51, v22, v23
    s_waitcnt lgkmcnt(3)
    v_mfma_f32_32x32x16_bf16 v[32:47], v[72:75], v[52:55], v[32:47]
    ds_read_b128 v[72:75], v79 offset:9216
    v_exp_f32 v24, v24
    v_exp_f32 v25, v25
    v_exp_f32 v26, v26
    v_exp_f32 v27, v27
    v_cvt_pk_bf16_f32 v52, v24, v25
    v_cvt_pk_bf16_f32 v53, v26, v27
    s_waitcnt lgkmcnt(3)
    v_mfma_f32_32x32x16_bf16 v[32:47], v[68:71], v[48:51], v[32:47]
    ds_read_b128 v[68:71], v78 offset:12288
    v_exp_f32 v28, v28
    v_exp_f32 v29, v29
    v_exp_f32 v30, v30
    v_exp_f32 v31, v31
    v_cvt_pk_bf16_f32 v54, v28, v29
    v_cvt_pk_bf16_f32 v55, v30, v31
    s_setprio 1
    s_waitcnt lgkmcnt(3)
    v_mfma_f32_32x32x16_bf16 v[16:31], v[56:59], v[64:67], 0
    ds_read_b128 v[56:59], v76 offset:18432
    v_exp_f32 v0, v0
    v_exp_f32 v1, v1
    v_exp_f32 v2, v2
    v_exp_f32 v3, v3
    v_cvt_pk_bf16_f32 v48, v0, v1
    v_cvt_pk_bf16_f32 v49, v2, v3
    s_waitcnt lgkmcnt(3)
    v_mfma_f32_32x32x8_bf16 v[16:31], v[60:61], v[62:63], v[16:31]
    ds_read_b64 v[60:61], v77 offset:18432
    v_exp_f32 v4, v4
    v_exp_f32 v5, v5
    v_exp_f32 v6, v6
    v_exp_f32 v7, v7
    v_cvt_pk_bf16_f32 v50, v4, v5
    v_cvt_pk_bf16_f32 v51, v6, v7
    s_waitcnt lgkmcnt(3)
    v_mfma_f32_32x32x16_bf16 v[32:47], v[72:75], v[52:55], v[32:47]
    ds_read_b128 v[72:75], v79 offset:12288
    s_mul_i32 s36, s12, 122880
    buffer_load_dword v238, v239, s[20:23], s36 offen
    v_exp_f32 v8, v8
    v_exp_f32 v9, v9
    v_exp_f32 v10, v10
    v_exp_f32 v11, v11
    v_cvt_pk_bf16_f32 v52, v8, v9
    v_cvt_pk_bf16_f32 v53, v10, v11
    s_waitcnt lgkmcnt(3)
    v_mfma_f32_32x32x16_bf16 v[32:47], v[68:71], v[48:51], v[32:47]
    ds_read_b128 v[68:71], v78 offset:15360
    v_exp_f32 v12, v12
    v_exp_f32 v13, v13
    v_exp_f32 v14, v14
    v_exp_f32 v15, v15
    v_cvt_pk_bf16_f32 v54, v12, v13
    v_cvt_pk_bf16_f32 v55, v14, v15
    s_setprio 0
    s_waitcnt lgkmcnt(3)
    v_mfma_f32_32x32x16_bf16 v[0:15], v[56:59], v[64:67], 0
    ds_read_b128 v[56:59], v76 offset:21504
    v_exp_f32 v16, v16
    v_exp_f32 v17, v17
    v_exp_f32 v18, v18
    v_exp_f32 v19, v19
    v_cvt_pk_bf16_f32 v48, v16, v17
    v_cvt_pk_bf16_f32 v49, v18, v19
    s_waitcnt lgkmcnt(3)
    v_mfma_f32_32x32x8_bf16 v[0:15], v[60:61], v[62:63], v[0:15]
    ds_read_b64 v[60:61], v77 offset:21504
    v_exp_f32 v20, v20
    v_exp_f32 v21, v21
    v_exp_f32 v22, v22
    v_exp_f32 v23, v23
    v_cvt_pk_bf16_f32 v50, v20, v21
    v_cvt_pk_bf16_f32 v51, v22, v23
    s_waitcnt lgkmcnt(3)
    v_mfma_f32_32x32x16_bf16 v[32:47], v[72:75], v[52:55], v[32:47]
    ds_read_b128 v[72:75], v79 offset:15360
    s_lshr_b32 s36, s14, 2
    s_mul_i32 s36, s36, 102400
    s_and_b32 s37, s14, 3
    s_mul_i32 s37, s37, 25600
    s_add_u32 s36, s36, s37
    s_lshl_b32 s37, s12, 12
    s_add_u32 s36, s36, s37
    s_add_u32 s36, s36, 0x1c80000
    v_lshlrev_b32 v242, 7, v254
    buffer_load_dword v238, v242, s[8:11], s36 offen
    v_exp_f32 v24, v24
    v_exp_f32 v25, v25
    v_exp_f32 v26, v26
    v_exp_f32 v27, v27
    v_cvt_pk_bf16_f32 v52, v24, v25
    v_cvt_pk_bf16_f32 v53, v26, v27
    s_waitcnt lgkmcnt(3)
    v_mfma_f32_32x32x16_bf16 v[32:47], v[68:71], v[48:51], v[32:47]
    ds_read_b128 v[68:71], v78 offset:18432
    v_exp_f32 v28, v28
    v_exp_f32 v29, v29
    v_exp_f32 v30, v30
    v_exp_f32 v31, v31
    v_cvt_pk_bf16_f32 v54, v28, v29
    v_cvt_pk_bf16_f32 v55, v30, v31
    s_waitcnt vmcnt(3)
    s_barrier
    s_setprio 3
    s_waitcnt lgkmcnt(3)
    v_mfma_f32_32x32x16_bf16 v[16:31], v[56:59], v[64:67], 0
    ds_read_b128 v[56:59], v76 offset:24576
    v_exp_f32 v0, v0
    v_exp_f32 v1, v1
    v_exp_f32 v2, v2
    v_exp_f32 v3, v3
    v_cvt_pk_bf16_f32 v48, v0, v1
    v_cvt_pk_bf16_f32 v49, v2, v3
    s_waitcnt lgkmcnt(3)
    v_mfma_f32_32x32x8_bf16 v[16:31], v[60:61], v[62:63], v[16:31]
    ds_read_b64 v[60:61], v77 offset:24576
    v_exp_f32 v4, v4
    v_exp_f32 v5, v5
    v_exp_f32 v6, v6
    v_exp_f32 v7, v7
    v_cvt_pk_bf16_f32 v50, v4, v5
    v_cvt_pk_bf16_f32 v51, v6, v7
    s_waitcnt lgkmcnt(3)
    v_mfma_f32_32x32x16_bf16 v[32:47], v[72:75], v[52:55], v[32:47]
    ds_read_b128 v[72:75], v79 offset:18432
    v_exp_f32 v8, v8
    v_exp_f32 v9, v9
    v_exp_f32 v10, v10
    v_exp_f32 v11, v11
    v_cvt_pk_bf16_f32 v52, v8, v9
    v_cvt_pk_bf16_f32 v53, v10, v11
    s_waitcnt lgkmcnt(3)
    v_mfma_f32_32x32x16_bf16 v[32:47], v[68:71], v[48:51], v[32:47]
    ds_read_b128 v[68:71], v78 offset:21504
    v_exp_f32 v12, v12
    v_exp_f32 v13, v13
    v_exp_f32 v14, v14
    v_exp_f32 v15, v15
    v_cvt_pk_bf16_f32 v54, v12, v13
    v_cvt_pk_bf16_f32 v55, v14, v15
    s_waitcnt lgkmcnt(3)
    v_mfma_f32_32x32x16_bf16 v[0:15], v[56:59], v[64:67], 0
    ds_read_b128 v[56:59], v76 offset:27648
    v_exp_f32 v16, v16
    v_exp_f32 v17, v17
    v_exp_f32 v18, v18
    v_exp_f32 v19, v19
    v_cvt_pk_bf16_f32 v48, v16, v17
    v_cvt_pk_bf16_f32 v49, v18, v19
    s_waitcnt lgkmcnt(3)
    v_mfma_f32_32x32x8_bf16 v[0:15], v[60:61], v[62:63], v[0:15]
    ds_read_b64 v[60:61], v77 offset:27648
    v_exp_f32 v20, v20
    v_exp_f32 v21, v21
    v_exp_f32 v22, v22
    v_exp_f32 v23, v23
    v_cvt_pk_bf16_f32 v50, v20, v21
    v_cvt_pk_bf16_f32 v51, v22, v23
    s_waitcnt lgkmcnt(3)
    v_mfma_f32_32x32x16_bf16 v[32:47], v[72:75], v[52:55], v[32:47]
    ds_read_b128 v[72:75], v79 offset:21504
    v_exp_f32 v24, v24
    v_exp_f32 v25, v25
    v_exp_f32 v26, v26
    v_exp_f32 v27, v27
    v_cvt_pk_bf16_f32 v52, v24, v25
    v_cvt_pk_bf16_f32 v53, v26, v27
    s_waitcnt lgkmcnt(3)
    v_mfma_f32_32x32x16_bf16 v[32:47], v[68:71], v[48:51], v[32:47]
    ds_read_b128 v[68:71], v78 offset:24576
    v_exp_f32 v28, v28
    v_exp_f32 v29, v29
    v_exp_f32 v30, v30
    v_exp_f32 v31, v31
    v_cvt_pk_bf16_f32 v54, v28, v29
    v_cvt_pk_bf16_f32 v55, v30, v31
    s_setprio 3
    s_waitcnt lgkmcnt(3)
    v_mfma_f32_32x32x16_bf16 v[16:31], v[56:59], v[64:67], 0
    ds_read_b128 v[56:59], v76 offset:30720
    v_exp_f32 v0, v0
    v_exp_f32 v1, v1
    v_exp_f32 v2, v2
    v_exp_f32 v3, v3
    v_cvt_pk_bf16_f32 v48, v0, v1
    v_cvt_pk_bf16_f32 v49, v2, v3
    s_waitcnt lgkmcnt(3)
    v_mfma_f32_32x32x8_bf16 v[16:31], v[60:61], v[62:63], v[16:31]
    ds_read_b64 v[60:61], v77 offset:30720
    v_exp_f32 v4, v4
    v_exp_f32 v5, v5
    v_exp_f32 v6, v6
    v_exp_f32 v7, v7
    v_cvt_pk_bf16_f32 v50, v4, v5
    v_cvt_pk_bf16_f32 v51, v6, v7
    s_waitcnt lgkmcnt(3)
    v_mfma_f32_32x32x16_bf16 v[32:47], v[72:75], v[52:55], v[32:47]
    ds_read_b128 v[72:75], v79 offset:24576
    v_exp_f32 v8, v8
    v_exp_f32 v9, v9
    v_exp_f32 v10, v10
    v_exp_f32 v11, v11
    v_cvt_pk_bf16_f32 v52, v8, v9
    v_cvt_pk_bf16_f32 v53, v10, v11
    s_waitcnt lgkmcnt(3)
    v_mfma_f32_32x32x16_bf16 v[32:47], v[68:71], v[48:51], v[32:47]
    ds_read_b128 v[68:71], v78 offset:27648
    v_exp_f32 v12, v12
    v_exp_f32 v13, v13
    v_exp_f32 v14, v14
    v_exp_f32 v15, v15
    v_cvt_pk_bf16_f32 v54, v12, v13
    v_cvt_pk_bf16_f32 v55, v14, v15
    s_waitcnt lgkmcnt(3)
    v_mfma_f32_32x32x16_bf16 v[0:15], v[56:59], v[64:67], 0
    ds_read_b128 v[56:59], v76 offset:33792
    v_exp_f32 v16, v16
    v_exp_f32 v17, v17
    v_exp_f32 v18, v18
    v_exp_f32 v19, v19
    v_cvt_pk_bf16_f32 v48, v16, v17
    v_cvt_pk_bf16_f32 v49, v18, v19
    s_waitcnt lgkmcnt(3)
    v_mfma_f32_32x32x8_bf16 v[0:15], v[60:61], v[62:63], v[0:15]
    ds_read_b64 v[60:61], v77 offset:33792
    v_exp_f32 v20, v20
    v_exp_f32 v21, v21
    v_exp_f32 v22, v22
    v_exp_f32 v23, v23
    v_cvt_pk_bf16_f32 v50, v20, v21
    v_cvt_pk_bf16_f32 v51, v22, v23
    s_waitcnt lgkmcnt(3)
    v_mfma_f32_32x32x16_bf16 v[32:47], v[72:75], v[52:55], v[32:47]
    ds_read_b128 v[72:75], v79 offset:27648
    v_exp_f32 v24, v24
    v_exp_f32 v25, v25
    v_exp_f32 v26, v26
    v_exp_f32 v27, v27
    v_cvt_pk_bf16_f32 v52, v24, v25
    v_cvt_pk_bf16_f32 v53, v26, v27
    s_waitcnt lgkmcnt(3)
    v_mfma_f32_32x32x16_bf16 v[32:47], v[68:71], v[48:51], v[32:47]
    ds_read_b128 v[68:71], v78 offset:30720
    v_exp_f32 v28, v28
    v_exp_f32 v29, v29
    v_exp_f32 v30, v30
    v_exp_f32 v31, v31
    v_cvt_pk_bf16_f32 v54, v28, v29
    v_cvt_pk_bf16_f32 v55, v30, v31
    s_waitcnt lgkmcnt(3)
    v_mfma_f32_32x32x16_bf16 v[16:31], v[56:59], v[64:67], 0
    ds_read_b128 v[56:59], v76 offset:36864
    v_exp_f32 v0, v0
    v_exp_f32 v1, v1
    v_exp_f32 v2, v2
    v_exp_f32 v3, v3
    v_cvt_pk_bf16_f32 v48, v0, v1
    v_cvt_pk_bf16_f32 v49, v2, v3
    s_waitcnt lgkmcnt(3)
    v_mfma_f32_32x32x8_bf16 v[16:31], v[60:61], v[62:63], v[16:31]
    ds_read_b64 v[60:61], v77 offset:36864
    v_exp_f32 v4, v4
    v_exp_f32 v5, v5
    v_exp_f32 v6, v6
    v_exp_f32 v7, v7
    v_cvt_pk_bf16_f32 v50, v4, v5
    v_cvt_pk_bf16_f32 v51, v6, v7
    s_waitcnt lgkmcnt(3)
    v_mfma_f32_32x32x16_bf16 v[32:47], v[72:75], v[52:55], v[32:47]
    ds_read_b128 v[72:75], v79 offset:30720
    v_exp_f32 v8, v8
    v_exp_f32 v9, v9
    v_exp_f32 v10, v10
    v_exp_f32 v11, v11
    v_cvt_pk_bf16_f32 v52, v8, v9
    v_cvt_pk_bf16_f32 v53, v10, v11
    s_waitcnt lgkmcnt(3)
    v_mfma_f32_32x32x16_bf16 v[32:47], v[68:71], v[48:51], v[32:47]
    ds_read_b128 v[68:71], v78 offset:33792
    v_exp_f32 v12, v12
    v_exp_f32 v13, v13
    v_exp_f32 v14, v14
    v_exp_f32 v15, v15
    v_cvt_pk_bf16_f32 v54, v12, v13
    v_cvt_pk_bf16_f32 v55, v14, v15
    s_waitcnt lgkmcnt(3)
    v_mfma_f32_32x32x16_bf16 v[0:15], v[56:59], v[64:67], 0
    ds_read_b128 v[56:59], v76 offset:39936
    v_exp_f32 v16, v16
    v_exp_f32 v17, v17
    v_exp_f32 v18, v18
    v_exp_f32 v19, v19
    v_cvt_pk_bf16_f32 v48, v16, v17
    v_cvt_pk_bf16_f32 v49, v18, v19
    s_waitcnt lgkmcnt(3)
    v_mfma_f32_32x32x8_bf16 v[0:15], v[60:61], v[62:63], v[0:15]
    ds_read_b64 v[60:61], v77 offset:39936
    v_exp_f32 v20, v20
    v_exp_f32 v21, v21
    v_exp_f32 v22, v22
    v_exp_f32 v23, v23
    v_cvt_pk_bf16_f32 v50, v20, v21
    v_cvt_pk_bf16_f32 v51, v22, v23
    s_waitcnt lgkmcnt(3)
    v_mfma_f32_32x32x16_bf16 v[32:47], v[72:75], v[52:55], v[32:47]
    ds_read_b128 v[72:75], v79 offset:33792
    v_exp_f32 v24, v24
    v_exp_f32 v25, v25
    v_exp_f32 v26, v26
    v_exp_f32 v27, v27
    v_cvt_pk_bf16_f32 v52, v24, v25
    v_cvt_pk_bf16_f32 v53, v26, v27
    s_waitcnt lgkmcnt(3)
    v_mfma_f32_32x32x16_bf16 v[32:47], v[68:71], v[48:51], v[32:47]
    ds_read_b128 v[68:71], v78 offset:36864
    v_exp_f32 v28, v28
    v_exp_f32 v29, v29
    v_exp_f32 v30, v30
    v_exp_f32 v31, v31
    v_cvt_pk_bf16_f32 v54, v28, v29
    v_cvt_pk_bf16_f32 v55, v30, v31
    s_setprio 2
    s_waitcnt lgkmcnt(3)
    v_mfma_f32_32x32x16_bf16 v[16:31], v[56:59], v[64:67], 0
    ds_read_b128 v[56:59], v76 offset:43008
    v_exp_f32 v0, v0
    v_exp_f32 v1, v1
    v_exp_f32 v2, v2
    v_exp_f32 v3, v3
    v_cvt_pk_bf16_f32 v48, v0, v1
    v_cvt_pk_bf16_f32 v49, v2, v3
    s_waitcnt lgkmcnt(3)
    v_mfma_f32_32x32x8_bf16 v[16:31], v[60:61], v[62:63], v[16:31]
    ds_read_b64 v[60:61], v77 offset:43008
    v_exp_f32 v4, v4
    v_exp_f32 v5, v5
    v_exp_f32 v6, v6
    v_exp_f32 v7, v7
    v_cvt_pk_bf16_f32 v50, v4, v5
    v_cvt_pk_bf16_f32 v51, v6, v7
    s_waitcnt lgkmcnt(3)
    v_mfma_f32_32x32x16_bf16 v[32:47], v[72:75], v[52:55], v[32:47]
    ds_read_b128 v[72:75], v79 offset:36864
    v_exp_f32 v8, v8
    v_exp_f32 v9, v9
    v_exp_f32 v10, v10
    v_exp_f32 v11, v11
    v_cvt_pk_bf16_f32 v52, v8, v9
    v_cvt_pk_bf16_f32 v53, v10, v11
    s_waitcnt lgkmcnt(3)
    v_mfma_f32_32x32x16_bf16 v[32:47], v[68:71], v[48:51], v[32:47]
    ds_read_b128 v[68:71], v78 offset:39936
    v_exp_f32 v12, v12
    v_exp_f32 v13, v13
    v_exp_f32 v14, v14
    v_exp_f32 v15, v15
    v_cvt_pk_bf16_f32 v54, v12, v13
    v_cvt_pk_bf16_f32 v55, v14, v15
    s_waitcnt lgkmcnt(3)
    v_mfma_f32_32x32x16_bf16 v[0:15], v[56:59], v[64:67], 0
    ds_read_b128 v[56:59], v76 offset:46080
    v_exp_f32 v16, v16
    v_exp_f32 v17, v17
    v_exp_f32 v18, v18
    v_exp_f32 v19, v19
    v_cvt_pk_bf16_f32 v48, v16, v17
    v_cvt_pk_bf16_f32 v49, v18, v19
    s_waitcnt lgkmcnt(3)
    v_mfma_f32_32x32x8_bf16 v[0:15], v[60:61], v[62:63], v[0:15]
    ds_read_b64 v[60:61], v77 offset:46080
    v_exp_f32 v20, v20
    v_exp_f32 v21, v21
    v_exp_f32 v22, v22
    v_exp_f32 v23, v23
    v_cvt_pk_bf16_f32 v50, v20, v21
    v_cvt_pk_bf16_f32 v51, v22, v23
    s_waitcnt lgkmcnt(3)
    v_mfma_f32_32x32x16_bf16 v[32:47], v[72:75], v[52:55], v[32:47]
    ds_read_b128 v[72:75], v79 offset:39936
    v_exp_f32 v24, v24
    v_exp_f32 v25, v25
    v_exp_f32 v26, v26
    v_exp_f32 v27, v27
    v_cvt_pk_bf16_f32 v52, v24, v25
    v_cvt_pk_bf16_f32 v53, v26, v27
    s_waitcnt lgkmcnt(3)
    v_mfma_f32_32x32x16_bf16 v[32:47], v[68:71], v[48:51], v[32:47]
    ds_read_b128 v[68:71], v78 offset:43008
    v_exp_f32 v28, v28
    v_exp_f32 v29, v29
    v_exp_f32 v30, v30
    v_exp_f32 v31, v31
    v_cvt_pk_bf16_f32 v54, v28, v29
    v_cvt_pk_bf16_f32 v55, v30, v31
    s_setprio 1
    s_waitcnt lgkmcnt(3)
    v_mfma_f32_32x32x16_bf16 v[16:31], v[56:59], v[64:67], 0
    v_exp_f32 v0, v0
    v_exp_f32 v1, v1
    v_exp_f32 v2, v2
    v_exp_f32 v3, v3
    v_cvt_pk_bf16_f32 v48, v0, v1
    v_cvt_pk_bf16_f32 v49, v2, v3
    s_waitcnt lgkmcnt(2)
    v_mfma_f32_32x32x8_bf16 v[16:31], v[60:61], v[62:63], v[16:31]
    v_exp_f32 v4, v4
    v_exp_f32 v5, v5
    v_exp_f32 v6, v6
    v_exp_f32 v7, v7
    v_cvt_pk_bf16_f32 v50, v4, v5
    v_cvt_pk_bf16_f32 v51, v6, v7
    s_waitcnt lgkmcnt(1)
    v_mfma_f32_32x32x16_bf16 v[32:47], v[72:75], v[52:55], v[32:47]
    ds_read_b128 v[72:75], v79 offset:43008
    v_exp_f32 v8, v8
    v_exp_f32 v9, v9
    v_exp_f32 v10, v10
    v_exp_f32 v11, v11
    v_cvt_pk_bf16_f32 v52, v8, v9
    v_cvt_pk_bf16_f32 v53, v10, v11
    s_waitcnt lgkmcnt(1)
    v_mfma_f32_32x32x16_bf16 v[32:47], v[68:71], v[48:51], v[32:47]
    ds_read_b128 v[68:71], v78 offset:46080
    v_exp_f32 v12, v12
    v_exp_f32 v13, v13
    v_exp_f32 v14, v14
    v_exp_f32 v15, v15
    v_cvt_pk_bf16_f32 v54, v12, v13
    v_cvt_pk_bf16_f32 v55, v14, v15
    s_setprio 0
    v_exp_f32 v16, v16
    v_exp_f32 v17, v17
    v_exp_f32 v18, v18
    v_exp_f32 v19, v19
    v_cvt_pk_bf16_f32 v48, v16, v17
    v_cvt_pk_bf16_f32 v49, v18, v19
    v_exp_f32 v20, v20
    v_exp_f32 v21, v21
    v_exp_f32 v22, v22
    v_exp_f32 v23, v23
    v_cvt_pk_bf16_f32 v50, v20, v21
    v_cvt_pk_bf16_f32 v51, v22, v23
    s_waitcnt lgkmcnt(1)
    v_mfma_f32_32x32x16_bf16 v[32:47], v[72:75], v[52:55], v[32:47]
    ds_read_b128 v[72:75], v79 offset:46080
    v_exp_f32 v24, v24
    v_exp_f32 v25, v25
    v_exp_f32 v26, v26
    v_exp_f32 v27, v27
    v_cvt_pk_bf16_f32 v52, v24, v25
    v_cvt_pk_bf16_f32 v53, v26, v27
    s_waitcnt lgkmcnt(1)
    v_mfma_f32_32x32x16_bf16 v[32:47], v[68:71], v[48:51], v[32:47]
    v_exp_f32 v28, v28
    v_exp_f32 v29, v29
    v_exp_f32 v30, v30
    v_exp_f32 v31, v31
    v_cvt_pk_bf16_f32 v54, v28, v29
    v_cvt_pk_bf16_f32 v55, v30, v31
    s_waitcnt lgkmcnt(0)
    s_nop 0
    v_mfma_f32_32x32x16_bf16 v[32:47], v[72:75], v[52:55], v[32:47]
    s_mov_b32 s36, 0x5d800000
    s_lshl_b32 s43, s39, 15
    s_add_u32 s43, s43, 0x500000
    s_lshl_b32 s44, s14, 9
    s_add_u32 s43, s43, s44
    s_lshl_b32 s44, s14, 14
    s_lshl_b32 s45, s39, 8
    s_add_u32 s44, s44, s45
    s_add_u32 s44, s44, 0x700000
    v_lshrrev_b32 v84, 4, v254
    v_lshlrev_b32 v84, 14, v84
    v_lshl_add_u32 v84, v253, 8, v84
    v_and_b32 v85, 15, v254
    v_lshl_add_u32 v84, v85, 4, v84
    v_lshlrev_b32 v85, 3, v254
    v_cmp_ngt_f32 vcc, s36, v44
    s_cbranch_vccnz L_af_fb
L_af_store:
    v_rcp_f32 v82, v44
    s_nop 0
    v_mov_b32 v83, v82
    v_pk_mul_f32 v[32:33], v[32:33], v[82:83]
    v_pk_mul_f32 v[34:35], v[34:35], v[82:83]
    v_pk_mul_f32 v[36:37], v[36:37], v[82:83]
    v_pk_mul_f32 v[38:39], v[38:39], v[82:83]
    v_pk_mul_f32 v[40:41], v[40:41], v[82:83]
    v_pk_mul_f32 v[42:43], v[42:43], v[82:83]
    v_cvt_pk_bf16_f32 v32, v32, v33
    v_cvt_pk_bf16_f32 v33, v34, v35
    v_cvt_pk_bf16_f32 v34, v36, v37
    v_cvt_pk_bf16_f32 v35, v38, v39
    v_cvt_pk_bf16_f32 v36, v40, v41
    v_cvt_pk_bf16_f32 v37, v42, v43
    v_permlane32_swap_b32 v32, v34
    v_permlane32_swap_b32 v33, v35
    buffer_store_dwordx4 v[32:35], v84, s[8:11], s43 offen
    s_mov_b64 exec, s[28:29]
    buffer_store_dwordx2 v[36:37], v85, s[8:11], s44 offen
    s_mov_b64 exec, -1
    s_branch L_att_done
L_af_fb:
    s_mov_b32 s46, 0
    s_mov_b32 s47, 63
    v_mov_b32 v86, 81920
    v_cndmask_b32 v95, v86, v245, s[28:29]
    s_and_b32 s48, s14, 1
    s_lshl_b32 s48, s48, 2
    v_add_u32 v87, s48, v254
    v_subrev_u32 v88, 20, v87
    v_cmp_gt_u32 s[50:51], 20, v87
    v_cmp_gt_u32 s[52:53], 20, v254
    s_mul_i32 s48, s14, 320
    s_add_u32 s48, s48, 40960
    v_cndmask_b32 v87, v88, v87, s[50:51]
    v_mul_u32_u24 v88, 10240, v253
    v_lshl_add_u32 v87, v87, 4, v88
    v_add_u32 v87, s48, v87
    v_add_u32 v88, 20480, v87
    v_cndmask_b32 v96, v86, v87, s[52:53]
    v_cndmask_b32 v97, v86, v88, s[52:53]
    v_mov_b32 v80, 0
    v_cndmask_b32 v62, v80, v62, s[28:29]
    v_cndmask_b32 v63, v80, v63, s[28:29]
    v_mov_b32 v92, 0xf149f2ca
    v_mov_b32 v32, 0
    v_mov_b32 v33, 0
    v_mov_b32 v34, 0
    v_mov_b32 v35, 0
    v_mov_b32 v36, 0
    v_mov_b32 v37, 0
    v_mov_b32 v38, 0
    v_mov_b32 v39, 0
    v_mov_b32 v40, 0
    v_mov_b32 v41, 0
    v_mov_b32 v42, 0
    v_mov_b32 v43, 0
    v_mov_b32 v44, 0
    v_mov_b32 v45, 0
    v_mov_b32 v46, 0
    v_mov_b32 v47, 0
    s_mov_b32 s49, 0
L_fbpass_122:
    s_mov_b32 s48, s46
L_fbtile_123:
    s_mul_i32 s50, s48, 82048
    buffer_load_dwordx4 v[56:59], v249, s[32:35], s50 offen sc1
    buffer_load_dwordx2 v[60:61], v95, s[32:35], s50 offen sc1
    buffer_load_dwordx4 v[68:71], v96, s[32:35], s50 offen sc1
    buffer_load_dwordx4 v[72:75], v97, s[32:35], s50 offen sc1
    v_mov_b32 v16, 0
    v_mov_b32 v17, 0
    v_mov_b32 v18, 0
    v_mov_b32 v19, 0
    v_mov_b32 v20, 0
    v_mov_b32 v21, 0
    v_mov_b32 v22, 0
    v_mov_b32 v23, 0
    v_mov_b32 v24, 0
    v_mov_b32 v25, 0
    v_mov_b32 v26, 0
    v_mov_b32 v27, 0
    v_mov_b32 v28, 0
    v_mov_b32 v29, 0
    v_mov_b32 v30, 0
    v_mov_b32 v31, 0
    s_waitcnt vmcnt(0)
    s_nop 1
    v_mfma_f32_32x32x16_bf16 v[0:15], v[56:59], v[64:67], v[16:31]
    v_mfma_f32_32x32x8_bf16 v[0:15], v[60:61], v[62:63], v[0:15]
    s_nop 15
    s_cmp_lg_u32 s49, 0
    s_cbranch_scc1 L_fbp2_124
    v_max3_f32 v92, v92, v0, v1
    v_max3_f32 v92, v92, v2, v3
    v_max3_f32 v92, v92, v4, v5
    v_max3_f32 v92, v92, v6, v7
    v_max3_f32 v92, v92, v8, v9
    v_max3_f32 v92, v92, v10, v11
    v_max3_f32 v92, v92, v12, v13
    v_max3_f32 v92, v92, v14, v15
    s_branch L_fbnext_125
L_fbp2_124:
    v_exp_f32 v0, v0
    v_exp_f32 v1, v1
    v_exp_f32 v2, v2
    v_exp_f32 v3, v3
    v_exp_f32 v4, v4
    v_exp_f32 v5, v5
    v_exp_f32 v6, v6
    v_exp_f32 v7, v7
    v_exp_f32 v8, v8
    v_exp_f32 v9, v9
    v_exp_f32 v10, v10
    v_exp_f32 v11, v11
    v_exp_f32 v12, v12
    v_exp_f32 v13, v13
    v_exp_f32 v14, v14
    v_exp_f32 v15, v15
    s_nop 0
    v_cvt_pk_bf16_f32 v48, v0, v1
    v_cvt_pk_bf16_f32 v49, v2, v3
    v_cvt_pk_bf16_f32 v50, v4, v5
    v_cvt_pk_bf16_f32 v51, v6, v7
    v_cvt_pk_bf16_f32 v52, v8, v9
    v_cvt_pk_bf16_f32 v53, v10, v11
    v_cvt_pk_bf16_f32 v54, v12, v13
    v_cvt_pk_bf16_f32 v55, v14, v15
    s_nop 1
    v_mfma_f32_32x32x16_bf16 v[32:47], v[68:71], v[48:51], v[32:47]
    v_mfma_f32_32x32x16_bf16 v[32:47], v[72:75], v[52:55], v[32:47]
    s_nop 15
L_fbnext_125:
    s_add_u32 s48, s48, 1
    s_cmp_le_u32 s48, s47
    s_cbranch_scc1 L_fbtile_123
    s_cmp_lg_u32 s49, 0
    s_cbranch_scc1 L_af_store
    s_mov_b32 s49, 1
    v_mov_b32 v93, v84
    v_mov_b32 v94, v85
    v_mov_b32 v80, v92
    v_mov_b32 v81, v80
    s_nop 1
    v_permlane32_swap_b32 v80, v81
    s_nop 1
    v_max_f32 v80, v80, v81
    v_sub_f32 v80, 0, v80
    v_and_b32 v84, s31, v80
    v_sub_f32 v85, v80, v84
    v_and_b32 v83, s31, v85
    v_perm_b32 v82, v83, v84, s30
    v_sub_f32 v85, v85, v83
    v_lshrrev_b32 v83, 16, v85
    v_cndmask_b32 v62, v82, v62, s[28:29]
    v_cndmask_b32 v63, v83, v63, s[28:29]
    v_mov_b32 v84, v93
    v_mov_b32 v85, v94
    s_branch L_fbpass_122
L_att_done:
    s_add_u32 s17, s17, 1
    s_and_b32 s39, s14, 3
    s_lshr_b32 s40, s14, 2
    s_cmp_ge_u32 s12, 4
    s_cbranch_scc1 L_op_help
    s_lshl_b32 s41, s13, 4
    s_lshl_b32 s42, s39, 2
    s_add_u32 s41, s41, s42
    s_add_u32 s41, s41, s12
    s_lshl_b32 s43, s41, 14
    s_add_u32 s43, s43, 0x500000
    s_lshl_b32 s44, s41, 7
    s_add_u32 s44, s44, 0x700000
    s_lshr_b32 s45, s41, 1
    s_mul_i32 s45, s45, 40960
    s_mul_i32 s46, s40, 5120
    s_add_u32 s45, s45, s46
    s_add_u32 s45, s45, 0x0
    s_add_u32 s46, s45, 4096
    s_and_b32 s47, s41, 1
    s_lshl_b32 s47, s47, 8
    v_bfe_u32 v172, v255, 4, 4
    v_lshrrev_b32 v173, 8, v255
    v_add_u32 v160, 0x10000, v255
    v_add_u32 v161, 0x20000, v255
    v_lshlrev_b32 v162, 9, v173
    v_lshl_add_u32 v162, v172, 4, v162
    v_add_u32 v162, s47, v162
    v_lshlrev_b32 v163, 15, v173
    v_lshl_add_u32 v163, v172, 3, v163
    s_waitcnt vmcnt(2)
    v_lshlrev_b32 v0, 16, v138
    v_and_b32 v1, s31, v138
    v_lshlrev_b32 v2, 16, v139
    v_and_b32 v3, s31, v139
    v_lshlrev_b32 v4, 16, v140
    v_and_b32 v5, s31, v140
    v_lshlrev_b32 v6, 16, v141
    v_and_b32 v7, s31, v141
    v_lshlrev_b32 v8, 16, v142
    v_and_b32 v9, s31, v142
    v_lshlrev_b32 v10, 16, v143
    v_and_b32 v11, s31, v143
    v_lshlrev_b32 v12, 16, v144
    v_and_b32 v13, s31, v144
    v_lshlrev_b32 v14, 16, v145
    v_and_b32 v15, s31, v145
    v_lshlrev_b32 v16, 16, v146
    v_and_b32 v17, s31, v146
    v_lshlrev_b32 v18, 16, v147
    v_and_b32 v19, s31, v147
    s_waitcnt vmcnt(0) lgkmcnt(0)
    s_barrier
    s_cmp_lg_u32 s12, 0
    s_cbranch_scc1 L_att_sk_126
    s_mov_b64 exec, 1
    v_mov_b32 v240, s17
    v_mov_b32 v241, s19
    s_cmp_lg_u32 s15, 0
    s_cbranch_scc1 L_att_sf_127
    buffer_store_dword v240, v241, s[8:11], 0 offen
    s_branch L_att_g_128
L_att_sf_127:
    buffer_wbl2 sc1
    s_waitcnt vmcnt(0)
    buffer_store_dword v240, v241, s[8:11], 0 offen sc1
L_att_g_128:
    s_mov_b64 exec, -1
L_att_sk_126:
    buffer_load_dword v240, v252, s[8:11], s18 offen sc1
    ds_read_b128 v[20:23], v160 offset:11264
    ds_read_b128 v[24:27], v160 offset:12288
    ds_read_b128 v[28:31], v160 offset:13312
    ds_read_b128 v[32:35], v160 offset:14336
    ds_read_b128 v[36:39], v160 offset:15360
    ds_read_b128 v[40:43], v160 offset:16384
    ds_read_b128 v[44:47], v160 offset:17408
    ds_read_b128 v[48:51], v160 offset:18432
    ds_read_b128 v[52:55], v160 offset:19456
    ds_read_b128 v[56:59], v160 offset:20480
    s_waitcnt vmcnt(0)
    v_cmp_gt_u32 vcc, s17, v240
    s_cbranch_vccz L_op_d_130
    s_mov_b32 s37, 400000
L_op_p_129:
    buffer_load_dword v240, v252, s[8:11], s18 offen sc1
    s_waitcnt vmcnt(0)
    v_cmp_gt_u32 vcc, s17, v240
    s_cbranch_vccz L_op_d_130
    s_sub_u32 s37, s37, 1
    s_cmp_lg_u32 s37, 0
    s_cbranch_scc1 L_op_p_129
L_op_d_130:
    s_add_u32 s47, s43, 0
    buffer_load_dwordx4 v[60:63], v255, s[8:11], s47 offen offset:0 sc1
    buffer_load_dwordx4 v[64:67], v255, s[8:11], s47 offen offset:1024 sc1
    buffer_load_dwordx4 v[68:71], v255, s[8:11], s47 offen offset:2048 sc1
    buffer_load_dwordx4 v[72:75], v255, s[8:11], s47 offen offset:3072 sc1
    s_add_u32 s47, s43, 4096
    buffer_load_dwordx4 v[76:79], v255, s[8:11], s47 offen offset:0 sc1
    buffer_load_dwordx4 v[80:83], v255, s[8:11], s47 offen offset:1024 sc1
    buffer_load_dwordx4 v[84:87], v255, s[8:11], s47 offen offset:2048 sc1
    buffer_load_dwordx4 v[88:91], v255, s[8:11], s47 offen offset:3072 sc1
    s_waitcnt vmcnt(7)
    s_waitcnt lgkmcnt(9)
    v_mfma_f32_16x16x32_bf16 v[0:3], v[20:23], v[60:63], v[0:3]
    ds_read_b128 v[20:23], v160 offset:21504
    s_waitcnt lgkmcnt(9)
    v_mfma_f32_16x16x32_bf16 v[4:7], v[24:27], v[60:63], v[4:7]
    ds_read_b128 v[24:27], v160 offset:22528
    s_add_u32 s47, s43, 8192
    buffer_load_dwordx4 v[92:95], v255, s[8:11], s47 offen offset:0 sc1
    s_waitcnt lgkmcnt(9)
    v_mfma_f32_16x16x32_bf16 v[8:11], v[28:31], v[60:63], v[8:11]
    ds_read_b128 v[28:31], v160 offset:23552
    s_waitcnt lgkmcnt(9)
    v_mfma_f32_16x16x32_bf16 v[12:15], v[32:35], v[60:63], v[12:15]
    ds_read_b128 v[32:35], v160 offset:24576
    buffer_load_dwordx4 v[96:99], v255, s[8:11], s47 offen offset:1024 sc1
    s_waitcnt lgkmcnt(9)
    v_mfma_f32_16x16x32_bf16 v[16:19], v[36:39], v[60:63], v[16:19]
    ds_read_b128 v[36:39], v160 offset:25600
    s_waitcnt vmcnt(8)
    s_waitcnt lgkmcnt(9)
    v_mfma_f32_16x16x32_bf16 v[0:3], v[40:43], v[64:67], v[0:3]
    ds_read_b128 v[40:43], v160 offset:26624
    s_waitcnt lgkmcnt(9)
    v_mfma_f32_16x16x32_bf16 v[4:7], v[44:47], v[64:67], v[4:7]
    ds_read_b128 v[44:47], v160 offset:27648
    buffer_load_dwordx4 v[100:103], v255, s[8:11], s47 offen offset:2048 sc1
    s_waitcnt lgkmcnt(9)
    v_mfma_f32_16x16x32_bf16 v[8:11], v[48:51], v[64:67], v[8:11]
    ds_read_b128 v[48:51], v160 offset:28672
    s_waitcnt lgkmcnt(9)
    v_mfma_f32_16x16x32_bf16 v[12:15], v[52:55], v[64:67], v[12:15]
    ds_read_b128 v[52:55], v160 offset:29696
    buffer_load_dwordx4 v[104:107], v255, s[8:11], s47 offen offset:3072 sc1
    s_waitcnt lgkmcnt(9)
    v_mfma_f32_16x16x32_bf16 v[16:19], v[56:59], v[64:67], v[16:19]
    ds_read_b128 v[56:59], v160 offset:30720
    s_waitcnt vmcnt(9)
    s_waitcnt lgkmcnt(9)
    v_mfma_f32_16x16x32_bf16 v[0:3], v[20:23], v[68:71], v[0:3]
    ds_read_b128 v[20:23], v160 offset:31744
    s_waitcnt lgkmcnt(9)
    v_mfma_f32_16x16x32_bf16 v[4:7], v[24:27], v[68:71], v[4:7]
    ds_read_b128 v[24:27], v160 offset:32768
    s_add_u32 s47, s43, 12288
    buffer_load_dwordx4 v[108:111], v255, s[8:11], s47 offen offset:0 sc1
    s_waitcnt lgkmcnt(9)
    v_mfma_f32_16x16x32_bf16 v[8:11], v[28:31], v[68:71], v[8:11]
    ds_read_b128 v[28:31], v160 offset:33792
    s_waitcnt lgkmcnt(9)
    v_mfma_f32_16x16x32_bf16 v[12:15], v[32:35], v[68:71], v[12:15]
    ds_read_b128 v[32:35], v160 offset:34816
    buffer_load_dwordx4 v[112:115], v255, s[8:11], s47 offen offset:1024 sc1
    s_waitcnt lgkmcnt(9)
    v_mfma_f32_16x16x32_bf16 v[16:19], v[36:39], v[68:71], v[16:19]
    ds_read_b128 v[36:39], v160 offset:35840
    s_waitcnt vmcnt(10)
    s_waitcnt lgkmcnt(9)
    v_mfma_f32_16x16x32_bf16 v[0:3], v[40:43], v[72:75], v[0:3]
    ds_read_b128 v[40:43], v160 offset:36864
    s_waitcnt lgkmcnt(9)
    v_mfma_f32_16x16x32_bf16 v[4:7], v[44:47], v[72:75], v[4:7]
    ds_read_b128 v[44:47], v160 offset:37888
    buffer_load_dwordx4 v[116:119], v255, s[8:11], s47 offen offset:2048 sc1
    s_waitcnt lgkmcnt(9)
    v_mfma_f32_16x16x32_bf16 v[8:11], v[48:51], v[72:75], v[8:11]
    ds_read_b128 v[48:51], v160 offset:38912
    s_waitcnt lgkmcnt(9)
    v_mfma_f32_16x16x32_bf16 v[12:15], v[52:55], v[72:75], v[12:15]
    ds_read_b128 v[52:55], v160 offset:39936
    buffer_load_dwordx4 v[120:123], v255, s[8:11], s47 offen offset:3072 sc1
    s_waitcnt lgkmcnt(9)
    v_mfma_f32_16x16x32_bf16 v[16:19], v[56:59], v[72:75], v[16:19]
    ds_read_b128 v[56:59], v160 offset:40960
    s_waitcnt vmcnt(11)
    s_waitcnt lgkmcnt(9)
    v_mfma_f32_16x16x32_bf16 v[0:3], v[20:23], v[76:79], v[0:3]
    ds_read_b128 v[20:23], v160 offset:41984
    s_waitcnt lgkmcnt(9)
    v_mfma_f32_16x16x32_bf16 v[4:7], v[24:27], v[76:79], v[4:7]
    ds_read_b128 v[24:27], v160 offset:43008
    s_add_u32 s47, s44, 0
    s_add_u32 s48, s44, 16384
    buffer_load_dwordx2 v[124:125], v163, s[8:11], s47 offen sc1
    buffer_load_dwordx2 v[126:127], v163, s[8:11], s48 offen sc1
    s_waitcnt lgkmcnt(9)
    v_mfma_f32_16x16x32_bf16 v[8:11], v[28:31], v[76:79], v[8:11]
    ds_read_b128 v[28:31], v160 offset:44032
    s_waitcnt lgkmcnt(9)
    v_mfma_f32_16x16x32_bf16 v[12:15], v[32:35], v[76:79], v[12:15]
    ds_read_b128 v[32:35], v160 offset:45056
    s_add_u32 s47, s44, 131072
    s_add_u32 s48, s44, 147456
    buffer_load_dwordx2 v[128:129], v163, s[8:11], s47 offen sc1
    buffer_load_dwordx2 v[130:131], v163, s[8:11], s48 offen sc1
    s_waitcnt lgkmcnt(9)
    v_mfma_f32_16x16x32_bf16 v[16:19], v[36:39], v[76:79], v[16:19]
    ds_read_b128 v[36:39], v160 offset:46080
    s_waitcnt vmcnt(14)
    s_waitcnt lgkmcnt(9)
    v_mfma_f32_16x16x32_bf16 v[0:3], v[40:43], v[80:83], v[0:3]
    ds_read_b128 v[40:43], v160 offset:47104
    s_waitcnt lgkmcnt(9)
    v_mfma_f32_16x16x32_bf16 v[4:7], v[44:47], v[80:83], v[4:7]
    ds_read_b128 v[44:47], v160 offset:48128
    s_add_u32 s47, s44, 262144
    s_add_u32 s48, s44, 278528
    buffer_load_dwordx2 v[132:133], v163, s[8:11], s47 offen sc1
    buffer_load_dwordx2 v[134:135], v163, s[8:11], s48 offen sc1
    s_waitcnt lgkmcnt(9)
    v_mfma_f32_16x16x32_bf16 v[8:11], v[48:51], v[80:83], v[8:11]
    ds_read_b128 v[48:51], v160 offset:49152
    s_waitcnt lgkmcnt(9)
    v_mfma_f32_16x16x32_bf16 v[12:15], v[52:55], v[80:83], v[12:15]
    ds_read_b128 v[52:55], v160 offset:50176
    s_add_u32 s47, s44, 393216
    s_add_u32 s48, s44, 409600
    buffer_load_dwordx2 v[136:137], v163, s[8:11], s47 offen sc1
    buffer_load_dwordx2 v[138:139], v163, s[8:11], s48 offen sc1
    s_waitcnt lgkmcnt(9)
    v_mfma_f32_16x16x32_bf16 v[16:19], v[56:59], v[80:83], v[16:19]
    ds_read_b128 v[56:59], v160 offset:51200
    s_barrier
    s_waitcnt vmcnt(17)
    s_waitcnt lgkmcnt(9)
    v_mfma_f32_16x16x32_bf16 v[0:3], v[20:23], v[84:87], v[0:3]
    ds_read_b128 v[20:23], v160 offset:52224
    s_waitcnt lgkmcnt(9)
    v_mfma_f32_16x16x32_bf16 v[4:7], v[24:27], v[84:87], v[4:7]
    ds_read_b128 v[24:27], v160 offset:53248
    s_waitcnt lgkmcnt(9)
    v_mfma_f32_16x16x32_bf16 v[8:11], v[28:31], v[84:87], v[8:11]
    ds_read_b128 v[28:31], v160 offset:54272
    s_waitcnt lgkmcnt(9)
    v_mfma_f32_16x16x32_bf16 v[12:15], v[32:35], v[84:87], v[12:15]
    ds_read_b128 v[32:35], v160 offset:55296
    s_waitcnt lgkmcnt(9)
    v_mfma_f32_16x16x32_bf16 v[16:19], v[36:39], v[84:87], v[16:19]
    ds_read_b128 v[36:39], v160 offset:56320
    s_waitcnt vmcnt(16)
    s_waitcnt lgkmcnt(9)
    v_mfma_f32_16x16x32_bf16 v[0:3], v[40:43], v[88:91], v[0:3]
    ds_read_b128 v[40:43], v160 offset:57344
    s_waitcnt lgkmcnt(9)
    v_mfma_f32_16x16x32_bf16 v[4:7], v[44:47], v[88:91], v[4:7]
    ds_read_b128 v[44:47], v160 offset:58368
    s_waitcnt lgkmcnt(9)
    v_mfma_f32_16x16x32_bf16 v[8:11], v[48:51], v[88:91], v[8:11]
    ds_read_b128 v[48:51], v160 offset:59392
    s_waitcnt lgkmcnt(9)
    v_mfma_f32_16x16x32_bf16 v[12:15], v[52:55], v[88:91], v[12:15]
    ds_read_b128 v[52:55], v160 offset:60416
    s_waitcnt lgkmcnt(9)
    v_mfma_f32_16x16x32_bf16 v[16:19], v[56:59], v[88:91], v[16:19]
    ds_read_b128 v[56:59], v160 offset:61440
    s_waitcnt vmcnt(15)
    s_waitcnt lgkmcnt(9)
    v_mfma_f32_16x16x32_bf16 v[0:3], v[20:23], v[92:95], v[0:3]
    ds_read_b128 v[20:23], v160 offset:62464
    s_waitcnt lgkmcnt(9)
    v_mfma_f32_16x16x32_bf16 v[4:7], v[24:27], v[92:95], v[4:7]
    ds_read_b128 v[24:27], v160 offset:63488
    s_waitcnt lgkmcnt(9)
    v_mfma_f32_16x16x32_bf16 v[8:11], v[28:31], v[92:95], v[8:11]
    ds_read_b128 v[28:31], v160 offset:64512
    s_waitcnt lgkmcnt(9)
    v_mfma_f32_16x16x32_bf16 v[12:15], v[32:35], v[92:95], v[12:15]
    ds_read_b128 v[32:35], v161 offset:0
    s_waitcnt lgkmcnt(9)
    v_mfma_f32_16x16x32_bf16 v[16:19], v[36:39], v[92:95], v[16:19]
    ds_read_b128 v[36:39], v161 offset:1024
    s_waitcnt vmcnt(14)
    s_waitcnt lgkmcnt(9)
    v_mfma_f32_16x16x32_bf16 v[0:3], v[40:43], v[96:99], v[0:3]
    ds_read_b128 v[40:43], v161 offset:2048
    s_waitcnt lgkmcnt(9)
    v_mfma_f32_16x16x32_bf16 v[4:7], v[44:47], v[96:99], v[4:7]
    ds_read_b128 v[44:47], v161 offset:3072
    s_waitcnt lgkmcnt(9)
    v_mfma_f32_16x16x32_bf16 v[8:11], v[48:51], v[96:99], v[8:11]
    ds_read_b128 v[48:51], v161 offset:4096
    s_waitcnt lgkmcnt(9)
    v_mfma_f32_16x16x32_bf16 v[12:15], v[52:55], v[96:99], v[12:15]
    ds_read_b128 v[52:55], v161 offset:5120
    s_waitcnt lgkmcnt(9)
    v_mfma_f32_16x16x32_bf16 v[16:19], v[56:59], v[96:99], v[16:19]
    ds_read_b128 v[56:59], v161 offset:6144
    s_waitcnt vmcnt(13)
    s_waitcnt lgkmcnt(9)
    v_mfma_f32_16x16x32_bf16 v[0:3], v[20:23], v[100:103], v[0:3]
    ds_read_b128 v[20:23], v161 offset:7168
    s_waitcnt lgkmcnt(9)
    v_mfma_f32_16x16x32_bf16 v[4:7], v[24:27], v[100:103], v[4:7]
    ds_read_b128 v[24:27], v161 offset:8192
    s_waitcnt lgkmcnt(9)
    v_mfma_f32_16x16x32_bf16 v[8:11], v[28:31], v[100:103], v[8:11]
    ds_read_b128 v[28:31], v161 offset:9216
    s_waitcnt lgkmcnt(9)
    v_mfma_f32_16x16x32_bf16 v[12:15], v[32:35], v[100:103], v[12:15]
    ds_read_b128 v[32:35], v161 offset:10240
    s_waitcnt lgkmcnt(9)
    v_mfma_f32_16x16x32_bf16 v[16:19], v[36:39], v[100:103], v[16:19]
    ds_read_b128 v[36:39], v161 offset:11264
    s_waitcnt vmcnt(12)
    s_waitcnt lgkmcnt(9)
    v_mfma_f32_16x16x32_bf16 v[0:3], v[40:43], v[104:107], v[0:3]
    ds_read_b128 v[40:43], v161 offset:12288
    s_waitcnt lgkmcnt(9)
    v_mfma_f32_16x16x32_bf16 v[4:7], v[44:47], v[104:107], v[4:7]
    ds_read_b128 v[44:47], v161 offset:13312
    s_waitcnt lgkmcnt(9)
    v_mfma_f32_16x16x32_bf16 v[8:11], v[48:51], v[104:107], v[8:11]
    ds_read_b128 v[48:51], v161 offset:14336
    s_waitcnt lgkmcnt(9)
    v_mfma_f32_16x16x32_bf16 v[12:15], v[52:55], v[104:107], v[12:15]
    ds_read_b128 v[52:55], v161 offset:15360
    s_waitcnt lgkmcnt(9)
    v_mfma_f32_16x16x32_bf16 v[16:19], v[56:59], v[104:107], v[16:19]
    ds_read_b128 v[56:59], v161 offset:16384
    s_waitcnt vmcnt(11)
    s_waitcnt lgkmcnt(9)
    v_mfma_f32_16x16x32_bf16 v[0:3], v[20:23], v[108:111], v[0:3]
    ds_read_b128 v[20:23], v161 offset:17408
    s_waitcnt lgkmcnt(9)
    v_mfma_f32_16x16x32_bf16 v[4:7], v[24:27], v[108:111], v[4:7]
    ds_read_b128 v[24:27], v161 offset:18432
    s_waitcnt lgkmcnt(9)
    v_mfma_f32_16x16x32_bf16 v[8:11], v[28:31], v[108:111], v[8:11]
    ds_read_b128 v[28:31], v161 offset:19456
    s_waitcnt lgkmcnt(9)
    v_mfma_f32_16x16x32_bf16 v[12:15], v[32:35], v[108:111], v[12:15]
    ds_read_b128 v[32:35], v161 offset:20480
    s_waitcnt lgkmcnt(9)
    v_mfma_f32_16x16x32_bf16 v[16:19], v[36:39], v[108:111], v[16:19]
    ds_read_b128 v[36:39], v161 offset:21504
    s_waitcnt vmcnt(10)
    s_waitcnt lgkmcnt(9)
    v_mfma_f32_16x16x32_bf16 v[0:3], v[40:43], v[112:115], v[0:3]
    ds_read_b128 v[40:43], v161 offset:22528
    s_waitcnt lgkmcnt(9)
    v_mfma_f32_16x16x32_bf16 v[4:7], v[44:47], v[112:115], v[4:7]
    ds_read_b128 v[44:47], v161 offset:23552
    s_waitcnt lgkmcnt(9)
    v_mfma_f32_16x16x32_bf16 v[8:11], v[48:51], v[112:115], v[8:11]
    ds_read_b128 v[48:51], v161 offset:24576
    s_waitcnt lgkmcnt(9)
    v_mfma_f32_16x16x32_bf16 v[12:15], v[52:55], v[112:115], v[12:15]
    ds_read_b128 v[52:55], v161 offset:25600
    s_waitcnt lgkmcnt(9)
    v_mfma_f32_16x16x32_bf16 v[16:19], v[56:59], v[112:115], v[16:19]
    ds_read_b128 v[56:59], v161 offset:26624
    s_waitcnt vmcnt(9)
    s_waitcnt lgkmcnt(9)
    v_mfma_f32_16x16x32_bf16 v[0:3], v[20:23], v[116:119], v[0:3]
    ds_read_b128 v[20:23], v161 offset:27648
    s_waitcnt lgkmcnt(9)
    v_mfma_f32_16x16x32_bf16 v[4:7], v[24:27], v[116:119], v[4:7]
    ds_read_b128 v[24:27], v161 offset:28672
    s_waitcnt lgkmcnt(9)
    v_mfma_f32_16x16x32_bf16 v[8:11], v[28:31], v[116:119], v[8:11]
    ds_read_b128 v[28:31], v161 offset:29696
    s_waitcnt lgkmcnt(9)
    v_mfma_f32_16x16x32_bf16 v[12:15], v[32:35], v[116:119], v[12:15]
    ds_read_b128 v[32:35], v161 offset:30720
    s_waitcnt lgkmcnt(9)
    v_mfma_f32_16x16x32_bf16 v[16:19], v[36:39], v[116:119], v[16:19]
    ds_read_b128 v[36:39], v161 offset:31744
    s_waitcnt vmcnt(8)
    s_waitcnt lgkmcnt(9)
    v_mfma_f32_16x16x32_bf16 v[0:3], v[40:43], v[120:123], v[0:3]
    ds_read_b128 v[40:43], v255 offset:61440
    s_waitcnt lgkmcnt(9)
    v_mfma_f32_16x16x32_bf16 v[4:7], v[44:47], v[120:123], v[4:7]
    ds_read_b128 v[44:47], v255 offset:62464
    s_waitcnt lgkmcnt(9)
    v_mfma_f32_16x16x32_bf16 v[8:11], v[48:51], v[120:123], v[8:11]
    ds_read_b128 v[48:51], v255 offset:63488
    s_waitcnt lgkmcnt(9)
    v_mfma_f32_16x16x32_bf16 v[12:15], v[52:55], v[120:123], v[12:15]
    ds_read_b128 v[52:55], v255 offset:64512
    s_waitcnt lgkmcnt(9)
    v_mfma_f32_16x16x32_bf16 v[16:19], v[56:59], v[120:123], v[16:19]
    ds_read_b128 v[56:59], v160 offset:0
    s_waitcnt vmcnt(6)
    s_waitcnt lgkmcnt(9)
    v_mfma_f32_16x16x32_bf16 v[0:3], v[20:23], v[124:127], v[0:3]
    ds_read_b128 v[20:23], v160 offset:1024
    s_waitcnt lgkmcnt(9)
    v_mfma_f32_16x16x32_bf16 v[4:7], v[24:27], v[124:127], v[4:7]
    ds_read_b128 v[24:27], v160 offset:2048
    s_waitcnt lgkmcnt(9)
    v_mfma_f32_16x16x32_bf16 v[8:11], v[28:31], v[124:127], v[8:11]
    ds_read_b128 v[28:31], v160 offset:3072
    s_waitcnt lgkmcnt(9)
    v_mfma_f32_16x16x32_bf16 v[12:15], v[32:35], v[124:127], v[12:15]
    ds_read_b128 v[32:35], v160 offset:4096
    s_waitcnt lgkmcnt(9)
    v_mfma_f32_16x16x32_bf16 v[16:19], v[36:39], v[124:127], v[16:19]
    ds_read_b128 v[36:39], v160 offset:5120
    s_waitcnt vmcnt(4)
    s_waitcnt lgkmcnt(9)
    v_mfma_f32_16x16x32_bf16 v[0:3], v[40:43], v[128:131], v[0:3]
    ds_read_b128 v[40:43], v160 offset:6144
    s_waitcnt lgkmcnt(9)
    v_mfma_f32_16x16x32_bf16 v[4:7], v[44:47], v[128:131], v[4:7]
    ds_read_b128 v[44:47], v160 offset:7168
    s_waitcnt lgkmcnt(9)
    v_mfma_f32_16x16x32_bf16 v[8:11], v[48:51], v[128:131], v[8:11]
    ds_read_b128 v[48:51], v160 offset:8192
    s_waitcnt lgkmcnt(9)
    v_mfma_f32_16x16x32_bf16 v[12:15], v[52:55], v[128:131], v[12:15]
    ds_read_b128 v[52:55], v160 offset:9216
    s_waitcnt lgkmcnt(9)
    v_mfma_f32_16x16x32_bf16 v[16:19], v[56:59], v[128:131], v[16:19]
    ds_read_b128 v[56:59], v160 offset:10240
    s_waitcnt vmcnt(2)
    s_waitcnt lgkmcnt(9)
    v_mfma_f32_16x16x32_bf16 v[0:3], v[20:23], v[132:135], v[0:3]
    s_waitcnt lgkmcnt(8)
    v_mfma_f32_16x16x32_bf16 v[4:7], v[24:27], v[132:135], v[4:7]
    s_waitcnt lgkmcnt(7)
    v_mfma_f32_16x16x32_bf16 v[8:11], v[28:31], v[132:135], v[8:11]
    s_waitcnt lgkmcnt(6)
    v_mfma_f32_16x16x32_bf16 v[12:15], v[32:35], v[132:135], v[12:15]
    s_waitcnt lgkmcnt(5)
    v_mfma_f32_16x16x32_bf16 v[16:19], v[36:39], v[132:135], v[16:19]
    s_waitcnt vmcnt(0)
    s_waitcnt lgkmcnt(4)
    v_mfma_f32_16x16x32_bf16 v[0:3], v[40:43], v[136:139], v[0:3]
    s_waitcnt lgkmcnt(3)
    v_mfma_f32_16x16x32_bf16 v[4:7], v[44:47], v[136:139], v[4:7]
    s_waitcnt lgkmcnt(2)
    v_mfma_f32_16x16x32_bf16 v[8:11], v[48:51], v[136:139], v[8:11]
    s_waitcnt lgkmcnt(1)
    v_mfma_f32_16x16x32_bf16 v[12:15], v[52:55], v[136:139], v[12:15]
    s_waitcnt lgkmcnt(0)
    v_mfma_f32_16x16x32_bf16 v[16:19], v[56:59], v[136:139], v[16:19]
    s_cmp_eq_u32 s16, 3
    s_cbranch_scc1 L_opnb_132
    s_barrier
L_opnb_132:
    s_nop 4
    v_cvt_pk_bf16_f32 v148, v0, v1
    v_cvt_pk_bf16_f32 v149, v2, v3
    v_cvt_pk_bf16_f32 v150, v4, v5
    v_cvt_pk_bf16_f32 v151, v6, v7
    v_cvt_pk_bf16_f32 v152, v8, v9
    v_cvt_pk_bf16_f32 v153, v10, v11
    v_cvt_pk_bf16_f32 v154, v12, v13
    v_cvt_pk_bf16_f32 v155, v14, v15
    v_cvt_pk_bf16_f32 v156, v16, v17
    v_cvt_pk_bf16_f32 v157, v18, v19
    s_nop 0
    v_permlane32_swap_b32 v148, v150
    v_permlane32_swap_b32 v149, v151
    v_permlane32_swap_b32 v152, v154
    v_permlane32_swap_b32 v153, v155
    v_permlane32_swap_b32 v156, v158
    v_permlane32_swap_b32 v157, v159
    s_cmp_eq_u32 s16, 3
    s_cbranch_scc1 L_op_last
    buffer_store_dwordx4 v[148:151], v162, s[8:11], s45 offen
    buffer_store_dwordx4 v[152:155], v162, s[8:11], s45 offen offset:2048
    s_mov_b64 exec, s[28:29]
    buffer_store_dwordx4 v[156:159], v162, s[8:11], s46 offen
    s_mov_b64 exec, -1
    v_pk_add_f32 v[164:165], v[0:1], v[2:3]
    v_pk_mul_f32 v[166:167], v[0:1], v[0:1]
    v_pk_fma_f32 v[166:167], v[2:3], v[2:3], v[166:167]
    v_pk_add_f32 v[164:165], v[164:165], v[4:5]
    v_pk_fma_f32 v[166:167], v[4:5], v[4:5], v[166:167]
    v_pk_add_f32 v[164:165], v[164:165], v[6:7]
    v_pk_fma_f32 v[166:167], v[6:7], v[6:7], v[166:167]
    v_pk_add_f32 v[164:165], v[164:165], v[8:9]
    v_pk_fma_f32 v[166:167], v[8:9], v[8:9], v[166:167]
    v_pk_add_f32 v[164:165], v[164:165], v[10:11]
    v_pk_fma_f32 v[166:167], v[10:11], v[10:11], v[166:167]
    v_pk_add_f32 v[164:165], v[164:165], v[12:13]
    v_pk_fma_f32 v[166:167], v[12:13], v[12:13], v[166:167]
    v_pk_add_f32 v[164:165], v[164:165], v[14:15]
    v_pk_fma_f32 v[166:167], v[14:15], v[14:15], v[166:167]
    v_pk_add_f32 v[164:165], v[164:165], v[16:17]
    v_pk_fma_f32 v[166:167], v[16:17], v[16:17], v[166:167]
    v_pk_add_f32 v[164:165], v[164:165], v[18:19]
    v_pk_fma_f32 v[166:167], v[18:19], v[18:19], v[166:167]
    v_add_f32 v164, v164, v165
    v_add_f32 v165, v166, v167
    v_mov_b32 v166, v164
    v_mov_b32 v167, v165
    s_lshl_b32 s47, s40, 3
    s_lshl_b32 s48, s41, 10
    v_permlane32_swap_b32 v164, v166
    v_permlane32_swap_b32 v165, v167
    s_add_u32 s47, s47, s48
    s_add_u32 s47, s47, 0x1e30000
    v_add_f32 v164, v164, v166
    v_add_f32 v165, v165, v167
    v_mov_b32 v166, v164
    v_mov_b32 v167, v165
    v_lshlrev_b32 v168, 6, v172
    s_nop 0
    v_permlane16_swap_b32 v164, v166
    v_permlane16_swap_b32 v165, v167
    s_nop 0
    v_add_f32 v164, v164, v166
    v_add_f32 v165, v165, v167
    s_mov_b64 exec, 0xffff
    buffer_store_dwordx2 v[164:165], v168, s[8:11], s47 offen
    s_mov_b64 exec, -1
    s_waitcnt vmcnt(0)
    s_branch L_op_done
L_op_last:
    s_mov_b32 s20, s6
    s_and_b32 s21, s7, 0xffff
    s_mov_b32 s22, 2621440
    s_mul_i32 s47, s41, 20480
    s_mul_i32 s48, s40, 160
    s_add_u32 s47, s47, s48
    v_mul_u32_u24 v168, 1280, v172
    v_lshrrev_b32 v169, 1, v173
    v_lshl_add_u32 v168, v169, 5, v168
    v_and_b32 v169, 1, v173
    v_lshl_add_u32 v168, v169, 3, v168
    buffer_store_dwordx2 v[148:149], v168, s[20:23], s47 offen offset:0
    buffer_store_dwordx2 v[150:151], v168, s[20:23], s47 offen offset:16
    buffer_store_dwordx2 v[152:153], v168, s[20:23], s47 offen offset:64
    buffer_store_dwordx2 v[154:155], v168, s[20:23], s47 offen offset:80
    s_mov_b64 exec, s[28:29]
    buffer_store_dwordx2 v[156:157], v168, s[20:23], s47 offen offset:128
    buffer_store_dwordx2 v[158:159], v168, s[20:23], s47 offen offset:144
    s_mov_b64 exec, -1
    s_branch L_fin
L_op_help:
    s_waitcnt vmcnt(0) lgkmcnt(0)
    s_barrier
    s_add_u32 s41, s62, s63
    s_add_u32 s41, s41, 87040
    s_add_u32 s42, s63, 61440
    s_add_u32 m0, s42, 0
    s_add_u32 s43, s41, 0
    buffer_load_dwordx4 v255, s[8:11], s43 offen lds
    s_add_u32 m0, s42, 4096
    s_add_u32 s43, s41, 4096
    buffer_load_dwordx4 v255, s[8:11], s43 offen lds
    s_add_u32 m0, s42, 8192
    s_add_u32 s43, s41, 8192
    buffer_load_dwordx4 v255, s[8:11], s43 offen lds
    s_cmp_eq_u32 s12, 7
    s_cbranch_scc1 L_oph_133
    s_add_u32 m0, s42, 12288
    s_add_u32 s43, s41, 12288
    buffer_load_dwordx4 v255, s[8:11], s43 offen lds
L_oph_133:
    v_add_u32 v0, s63, v255
    v_add_u32 v1, 0x10000, v0
    v_add_u32 v2, 0x20000, v0
    s_waitcnt vmcnt(0)
    s_barrier
    s_cmp_eq_u32 s16, 3
    s_cbranch_scc1 L_fin_wb
    s_add_u32 m0, s63, 0
    s_add_u32 s36, s61, 0
    buffer_load_dwordx4 v244, s[20:23], s36 offen lds
    s_add_u32 m0, s63, 4096
    s_add_u32 s36, s61, 61440
    buffer_load_dwordx4 v244, s[20:23], s36 offen lds
    s_add_u32 m0, s63, 8192
    s_add_u32 s36, s61, 122880
    buffer_load_dwordx4 v244, s[20:23], s36 offen lds
    s_add_u32 m0, s63, 12288
    s_add_u32 s36, s61, 184320
    buffer_load_dwordx4 v244, s[20:23], s36 offen lds
    s_add_u32 m0, s63, 16384
    s_add_u32 s36, s61, 245760
    buffer_load_dwordx4 v244, s[20:23], s36 offen lds
    s_add_u32 m0, s63, 20480
    s_add_u32 s36, s61, 307200
    buffer_load_dwordx4 v244, s[20:23], s36 offen lds
    s_add_u32 m0, s63, 24576
    s_add_u32 s36, s61, 368640
    buffer_load_dwordx4 v244, s[20:23], s36 offen lds
    s_add_u32 m0, s63, 28672
    s_add_u32 s36, s61, 430080
    buffer_load_dwordx4 v244, s[20:23], s36 offen lds
    s_add_u32 m0, s63, 32768
    s_add_u32 s36, s61, 491520
    buffer_load_dwordx4 v244, s[20:23], s36 offen lds
    s_add_u32 m0, s63, 36864
    s_add_u32 s36, s61, 552960
    buffer_load_dwordx4 v244, s[20:23], s36 offen lds
    s_add_u32 m0, s63, 40960
    s_add_u32 s36, s61, 614400
    buffer_load_dwordx4 v244, s[20:23], s36 offen lds
    s_add_u32 m0, s63, 45056
    s_add_u32 s36, s61, 675840
    buffer_load_dwordx4 v244, s[20:23], s36 offen lds
    s_add_u32 m0, s63, 49152
    s_add_u32 s36, s61, 737280
    buffer_load_dwordx4 v244, s[20:23], s36 offen lds
    s_add_u32 m0, s63, 53248
    s_add_u32 s36, s61, 798720
    buffer_load_dwordx4 v244, s[20:23], s36 offen lds
    s_add_u32 m0, s63, 57344
    s_add_u32 s36, s61, 860160
    buffer_load_dwordx4 v244, s[20:23], s36 offen lds
    s_barrier
    ds_write_b128 v0, v[138:141] offset:61440
    ds_write_b128 v1, v[142:145] offset:0
    ds_write_b128 v1, v[146:149] offset:4096
    ds_write_b128 v1, v[150:153] offset:8192
    ds_write_b128 v1, v[154:157] offset:12288
    ds_write_b128 v1, v[158:161] offset:16384
    ds_write_b128 v1, v[162:165] offset:20480
    ds_write_b128 v1, v[166:169] offset:24576
    ds_write_b128 v1, v[170:173] offset:28672
    ds_write_b128 v1, v[174:177] offset:32768
L_op_done:
    s_add_u32 s17, s17, 1
    s_barrier
    s_cmp_lg_u32 s12, 0
    s_cbranch_scc1 L_op_sk_134
    s_mov_b64 exec, 1
    v_mov_b32 v240, s17
    v_mov_b32 v241, s19
    s_cmp_lg_u32 s15, 0
    s_cbranch_scc1 L_op_sf_135
    buffer_store_dword v240, v241, s[8:11], 0 offen
    s_branch L_op_g_136
L_op_sf_135:
    buffer_wbl2 sc1
    s_waitcnt vmcnt(0)
    buffer_store_dword v240, v241, s[8:11], 0 offen sc1
L_op_g_136:
    s_mov_b64 exec, -1
L_op_sk_134:
    s_add_u32 s16, s16, 1
    s_branch L_qkv
L_fin_wb:
L_fin:
L_exit:
    s_endpgm
L_code_end:

.section .rodata,"a"
.p2align 6
.amdhsa_kernel interleave_layers__sliding_block__mha_block__prompt_kernel
  .amdhsa_next_free_vgpr 256
  .amdhsa_next_free_sgpr 102
  .amdhsa_accum_offset 256
  .amdhsa_group_segment_fixed_size 0
  .amdhsa_kernarg_size 72
  .amdhsa_user_sgpr_count 2
  .amdhsa_user_sgpr_kernarg_segment_ptr 1
  .amdhsa_system_sgpr_workgroup_id_x 1
  .amdhsa_float_denorm_mode_32 3
.end_amdhsa_kernel
```
